```python
import torch

def _softmax(x, axis=-1):
    return torch.softmax(x, dim=axis)
def _gelu(x):
    return torch.nn.functional.gelu(x, approximate="tanh")
def _silu(x):
    return torch.nn.functional.silu(x)
def _sigmoid(x):
    return torch.sigmoid(x)
def _layernorm(x, axis=-1, eps=1e-5):
    m = x.mean(dim=axis, keepdim=True)
    v = x.var(dim=axis, keepdim=True, unbiased=False)
    return (x - m) / torch.sqrt(v + eps)
def _scatter_add(tgt, idx, src, axis=0):
    return tgt.clone().index_add_(axis, idx, src)
def _segment_sum(src, seg, n):
    out = torch.zeros((n,) + src.shape[1:], dtype=src.dtype)
    return out.index_add_(0, seg, src)
def _pad(x, pw):
    flat = tuple(v for pair in reversed(pw) for v in pair)
    return torch.nn.functional.pad(x, flat)

kernel_name = 'sequential_preLN__grouped_kv_mqa__glu_gated_swiglu__prompt'

def setup_inputs():

    _w = (lambda a: (lambda t: t.to(torch.bfloat16) if t.is_floating_point() else t)(torch.as_tensor(a)))
    def _A_setup():
        B, S, D, H = 1, 2048, 640, 32
        Dh = D // H
        return {
            "x": _w((lambda *s: torch.randn(*s, dtype=torch.bfloat16) * 0.05)(B, S, D)),
            "wq": _w((lambda *s: torch.randn(*s, dtype=torch.bfloat16) * 0.05)(D, H * Dh)),
            "wk": _w((lambda *s: torch.randn(*s, dtype=torch.bfloat16) * 0.05)(D, Dh)),
            "wv": _w((lambda *s: torch.randn(*s, dtype=torch.bfloat16) * 0.05)(D, Dh)),
            "wo": _w((lambda *s: torch.randn(*s, dtype=torch.bfloat16) * 0.05)(H * Dh, D)),
        }
    _A_in = _A_setup()

    def _B_setup():
        B, S, D, F = 1, 2048, 640, 1728
        return {
            "x": _w((lambda *s: torch.randn(*s, dtype=torch.bfloat16) * 0.05)(B, S, D)),
            "w1": _w((lambda *s: torch.randn(*s, dtype=torch.bfloat16) * 0.4)(D, F) * (2.0 / D) ** 0.5),
            "w3": _w((lambda *s: torch.randn(*s, dtype=torch.bfloat16) * 0.4)(D, F) * (2.0 / D) ** 0.5),
            "w2": _w((lambda *s: torch.randn(*s, dtype=torch.bfloat16) * 0.4)(F, D) * (2.0 / F) ** 0.5),
        }
    _B_in = _B_setup()

    return {
        "A_x": _A_in["x"],
        "A_wq": _A_in["wq"],
        "A_wk": _A_in["wk"],
        "A_wv": _A_in["wv"],
        "A_wo": _A_in["wo"],
        "B_x": _B_in["x"],
        "B_w1": _B_in["w1"],
        "B_w3": _B_in["w3"],
        "B_w2": _B_in["w2"],
    }

def reference(A_x, A_wq, A_wk, A_wv, A_wo, B_x, B_w1, B_w3, B_w2):
    def _A_ref(x, wq, wk, wv, wo):
        B, S, D = x.shape
        H = 32
        Dh = D // H
        q = (lambda x, *d: x.permute(*d))((x @ wq).reshape(B, S, H, Dh), 0, 2, 1, 3)
        k = x @ wk
        v = x @ wv
        scores = torch.einsum("bhqd,bkd->bhqk", q, k) * (Dh ** -0.5)
        p = _softmax(scores, axis=-1)
        o = torch.einsum("bhqk,bkd->bhqd", p, v)
        return (lambda x, *d: x.permute(*d))(o, 0, 2, 1, 3).reshape(B, S, H * Dh) @ wo

    def _B_ref(x, w1, w3, w2):
        gate = torch.einsum("bsd,df->bsf", x, w1)
        up = torch.einsum("bsd,df->bsf", x, w3)
        h = _silu(gate) * up
        out = torch.einsum("bsf,fd->bsd", h, w2)
        return out

    x = A_x
    h = x + _A_ref(_layernorm(x, axis=-1), A_wq, A_wk, A_wv, A_wo)
    h2 = h + _B_ref(_layernorm(h, axis=-1), B_w1, B_w3, B_w2)
    return h2
```

```asm
; @launch grid=(256,1,1) block=(512,1,1) lds=163840
.amdgcn_target "amdgcn-amd-amdhsa--gfx950"
.text
.globl sequential_preLN__grouped_kv_mqa__glu_gated_swiglu__prompt_kernel
.p2align 12
.p2align 8
.type sequential_preLN__grouped_kv_mqa__glu_gated_swiglu__prompt_kernel,@function
sequential_preLN__grouped_kv_mqa__glu_gated_swiglu__prompt_kernel:
    s_cmp_ge_u32 s2, 256
    s_cbranch_scc1 L_END
    s_load_dwordx16 s[16:31], s[0:1], 0
    s_load_dwordx8 s[32:39], s[0:1], 64
    s_memrealtime s[100:101]
    v_lshrrev_b32 v1, 6, v0
    s_and_b32 s10, s2, 7
    s_lshr_b32 s11, s2, 3
    v_readfirstlane_b32 s3, v1
    s_lshr_b32 s13, s2, 6
    s_lshl2_add_u32 s6, s10, s13
    s_and_b32 s5, s11, 7
    v_and_b32 v1, 63, v0
    v_lshrrev_b32 v4, 3, v1
    v_lshrrev_b32 v5, 4, v1
    v_xor_b32 v5, v5, v1
    v_and_b32 v5, 7, v5
    v_mul_u32_u24 v4, 1280, v4
    v_lshl_add_u32 v128, v5, 4, v4
    v_xor_b32 v129, 64, v128
    v_add_u32 v129, 9216, v129
    v_lshlrev_b32 v15, 4, v1
    s_mul_i32 s72, s13, 5
    s_lshr_b32 s72, s72, 1
    s_lshr_b32 s73, s5, 1
    s_mul_i32 s74, s6, 81920
    s_mov_b32 s42, 2621440
    s_mov_b32 s43, 0x00020000
    s_mov_b32 s50, 25600
    s_mov_b32 s51, 0x00020000
    s_mov_b32 s46, 819200
    s_mov_b32 s47, 0x00020000
    s_mov_b32 s66, 256
    s_mov_b32 s67, 0x00020000
    s_mov_b32 s9, 60000
    s_sub_u32 s10, s3, 5
    s_cmp_lt_u32 s10, 2
    s_cbranch_scc1 P1_LD
    s_mov_b32 s12, 133952
    v_lshl_add_u32 v4, v1, 2, s12
    v_mov_b32 v8, 0
    ds_write_b32 v4, v8
    s_and_b32 s10, s5, 1
    s_mul_i32 s10, s10, 5
    s_add_u32 s10, s10, s3
    s_add_u32 s81, s10, s72
    s_cmp_ge_u32 s81, 10
    s_cselect_b32 s12, 10, 0
    s_sub_u32 s81, s81, s12
    s_lshl2_add_u32 s82, s10, s73
    s_lshl_b32 s82, s82, 11
    s_mul_i32 s14, s73, 20480
    s_add_u32 s14, s14, s74
    s_lshl_b32 s12, s81, 7
    s_add_u32 s12, s12, s14
    s_mov_b32 m0, s82
    s_mul_i32 s83, s3, 5120
    s_add_u32 s83, s83, 137984
    s_bitcmp1_b32 s5, 0
    s_waitcnt lgkmcnt(0)
    s_mov_b64 s[40:41], s[16:17]
    s_cselect_b64 s[48:49], s[22:23], s[20:21]
    s_mov_b64 s[44:45], s[18:19]
    s_mov_b64 s[64:65], s[36:37]
    s_mov_b32 s20, s14
    s_cmp_eq_u32 s3, 7
    s_cbranch_scc1 P1_T
    buffer_load_dwordx4 v128, s[40:43], s12 offen lds
    buffer_load_dwordx4 v129, s[40:43], s12 offen offset:1024 lds
    s_branch P1_COM
P1_LD:
    s_sub_u32 s14, s3, 5
    v_add_u32 v7, 0, v1
    v_mul_u32_u24 v4, 205, v7
    v_lshrrev_b32 v4, 11, v4
    v_mul_u32_u24 v5, 10, v4
    v_sub_u32 v5, v7, v5
    v_and_b32 v6, 19, v4
    v_bfe_u32 v7, v4, 2, 1
    v_lshl_add_u32 v6, v7, 3, v6
    v_bfe_u32 v7, v4, 3, 1
    v_lshl_add_u32 v6, v7, 2, v6
    v_mul_u32_u24 v6, 1280, v6
    v_lshl_add_u32 v64, v5, 4, v6
    v_add_u32 v7, 64, v1
    v_mul_u32_u24 v4, 205, v7
    v_lshrrev_b32 v4, 11, v4
    v_mul_u32_u24 v5, 10, v4
    v_sub_u32 v5, v7, v5
    v_and_b32 v6, 19, v4
    v_bfe_u32 v7, v4, 2, 1
    v_lshl_add_u32 v6, v7, 3, v6
    v_bfe_u32 v7, v4, 3, 1
    v_lshl_add_u32 v6, v7, 2, v6
    v_mul_u32_u24 v6, 1280, v6
    v_lshl_add_u32 v65, v5, 4, v6
    v_subrev_u32 v65, 1024, v65
    v_add_u32 v7, 128, v1
    v_mul_u32_u24 v4, 205, v7
    v_lshrrev_b32 v4, 11, v4
    v_mul_u32_u24 v5, 10, v4
    v_sub_u32 v5, v7, v5
    v_and_b32 v6, 19, v4
    v_bfe_u32 v7, v4, 2, 1
    v_lshl_add_u32 v6, v7, 3, v6
    v_bfe_u32 v7, v4, 3, 1
    v_lshl_add_u32 v6, v7, 2, v6
    v_mul_u32_u24 v6, 1280, v6
    v_lshl_add_u32 v66, v5, 4, v6
    v_subrev_u32 v66, 2048, v66
    v_add_u32 v7, 192, v1
    v_mul_u32_u24 v4, 205, v7
    v_lshrrev_b32 v4, 11, v4
    v_mul_u32_u24 v5, 10, v4
    v_sub_u32 v5, v7, v5
    v_and_b32 v6, 19, v4
    v_bfe_u32 v7, v4, 2, 1
    v_lshl_add_u32 v6, v7, 3, v6
    v_bfe_u32 v7, v4, 3, 1
    v_lshl_add_u32 v6, v7, 2, v6
    v_mul_u32_u24 v6, 1280, v6
    v_lshl_add_u32 v67, v5, 4, v6
    v_subrev_u32 v67, 3072, v67
    v_add_u32 v7, 256, v1
    v_mul_u32_u24 v4, 205, v7
    v_lshrrev_b32 v4, 11, v4
    v_mul_u32_u24 v5, 10, v4
    v_sub_u32 v5, v7, v5
    v_and_b32 v6, 19, v4
    v_bfe_u32 v7, v4, 2, 1
    v_lshl_add_u32 v6, v7, 3, v6
    v_bfe_u32 v7, v4, 3, 1
    v_lshl_add_u32 v6, v7, 2, v6
    v_mul_u32_u24 v6, 1280, v6
    v_lshl_add_u32 v68, v5, 4, v6
    s_bitcmp1_b32 s5, 0
    s_waitcnt lgkmcnt(0)
    s_mov_b64 s[40:41], s[16:17]
    s_cselect_b64 s[48:49], s[22:23], s[20:21]
    s_mov_b64 s[44:45], s[18:19]
    s_mov_b64 s[64:65], s[36:37]
    s_mul_i32 s10, s14, 3
    s_lshl_b32 s11, s73, 1
    s_add_u32 s10, s10, s11
    s_add_u32 s11, s10, 2
    s_and_b32 s11, s11, 7
    s_lshl_b32 s16, s11, 10
    s_mul_i32 s12, s11, 10240
    s_add_u32 s12, s12, s74
    s_and_b32 s11, s11, 1
    s_lshl_b32 s11, s11, 6
    v_xor_b32 v72, s11, v128
    v_add_u32 v72, s12, v72
    s_add_u32 s11, s10, 3
    s_and_b32 s11, s11, 7
    s_lshl_b32 s17, s11, 10
    s_mul_i32 s12, s11, 10240
    s_add_u32 s12, s12, s74
    s_and_b32 s11, s11, 1
    s_lshl_b32 s11, s11, 6
    v_xor_b32 v73, s11, v128
    v_add_u32 v73, s12, v73
    s_add_u32 s11, s10, 4
    s_and_b32 s11, s11, 7
    s_lshl_b32 s18, s11, 10
    s_mul_i32 s12, s11, 10240
    s_add_u32 s12, s12, s74
    s_and_b32 s11, s11, 1
    s_lshl_b32 s11, s11, 6
    v_xor_b32 v74, s11, v128
    v_add_u32 v74, s12, v74
    s_mul_i32 s82, s14, 40960
    s_mul_i32 s10, s5, 160
    s_add_u32 s82, s82, s10
    s_mul_i32 s83, s14, 5120
    s_add_u32 s83, s83, 81920
    s_mov_b32 s81, s72
    s_mov_b32 s15, 0
    s_lshl_b32 s10, s14, 2
    s_add_u32 s10, s10, 133952
    v_mov_b32 v12, 0x30000
    v_writelane_b32 v12, s10, 0
    v_min_u32 v13, 3, v1
    v_lshlrev_b32 v13, 2, v13
    v_add_u32 v13, 133984, v13
    s_mov_b64 exec, 0
    s_cmp_eq_u32 s14, 1
    s_cbranch_scc1 WARMA1
    s_branch WARMA0
WRETA:
    s_mov_b64 exec, -1
    s_mul_i32 s10, s81, 81920
    s_mov_b32 m0, s83
    s_add_u32 s10, s10, s82
    s_lshl_b32 s11, s81, 7
    v_mov_b32 v9, 0
    s_barrier
    s_setprio 3
LD_L:
    buffer_load_dwordx4 v64, s[44:47], s10 offen offset:0 lds
    s_waitcnt vmcnt(9)
    ds_write_b32 v12, v9
    buffer_load_dwordx4 v65, s[44:47], s10 offen offset:1024 lds
    s_add_u32 s81, s81, 1
    s_cmp_eq_u32 s81, 10
    s_cselect_b32 s81, 0, s81
    buffer_load_dwordx4 v66, s[44:47], s10 offen offset:2048 lds
    s_cmp_eq_u32 s15, 4
    s_cselect_b32 s12, 51200, 0
    s_sub_u32 s83, s83, s12
    buffer_load_dwordx4 v67, s[44:47], s10 offen offset:3072 lds
    s_add_u32 m0, m0, 4096
    s_add_u32 s83, s83, 10240
    v_mov_b32 v9, s15
    buffer_load_dwordx4 v68, s[44:47], s10 offen offset:0 lds
    s_mov_b32 m0, s16
    s_add_u32 s16, s16, 8192
    ds_read_b32 v8, v13
    s_sub_i32 s12, s15, 3
    buffer_load_dwordx4 v72, s[40:43], s11 offen lds
    s_mov_b32 m0, s17
    s_add_u32 s17, s17, 8192
    s_mul_i32 s10, s81, 81920
    s_add_u32 s10, s10, s82
    buffer_load_dwordx4 v73, s[40:43], s11 offen lds
    s_mov_b32 m0, s18
    s_add_u32 s18, s18, 8192
    s_waitcnt lgkmcnt(0)
    v_cmp_gt_i32 vcc, s12, v8
    s_add_u32 s15, s15, 1
    buffer_load_dwordx4 v74, s[40:43], s11 offen lds
    s_mov_b32 m0, s83
    s_lshl_b32 s11, s81, 7
    s_cmp_eq_u32 s15, 10
    s_cbranch_scc1 LD_F
    s_cbranch_vccz LD_L
    s_waitcnt vmcnt(8)
    ds_write_b32 v12, v9
LD_C:
    ds_read_b32 v8, v13
    s_waitcnt lgkmcnt(0)
    v_cmp_gt_i32 vcc, s12, v8
    s_cbranch_vccz LD_L
    s_sub_i32 s9, s9, 1
    s_cmp_gt_i32 s9, 0
    s_cbranch_scc1 LD_C
    s_branch LD_L
LD_F:
    s_waitcnt vmcnt(8)
    ds_write_b32 v12, v9
LD_E:
    v_mov_b32 v9, 64
    s_waitcnt vmcnt(0)
    ds_write_b32 v12, v9
    s_branch P1_COM
P1_T:
    v_lshlrev_b32 v4, 4, v15
    s_lshr_b32 s10, s11, 1
    s_mul_i32 s10, s10, 1600
    s_andn2_b32 s10, s10, 127
    s_mov_b64 exec, 0x7f
    buffer_load_dwordx2 v[16:17], v4, s[48:51], s10 offen offset:124
    s_mov_b64 exec, 1
    buffer_load_dword v16, v4, s[44:47], s10 offen
    s_or_b32 s100, s100, 1
    v_mov_b32 v5, s100
    s_cmp_lg_u32 s2, 0
    s_cbranch_scc1 P1_T1
    buffer_store_dword v5, v8, s[64:67], 0 offen sc1
P1_T1:
    s_mov_b64 exec, -1
P1_COM:
    s_mov_b32 s68, s38
    s_mov_b32 s69, s39
    s_mov_b32 s70, 67108864
    s_mov_b32 s71, 0x00020000
    s_mov_b32 s60, s34
    s_mov_b32 s61, s35
    s_mov_b32 s62, 2621440
    s_mov_b32 s63, 0x00020000
    s_and_b32 s10, s6, 1
    s_mul_i32 s10, s10, 7
    s_add_u32 s10, s10, s5
    s_lshl3_add_u32 s11, s10, s3
    s_lshr_b32 s11, s11, 2
    s_cmp_eq_u32 s11, 27
    s_cselect_b32 s80, 0x30000, 0
    s_lshl_b32 s10, s10, 8
    s_mul_i32 s11, s6, 81920
    s_cmp_eq_u32 s5, 7
    s_cselect_b64 s[52:53], s[32:33], s[28:29]
    s_cselect_b64 s[56:57], s[32:33], s[30:31]
    s_cselect_b32 s10, s11, s10
    s_movk_i32 s11, 3456
    s_cselect_b32 s11, 1280, s11
    s_cselect_b32 s12, 256, 0
    s_mov_b32 s78, 221184
    s_cselect_b32 s78, 512, s78
    s_mov_b32 s54, 2211840
    s_mov_b32 s55, 0x00020000
    s_mov_b32 s58, 2211840
    s_mov_b32 s59, 0x00020000
    s_mov_b32 s26, 819200
    s_mov_b32 s27, 0x00020000
    s_lshl_b32 s77, s11, 2
    s_mul_i32 s75, s77, s3
    s_lshl1_add_u32 s75, s75, s10
    s_add_u32 s76, s75, s12
    s_sub_u32 s77, s77, 1024
    s_lshr_b32 s79, s6, 1
    s_lshl_b32 s79, s79, 20
    s_add_u32 s79, s79, 2097152
    s_getreg_b32 s8, hwreg(HW_REG_XCC_ID)
    s_and_b32 s10, s3, 1
    s_lshl_b32 s10, s10, 2
    v_lshrrev_b32 v4, 4, v1
    v_mul_lo_u32 v5, v4, s11
    v_or_b32 v6, s10, v4
    v_lshlrev_b32 v6, 5, v6
    v_and_b32 v7, 0xf0, v15
    v_xor_b32 v6, v6, v7
    v_add_u32 v14, v5, v6
    v_add_u32 v9, s77, v14
    v_bfe_u32 v5, v1, 2, 3
    v_xor_b32 v5, s3, v5
    v_and_b32 v6, 3, v1
    v_lshl_add_u32 v6, v6, 3, s80
    v_lshl_add_u32 v5, v5, 5, v6
    v_bfe_u32 v6, v1, 2, 2
    v_lshl_add_u32 v6, v4, 3, v6
    v_lshl_add_u32 v5, v6, 8, v5
    v_add_u32 v13, 16384, v5
    v_add_u32 v12, 81920, v5
    v_mul_u32_u24 v4, 205, v1
    v_lshrrev_b32 v4, 11, v4
    v_mul_u32_u24 v4, 1120, v4
    v_add_u32 v11, v4, v15
    v_lshrrev_b32 v2, 5, v1
    v_and_b32 v3, 31, v1
    s_lshr_b32 s10, s3, 2
    s_and_b32 s11, s3, 3
    s_lshl_b32 s12, s10, 14
    s_mul_i32 s13, s11, 80
    s_add_u32 s12, s12, s13
    v_and_b32 v4, 15, v1
    v_mul_u32_u24 v4, 336, v4
    v_bfe_u32 v5, v1, 4, 1
    v_lshl_add_u32 v4, v5, 13, v4
    v_lshl_add_u32 v5, v2, 3, s12
    v_add_u32 v91, v4, v5
    v_mul_u32_u24 v6, 24, v2
    v_add_u32 v90, v91, v6
    s_add_u32 s13, s13, 133632
    v_lshl_add_u32 v93, v2, 3, s13
    v_add_u32 v92, v93, v6
    s_lshl_b32 s12, s10, 8
    s_add_u32 s12, s12, 133120
    v_lshl_add_u32 v94, v3, 3, s12
    v_lshlrev_b32 v10, 4, v15
    v_add_u32 v85, 114688, v15
    v_lshlrev_b32 v8, 2, v2
    v_lshl_add_u32 v8, v3, 4, v8
    v_add_u32 v86, 117248, v8
    v_min_u32 v8, 20, v3
    v_mul_u32_u24 v2, 384, v2
    v_lshl_add_u32 v8, v8, 4, v2
    v_add_u32 v87, 115712, v8
    s_mov_b32 exec_lo, 0xeef00000
    s_mov_b32 exec_hi, 0xeef00000
    v_mov_b32 v87, 0x30000
    s_mov_b64 exec, -1
    v_mov_b32 v84, 0xdddddddd
    v_mov_b32 v69, 0
    v_mov_b32 v71, 0x3f803f80
    s_mov_b32 exec_lo, 0
    v_mov_b32 v71, 0
    s_mov_b32 exec_lo, -1
    v_mov_b32 v48, 0
    v_mov_b32 v49, 0
    v_mov_b32 v50, 0
    v_mov_b32 v51, 0
    v_mov_b32 v52, 0
    v_mov_b32 v53, 0
    v_mov_b32 v54, 0
    v_mov_b32 v55, 0
    v_mov_b32 v56, 0
    v_mov_b32 v57, 0
    v_mov_b32 v58, 0
    v_mov_b32 v59, 0
    v_mov_b32 v60, 0
    v_mov_b32 v61, 0
    v_mov_b32 v62, 0
    v_mov_b32 v63, 0
    v_mov_b32 v95, 134016
    s_and_b32 s12, s6, 1
    s_lshl1_add_u32 s12, s12, s10
    s_lshl3_add_u32 s12, s12, s5
    s_lshl2_add_u32 s16, s12, s11
    s_mul_i32 s73, s3, 3072
    s_lshr_b32 s72, s6, 2
    s_lshl_b32 s72, s72, 15
    s_add_u32 s72, s72, s73
    s_bitset1_b32 s72, 19
    s_mov_b32 s74, 0
    s_lshl_b32 s17, s3, 11
    s_mul_i32 s19, s3, 960
    s_mul_i32 s12, s5, 160
    s_lshl3_add_u32 s18, s19, s12
    s_sub_u32 s10, s3, 5
    s_cmp_lt_u32 s10, 2
    s_cbranch_scc1 P1_END
    v_mov_b32 v140, 0x3f803f80
    s_mov_b32 s28, 0x100001
    s_mov_b32 s29, 0x10000100
    v_mov_b32 v141, 0x3f803f80
    s_mov_b32 s30, 0x200002
    s_mov_b32 s31, 0x20000200
    v_mov_b32 v142, 0x3f803f80
    s_mov_b32 s32, 0x400004
    s_mov_b32 s33, 0x40000400
    v_mov_b32 v143, 0x3f803f80
    s_mov_b32 s34, 0x800008
    s_mov_b32 s35, 0x80000800
    v_lshrrev_b32 v131, 4, v1
    v_and_b32 v132, 15, v1
    v_bfe_u32 v133, v1, 2, 2
    v_and_b32 v134, 3, v1
    s_cmp_eq_u32 s3, 7
    s_cbranch_scc1 P1_KV
    v_lshrrev_b32 v130, 1, v132
    v_xor_b32 v130, v130, v131
    v_lshlrev_b32 v130, 4, v130
    v_lshl_add_u32 v130, v132, 7, v130
    v_add_u32 v44, s82, v130
    s_bitcmp1_b32 s5, 0
    s_mov_b32 s10, 40960
    s_cselect_b32 s10, 0xffff6000, s10
    s_add_u32 s82, s82, s10
    v_add_u32 v46, s10, v44
    v_xor_b32 v45, 64, v44
    v_xor_b32 v47, 64, v46
    v_lshl_add_u32 v137, v131, 3, v133
    v_mul_u32_u24 v137, 40, v137
    v_lshl_add_u32 v137, v134, 3, v137
    v_add_u32 v137, s83, v137
    v_add_u32 v138, s83, v15
    v_lshl_add_u32 v139, v1, 3, s83
    v_mov_b32 v16, 0
    v_mov_b32 v17, 0
    v_mov_b32 v18, 0
    v_mov_b32 v19, 0
    v_mov_b32 v20, 0
    v_mov_b32 v21, 0
    v_mov_b32 v22, 0
    v_mov_b32 v23, 0
    v_mov_b32 v24, 0
    v_mov_b32 v25, 0
    v_mov_b32 v26, 0
    v_mov_b32 v27, 0
    v_mov_b32 v28, 0
    v_mov_b32 v29, 0
    v_mov_b32 v30, 0
    v_mov_b32 v31, 0
    v_mov_b32 v32, 0
    v_mov_b32 v33, 0
    v_mov_b32 v34, 0
    v_mov_b32 v35, 0
    v_mov_b32 v36, 0
    v_mov_b32 v37, 0
    v_mov_b32 v38, 0
    v_mov_b32 v39, 0
    v_mov_b32 v40, 0
    v_mov_b32 v41, 0
    v_mov_b32 v42, 0
    v_mov_b32 v43, 0
    v_mov_b32 v104, 0
    v_mov_b32 v105, 0
    v_mov_b32 v106, 0
    v_mov_b32 v107, 0
    v_mov_b32 v108, 0
    v_mov_b32 v109, 0
    v_mov_b32 v110, 0
    v_mov_b32 v111, 0
    v_lshrrev_b32 v135, 1, v131
    v_lshl_add_u32 v133, v135, 4, v133
    v_and_b32 v135, 1, v131
    v_lshl_add_u32 v133, v135, 2, v133
    v_mul_u32_u24 v133, 160, v133
    v_lshl_add_u32 v133, v134, 3, v133
    v_add_u32 v133, 81920, v133
    v_mul_u32_u24 v135, 336, v132
    v_lshl_add_u32 v135, v131, 4, v135
    v_lshl_add_u32 v135, s3, 13, v135
    v_lshl_add_u32 v112, s3, 5, v133
    v_lshl_add_u32 v118, s3, 6, v135
    s_add_u32 s11, s3, 2
    s_cmp_ge_u32 s11, 5
    s_cselect_b32 s12, 5, 0
    s_sub_u32 s11, s11, s12
    v_lshl_add_u32 v113, s11, 5, v133
    v_lshl_add_u32 v119, s11, 6, v135
    s_add_u32 s11, s3, 3
    s_cmp_ge_u32 s11, 5
    s_cselect_b32 s12, 5, 0
    s_sub_u32 s11, s11, s12
    v_lshl_add_u32 v114, s11, 5, v133
    v_lshl_add_u32 v120, s11, 6, v135
    s_add_u32 s11, s3, 4
    s_cmp_ge_u32 s11, 5
    s_cselect_b32 s12, 5, 0
    s_sub_u32 s11, s11, s12
    v_lshl_add_u32 v115, s11, 5, v133
    v_lshl_add_u32 v121, s11, 6, v135
    v_lshl_add_u32 v116, s3, 11, v130
    v_xor_b32 v117, 64, v116
    s_lshl_b32 s10, s3, 7
    s_add_u32 s10, s10, 133120
    v_mov_b32 v122, 0x30000
    v_mov_b32 v123, 0x30000
    s_mov_b32 exec_lo, 0x00f0000f
    s_mov_b32 exec_hi, 0xf0000f00
    v_lshl_add_u32 v122, v132, 3, s10
    s_lshl_b32 s10, s3, 6
    s_add_u32 s10, s10, 133632
    s_mov_b32 exec_lo, 0x00010001
    s_mov_b32 exec_hi, 0x00010001
    v_lshl_add_u32 v123, v131, 4, s10
    s_mov_b64 exec, -1
    v_min_u32 v125, 6, v1
    v_lshlrev_b32 v125, 2, v125
    v_add_u32 v125, 133952, v125
    s_lshl_b32 s10, s3, 2
    s_add_u32 s10, s10, 133960
    v_mov_b32 v126, 0x30000
    v_writelane_b32 v126, s10, 0
    s_cmp_eq_u32 s3, 4
    s_cselect_b32 s10, 10, 64
    v_mov_b32 v127, s10
    s_mov_b32 s15, 1
    s_mov_b32 m0, s83
    s_mul_i32 s11, s81, 2560
    buffer_load_dwordx4 v15, s[48:51], s11 offen offset:0 lds
    buffer_load_dwordx4 v15, s[48:51], s11 offen offset:1024 lds
    s_mov_b32 exec_hi, 0
    buffer_load_dwordx4 v15, s[48:51], s11 offen offset:2048 lds
    s_mov_b32 exec_hi, -1
    s_cmp_ge_u32 s81, 5
    s_cselect_b32 s11, -5, 5
    s_add_u32 s81, s81, s11
    s_mov_b32 m0, s82
    s_lshl_b32 s12, s81, 7
    s_add_u32 s12, s12, s20
    buffer_load_dwordx4 v128, s[40:43], s12 offen lds
    buffer_load_dwordx4 v129, s[40:43], s12 offen offset:1024 lds
    s_add_u32 m0, s83, 2560
    s_mul_i32 s11, s81, 2560
    buffer_load_dwordx4 v15, s[48:51], s11 offen offset:0 lds
    buffer_load_dwordx4 v15, s[48:51], s11 offen offset:1024 lds
    s_mov_b32 exec_hi, 0
    buffer_load_dwordx4 v15, s[48:51], s11 offen offset:2048 lds
    s_mov_b32 exec_hi, -1
    s_barrier
    s_waitcnt vmcnt(5)
    ds_read_b128 v[176:179], v44
    ds_read_b64_tr_b16 v[168:169], v137 offset:0
    ds_read_b64_tr_b16 v[170:171], v137 offset:160
    ds_read_b64_tr_b16 v[172:173], v137 offset:32
    ds_read_b64_tr_b16 v[174:175], v137 offset:192
    ds_read_b128 v[188:191], v45
    ds_read_b64_tr_b16 v[180:181], v137 offset:1280
    ds_read_b64_tr_b16 v[182:183], v137 offset:1440
    ds_read_b64_tr_b16 v[184:185], v137 offset:1312
    ds_read_b64_tr_b16 v[186:187], v137 offset:1472
    s_waitcnt lgkmcnt(5)
    v_mfma_f32_16x16x32_bf16 v[164:167], v[176:179], v[176:179], 0
    v_mfma_f32_16x16x32_bf16 v[148:151], v[172:175], v[176:179], 0
    v_mfma_f32_16x16x32_bf16 v[156:159], v[172:175], v[140:143], 0
    v_mfma_f32_16x16x32_bf16 v[160:163], v[140:143], v[176:179], 0
    v_mfma_f32_16x16x32_bf16 v[152:155], v[168:171], v[140:143], 0
    v_mfma_f32_16x16x32_bf16 v[144:147], v[168:171], v[176:179], 0
    s_waitcnt vmcnt(0)
    ds_read_b128 v[200:203], v46
    ds_read_b64_tr_b16 v[192:193], v137 offset:2560
    ds_read_b64_tr_b16 v[194:195], v137 offset:2720
    ds_read_b64_tr_b16 v[196:197], v137 offset:2592
    ds_read_b64_tr_b16 v[198:199], v137 offset:2752
    ds_read_b128 v[212:215], v47
    ds_read_b64_tr_b16 v[204:205], v137 offset:3840
    ds_read_b64_tr_b16 v[206:207], v137 offset:4000
    ds_read_b64_tr_b16 v[208:209], v137 offset:3872
    ds_read_b64_tr_b16 v[210:211], v137 offset:4032
    s_waitcnt lgkmcnt(10)
    v_mfma_f32_16x16x32_bf16 v[164:167], v[188:191], v[188:191], v[164:167]
    v_mfma_f32_16x16x32_bf16 v[148:151], v[184:187], v[188:191], v[148:151]
    v_mfma_f32_16x16x32_bf16 v[156:159], v[184:187], v[140:143], v[156:159]
    v_mfma_f32_16x16x32_bf16 v[160:163], v[140:143], v[188:191], v[160:163]
    v_mfma_f32_16x16x32_bf16 v[152:155], v[180:183], v[140:143], v[152:155]
    v_mfma_f32_16x16x32_bf16 v[144:147], v[180:183], v[188:191], v[144:147]
    s_waitcnt lgkmcnt(5)
    v_mfma_f32_16x16x32_bf16 v[164:167], v[200:203], v[200:203], v[164:167]
    v_mfma_f32_16x16x32_bf16 v[148:151], v[196:199], v[200:203], v[148:151]
    v_mfma_f32_16x16x32_bf16 v[156:159], v[196:199], v[140:143], v[156:159]
    v_mfma_f32_16x16x32_bf16 v[160:163], v[140:143], v[200:203], v[160:163]
    v_mfma_f32_16x16x32_bf16 v[152:155], v[192:195], v[140:143], v[152:155]
    v_mfma_f32_16x16x32_bf16 v[144:147], v[192:195], v[200:203], v[144:147]
    s_waitcnt lgkmcnt(0)
    v_mfma_f32_16x16x32_bf16 v[164:167], v[212:215], v[212:215], v[164:167]
    v_mfma_f32_16x16x32_bf16 v[148:151], v[208:211], v[212:215], v[148:151]
    v_mfma_f32_16x16x32_bf16 v[156:159], v[208:211], v[140:143], v[156:159]
    v_mfma_f32_16x16x32_bf16 v[160:163], v[140:143], v[212:215], v[160:163]
    v_mfma_f32_16x16x32_bf16 v[152:155], v[204:207], v[140:143], v[152:155]
    v_mfma_f32_16x16x32_bf16 v[144:147], v[204:207], v[212:215], v[144:147]
    s_nop 2
    v_cndmask_b32 v135, 0, v164, s[28:29]
    v_cndmask_b32 v135, v135, v165, s[30:31]
    v_cndmask_b32 v135, v135, v166, s[32:33]
    v_cndmask_b32 v135, v135, v167, s[34:35]
    v_permlane16_swap_b32 v148, v156
    v_permlane16_swap_b32 v149, v157
    v_permlane16_swap_b32 v150, v158
    v_permlane16_swap_b32 v151, v159
    v_mov_b32 v161, v135
    ds_write_b128 v138, v[148:151] offset:1024
    ds_write_b64 v139, v[160:161] offset:3072
    ds_write_b128 v138, v[152:155] offset:2048
    ds_write_b128 v138, v[144:147]
    ds_write_b32 v126, v127
    s_cmp_eq_u32 s3, 4
    s_cbranch_scc1 P1_X
    v_mov_b32 v127, 1
Q_S:
    ds_read_b32 v124, v125
    s_sub_i32 s9, s9, 1
    s_cmp_lt_i32 s9, 0
    s_cbranch_scc1 Q_G
    s_waitcnt lgkmcnt(0)
    v_cmp_gt_i32 vcc, s15, v124
    s_cbranch_vccnz Q_S
Q_G:
    ds_read_b128 v[208:211], v116 offset:0
    ds_read_b64_tr_b16 v[168:169], v112 offset:0
    ds_read_b64_tr_b16 v[170:171], v112 offset:1280
    ds_read_b64_tr_b16 v[172:173], v112 offset:32
    ds_read_b64_tr_b16 v[174:175], v112 offset:1312
    ds_read_b64_tr_b16 v[176:177], v113 offset:0
    ds_read_b64_tr_b16 v[178:179], v113 offset:1280
    ds_read_b64_tr_b16 v[180:181], v114 offset:0
    ds_read_b64_tr_b16 v[182:183], v114 offset:1280
    ds_read_b64_tr_b16 v[184:185], v115 offset:0
    ds_read_b64_tr_b16 v[186:187], v115 offset:1280
    s_branch Q_H
Q_S0:
    ds_read_b32 v124, v125
    s_sub_i32 s9, s9, 1
    s_cmp_lt_i32 s9, 0
    s_cbranch_scc1 Q_G0
    s_waitcnt lgkmcnt(0)
    v_cmp_gt_i32 vcc, s15, v124
    s_cbranch_vccnz Q_S0
    s_branch Q_G0
Q_S1:
    ds_read_b32 v124, v125
    s_sub_i32 s9, s9, 1
    s_cmp_lt_i32 s9, 0
    s_cbranch_scc1 Q_G1
    s_waitcnt lgkmcnt(0)
    v_cmp_gt_i32 vcc, s15, v124
    s_cbranch_vccnz Q_S1
    s_branch Q_G1
Q_S2:
    ds_read_b32 v124, v125
    s_sub_i32 s9, s9, 1
    s_cmp_lt_i32 s9, 0
    s_cbranch_scc1 Q_G2
    s_waitcnt lgkmcnt(0)
    v_cmp_gt_i32 vcc, s15, v124
    s_cbranch_vccnz Q_S2
    s_branch Q_G2
Q_S3:
    ds_read_b32 v124, v125
    s_sub_i32 s9, s9, 1
    s_cmp_lt_i32 s9, 0
    s_cbranch_scc1 Q_G3
    s_waitcnt lgkmcnt(0)
    v_cmp_gt_i32 vcc, s15, v124
    s_cbranch_vccnz Q_S3
    s_branch Q_G3
Q_S4:
    ds_read_b32 v124, v125
    s_sub_i32 s9, s9, 1
    s_cmp_lt_i32 s9, 0
    s_cbranch_scc1 Q_G4
    s_waitcnt lgkmcnt(0)
    v_cmp_gt_i32 vcc, s15, v124
    s_cbranch_vccnz Q_S4
    s_branch Q_G4
Q_L:
    v_cmp_gt_i32 vcc, s15, v124
    s_cbranch_vccnz Q_S0
Q_G0:
    v_mfma_f32_16x16x32_bf16 v[108:111], v[212:215], v[212:215], v[108:111]
    ds_read_b128 v[208:211], v116 offset:0
    v_mfma_f32_16x16x32_bf16 v[104:107], v[140:143], v[212:215], v[104:107]
    ds_read_b64_tr_b16 v[168:169], v112 offset:0
    ds_read_b64_tr_b16 v[170:171], v112 offset:1280
    v_mfma_f32_16x16x32_bf16 v[36:39], v[188:191], v[140:143], v[36:39]
    ds_read_b64_tr_b16 v[172:173], v112 offset:32
    ds_read_b64_tr_b16 v[174:175], v112 offset:1312
    v_mfma_f32_16x16x32_bf16 v[16:19], v[188:191], v[212:215], v[16:19]
    ds_read_b64_tr_b16 v[176:177], v113 offset:0
    ds_read_b64_tr_b16 v[178:179], v113 offset:1280
    v_mfma_f32_16x16x32_bf16 v[40:43], v[192:195], v[140:143], v[40:43]
    ds_read_b64_tr_b16 v[180:181], v114 offset:0
    ds_read_b64_tr_b16 v[182:183], v114 offset:1280
    v_mfma_f32_16x16x32_bf16 v[20:23], v[192:195], v[212:215], v[20:23]
    ds_read_b64_tr_b16 v[184:185], v115 offset:0
    ds_read_b64_tr_b16 v[186:187], v115 offset:1280
    s_waitcnt lgkmcnt(11)
    v_mfma_f32_16x16x32_bf16 v[24:27], v[196:199], v[212:215], v[24:27]
    ds_add_u32 v126, v127 offset:24
    v_mfma_f32_16x16x32_bf16 v[28:31], v[200:203], v[212:215], v[28:31]
    v_mfma_f32_16x16x32_bf16 v[32:35], v[204:207], v[212:215], v[32:35]
Q_H:
    s_waitcnt lgkmcnt(6)
    v_mfma_f32_16x16x32_bf16 v[108:111], v[208:211], v[208:211], v[108:111]
    ds_read_b128 v[212:215], v117 offset:0
    v_mfma_f32_16x16x32_bf16 v[104:107], v[140:143], v[208:211], v[104:107]
    ds_read_b64_tr_b16 v[188:189], v112 offset:5120
WST4096:
WARMA0:
    s_cbranch_execz WST6144
    ds_read_b64_tr_b16 v[190:191], v112 offset:6400
    v_mfma_f32_16x16x32_bf16 v[36:39], v[168:171], v[140:143], v[36:39]
    ds_read_b64_tr_b16 v[192:193], v112 offset:5152
    ds_read_b64_tr_b16 v[194:195], v112 offset:6432
    ds_read_b32 v124, v125
    v_mfma_f32_16x16x32_bf16 v[16:19], v[168:171], v[208:211], v[16:19]
    ds_read_b64_tr_b16 v[196:197], v113 offset:5120
    ds_read_b64_tr_b16 v[198:199], v113 offset:6400
    v_mfma_f32_16x16x32_bf16 v[40:43], v[172:175], v[140:143], v[40:43]
    ds_read_b64_tr_b16 v[200:201], v114 offset:5120
    ds_read_b64_tr_b16 v[202:203], v114 offset:6400
    v_mfma_f32_16x16x32_bf16 v[20:23], v[172:175], v[208:211], v[20:23]
    ds_read_b64_tr_b16 v[204:205], v115 offset:5120
    ds_read_b64_tr_b16 v[206:207], v115 offset:6400
    s_waitcnt lgkmcnt(12)
    v_mfma_f32_16x16x32_bf16 v[24:27], v[176:179], v[208:211], v[24:27]
    s_add_u32 s15, s15, 1
    v_mfma_f32_16x16x32_bf16 v[28:31], v[180:183], v[208:211], v[28:31]
    v_mfma_f32_16x16x32_bf16 v[32:35], v[184:187], v[208:211], v[32:35]
    s_waitcnt lgkmcnt(6)
    v_cmp_gt_i32 vcc, s15, v124
    s_cbranch_vccnz Q_S1
Q_G1:
    v_mfma_f32_16x16x32_bf16 v[108:111], v[212:215], v[212:215], v[108:111]
    ds_read_b128 v[208:211], v116 offset:8192
    v_mfma_f32_16x16x32_bf16 v[104:107], v[140:143], v[212:215], v[104:107]
    ds_read_b64_tr_b16 v[168:169], v112 offset:10240
    ds_read_b64_tr_b16 v[170:171], v112 offset:11520
    v_mfma_f32_16x16x32_bf16 v[36:39], v[188:191], v[140:143], v[36:39]
    ds_read_b64_tr_b16 v[172:173], v112 offset:10272
    ds_read_b64_tr_b16 v[174:175], v112 offset:11552
    v_mfma_f32_16x16x32_bf16 v[16:19], v[188:191], v[212:215], v[16:19]
    ds_read_b64_tr_b16 v[176:177], v113 offset:10240
    ds_read_b64_tr_b16 v[178:179], v113 offset:11520
    v_mfma_f32_16x16x32_bf16 v[40:43], v[192:195], v[140:143], v[40:43]
    ds_read_b64_tr_b16 v[180:181], v114 offset:10240
    ds_read_b64_tr_b16 v[182:183], v114 offset:11520
    v_mfma_f32_16x16x32_bf16 v[20:23], v[192:195], v[212:215], v[20:23]
    ds_read_b64_tr_b16 v[184:185], v115 offset:10240
    ds_read_b64_tr_b16 v[186:187], v115 offset:11520
    s_waitcnt lgkmcnt(11)
    v_mfma_f32_16x16x32_bf16 v[24:27], v[196:199], v[212:215], v[24:27]
    ds_add_u32 v126, v127 offset:24
    v_mfma_f32_16x16x32_bf16 v[28:31], v[200:203], v[212:215], v[28:31]
    v_mfma_f32_16x16x32_bf16 v[32:35], v[204:207], v[212:215], v[32:35]
    s_waitcnt lgkmcnt(6)
    v_mfma_f32_16x16x32_bf16 v[108:111], v[208:211], v[208:211], v[108:111]
    ds_read_b128 v[212:215], v117 offset:8192
    v_mfma_f32_16x16x32_bf16 v[104:107], v[140:143], v[208:211], v[104:107]
    ds_read_b64_tr_b16 v[188:189], v112 offset:15360
    ds_read_b64_tr_b16 v[190:191], v112 offset:16640
    v_mfma_f32_16x16x32_bf16 v[36:39], v[168:171], v[140:143], v[36:39]
    ds_read_b64_tr_b16 v[192:193], v112 offset:15392
    ds_read_b64_tr_b16 v[194:195], v112 offset:16672
    ds_read_b32 v124, v125
    v_mfma_f32_16x16x32_bf16 v[16:19], v[168:171], v[208:211], v[16:19]
    ds_read_b64_tr_b16 v[196:197], v113 offset:15360
    ds_read_b64_tr_b16 v[198:199], v113 offset:16640
    v_mfma_f32_16x16x32_bf16 v[40:43], v[172:175], v[140:143], v[40:43]
    ds_read_b64_tr_b16 v[200:201], v114 offset:15360
    ds_read_b64_tr_b16 v[202:203], v114 offset:16640
    v_mfma_f32_16x16x32_bf16 v[20:23], v[172:175], v[208:211], v[20:23]
    ds_read_b64_tr_b16 v[204:205], v115 offset:15360
    ds_read_b64_tr_b16 v[206:207], v115 offset:16640
    s_waitcnt lgkmcnt(12)
    v_mfma_f32_16x16x32_bf16 v[24:27], v[176:179], v[208:211], v[24:27]
    s_add_u32 s15, s15, 1
    v_mfma_f32_16x16x32_bf16 v[28:31], v[180:183], v[208:211], v[28:31]
    v_mfma_f32_16x16x32_bf16 v[32:35], v[184:187], v[208:211], v[32:35]
    s_waitcnt lgkmcnt(6)
    v_cmp_gt_i32 vcc, s15, v124
    s_cbranch_vccnz Q_S2
Q_G2:
    v_mfma_f32_16x16x32_bf16 v[108:111], v[212:215], v[212:215], v[108:111]
    ds_read_b128 v[208:211], v116 offset:16384
    v_mfma_f32_16x16x32_bf16 v[104:107], v[140:143], v[212:215], v[104:107]
    ds_read_b64_tr_b16 v[168:169], v112 offset:20480
    ds_read_b64_tr_b16 v[170:171], v112 offset:21760
    v_mfma_f32_16x16x32_bf16 v[36:39], v[188:191], v[140:143], v[36:39]
    ds_read_b64_tr_b16 v[172:173], v112 offset:20512
    ds_read_b64_tr_b16 v[174:175], v112 offset:21792
    v_mfma_f32_16x16x32_bf16 v[16:19], v[188:191], v[212:215], v[16:19]
    ds_read_b64_tr_b16 v[176:177], v113 offset:20480
    ds_read_b64_tr_b16 v[178:179], v113 offset:21760
    v_mfma_f32_16x16x32_bf16 v[40:43], v[192:195], v[140:143], v[40:43]
    ds_read_b64_tr_b16 v[180:181], v114 offset:20480
    ds_read_b64_tr_b16 v[182:183], v114 offset:21760
    v_mfma_f32_16x16x32_bf16 v[20:23], v[192:195], v[212:215], v[20:23]
    ds_read_b64_tr_b16 v[184:185], v115 offset:20480
    ds_read_b64_tr_b16 v[186:187], v115 offset:21760
    s_waitcnt lgkmcnt(11)
    v_mfma_f32_16x16x32_bf16 v[24:27], v[196:199], v[212:215], v[24:27]
    ds_add_u32 v126, v127 offset:24
    v_mfma_f32_16x16x32_bf16 v[28:31], v[200:203], v[212:215], v[28:31]
    v_mfma_f32_16x16x32_bf16 v[32:35], v[204:207], v[212:215], v[32:35]
    s_waitcnt lgkmcnt(6)
    v_mfma_f32_16x16x32_bf16 v[108:111], v[208:211], v[208:211], v[108:111]
    ds_read_b128 v[212:215], v117 offset:16384
    v_mfma_f32_16x16x32_bf16 v[104:107], v[140:143], v[208:211], v[104:107]
    ds_read_b64_tr_b16 v[188:189], v112 offset:25600
    ds_read_b64_tr_b16 v[190:191], v112 offset:26880
    v_mfma_f32_16x16x32_bf16 v[36:39], v[168:171], v[140:143], v[36:39]
    ds_read_b64_tr_b16 v[192:193], v112 offset:25632
    ds_read_b64_tr_b16 v[194:195], v112 offset:26912
    ds_read_b32 v124, v125
    v_mfma_f32_16x16x32_bf16 v[16:19], v[168:171], v[208:211], v[16:19]
    ds_read_b64_tr_b16 v[196:197], v113 offset:25600
    ds_read_b64_tr_b16 v[198:199], v113 offset:26880
    v_mfma_f32_16x16x32_bf16 v[40:43], v[172:175], v[140:143], v[40:43]
    ds_read_b64_tr_b16 v[200:201], v114 offset:25600
    ds_read_b64_tr_b16 v[202:203], v114 offset:26880
    v_mfma_f32_16x16x32_bf16 v[20:23], v[172:175], v[208:211], v[20:23]
    ds_read_b64_tr_b16 v[204:205], v115 offset:25600
    ds_read_b64_tr_b16 v[206:207], v115 offset:26880
    s_waitcnt lgkmcnt(12)
    v_mfma_f32_16x16x32_bf16 v[24:27], v[176:179], v[208:211], v[24:27]
    s_add_u32 s15, s15, 1
    v_mfma_f32_16x16x32_bf16 v[28:31], v[180:183], v[208:211], v[28:31]
    v_mfma_f32_16x16x32_bf16 v[32:35], v[184:187], v[208:211], v[32:35]
    s_waitcnt lgkmcnt(6)
    v_cmp_gt_i32 vcc, s15, v124
    s_cbranch_vccnz Q_S3
Q_G3:
    v_mfma_f32_16x16x32_bf16 v[108:111], v[212:215], v[212:215], v[108:111]
    ds_read_b128 v[208:211], v116 offset:24576
    v_mfma_f32_16x16x32_bf16 v[104:107], v[140:143], v[212:215], v[104:107]
    ds_read_b64_tr_b16 v[168:169], v112 offset:30720
    ds_read_b64_tr_b16 v[170:171], v112 offset:32000
    v_mfma_f32_16x16x32_bf16 v[36:39], v[188:191], v[140:143], v[36:39]
    ds_read_b64_tr_b16 v[172:173], v112 offset:30752
    ds_read_b64_tr_b16 v[174:175], v112 offset:32032
    v_mfma_f32_16x16x32_bf16 v[16:19], v[188:191], v[212:215], v[16:19]
    ds_read_b64_tr_b16 v[176:177], v113 offset:30720
    ds_read_b64_tr_b16 v[178:179], v113 offset:32000
    v_mfma_f32_16x16x32_bf16 v[40:43], v[192:195], v[140:143], v[40:43]
    ds_read_b64_tr_b16 v[180:181], v114 offset:30720
    ds_read_b64_tr_b16 v[182:183], v114 offset:32000
    v_mfma_f32_16x16x32_bf16 v[20:23], v[192:195], v[212:215], v[20:23]
    ds_read_b64_tr_b16 v[184:185], v115 offset:30720
    ds_read_b64_tr_b16 v[186:187], v115 offset:32000
WST5120:
WARMA1:
    s_cbranch_execz WST7168
    s_waitcnt lgkmcnt(11)
    v_mfma_f32_16x16x32_bf16 v[24:27], v[196:199], v[212:215], v[24:27]
    ds_add_u32 v126, v127 offset:24
    v_mfma_f32_16x16x32_bf16 v[28:31], v[200:203], v[212:215], v[28:31]
    v_mfma_f32_16x16x32_bf16 v[32:35], v[204:207], v[212:215], v[32:35]
    s_waitcnt lgkmcnt(6)
    v_mfma_f32_16x16x32_bf16 v[108:111], v[208:211], v[208:211], v[108:111]
    ds_read_b128 v[212:215], v117 offset:24576
    v_mfma_f32_16x16x32_bf16 v[104:107], v[140:143], v[208:211], v[104:107]
    ds_read_b64_tr_b16 v[188:189], v112 offset:35840
    ds_read_b64_tr_b16 v[190:191], v112 offset:37120
    v_mfma_f32_16x16x32_bf16 v[36:39], v[168:171], v[140:143], v[36:39]
    ds_read_b64_tr_b16 v[192:193], v112 offset:35872
    ds_read_b64_tr_b16 v[194:195], v112 offset:37152
    ds_read_b32 v124, v125
    v_mfma_f32_16x16x32_bf16 v[16:19], v[168:171], v[208:211], v[16:19]
    ds_read_b64_tr_b16 v[196:197], v113 offset:35840
    ds_read_b64_tr_b16 v[198:199], v113 offset:37120
    v_mfma_f32_16x16x32_bf16 v[40:43], v[172:175], v[140:143], v[40:43]
    ds_read_b64_tr_b16 v[200:201], v114 offset:35840
    ds_read_b64_tr_b16 v[202:203], v114 offset:37120
    v_mfma_f32_16x16x32_bf16 v[20:23], v[172:175], v[208:211], v[20:23]
    ds_read_b64_tr_b16 v[204:205], v115 offset:35840
    ds_read_b64_tr_b16 v[206:207], v115 offset:37120
    s_waitcnt lgkmcnt(12)
    v_mfma_f32_16x16x32_bf16 v[24:27], v[176:179], v[208:211], v[24:27]
    s_add_u32 s15, s15, 1
    v_mfma_f32_16x16x32_bf16 v[28:31], v[180:183], v[208:211], v[28:31]
    v_mfma_f32_16x16x32_bf16 v[32:35], v[184:187], v[208:211], v[32:35]
    s_waitcnt lgkmcnt(6)
    v_cmp_gt_i32 vcc, s15, v124
    s_cbranch_vccnz Q_S4
Q_G4:
    v_mfma_f32_16x16x32_bf16 v[108:111], v[212:215], v[212:215], v[108:111]
    ds_read_b128 v[208:211], v116 offset:32768
    v_mfma_f32_16x16x32_bf16 v[104:107], v[140:143], v[212:215], v[104:107]
    ds_read_b64_tr_b16 v[168:169], v112 offset:40960
    ds_read_b64_tr_b16 v[170:171], v112 offset:42240
    v_mfma_f32_16x16x32_bf16 v[36:39], v[188:191], v[140:143], v[36:39]
    ds_read_b64_tr_b16 v[172:173], v112 offset:40992
    ds_read_b64_tr_b16 v[174:175], v112 offset:42272
    v_mfma_f32_16x16x32_bf16 v[16:19], v[188:191], v[212:215], v[16:19]
    ds_read_b64_tr_b16 v[176:177], v113 offset:40960
    ds_read_b64_tr_b16 v[178:179], v113 offset:42240
    v_mfma_f32_16x16x32_bf16 v[40:43], v[192:195], v[140:143], v[40:43]
    ds_read_b64_tr_b16 v[180:181], v114 offset:40960
    ds_read_b64_tr_b16 v[182:183], v114 offset:42240
    v_mfma_f32_16x16x32_bf16 v[20:23], v[192:195], v[212:215], v[20:23]
    ds_read_b64_tr_b16 v[184:185], v115 offset:40960
    ds_read_b64_tr_b16 v[186:187], v115 offset:42240
    s_waitcnt lgkmcnt(11)
    v_mfma_f32_16x16x32_bf16 v[24:27], v[196:199], v[212:215], v[24:27]
    ds_add_u32 v126, v127 offset:24
    v_mfma_f32_16x16x32_bf16 v[28:31], v[200:203], v[212:215], v[28:31]
    v_mfma_f32_16x16x32_bf16 v[32:35], v[204:207], v[212:215], v[32:35]
    s_waitcnt lgkmcnt(6)
    v_mfma_f32_16x16x32_bf16 v[108:111], v[208:211], v[208:211], v[108:111]
    ds_read_b128 v[212:215], v117 offset:32768
    v_mfma_f32_16x16x32_bf16 v[104:107], v[140:143], v[208:211], v[104:107]
    ds_read_b64_tr_b16 v[188:189], v112 offset:46080
    ds_read_b64_tr_b16 v[190:191], v112 offset:47360
    v_mfma_f32_16x16x32_bf16 v[36:39], v[168:171], v[140:143], v[36:39]
    ds_read_b64_tr_b16 v[192:193], v112 offset:46112
    ds_read_b64_tr_b16 v[194:195], v112 offset:47392
    ds_read_b32 v124, v125
    v_mfma_f32_16x16x32_bf16 v[16:19], v[168:171], v[208:211], v[16:19]
    ds_read_b64_tr_b16 v[196:197], v113 offset:46080
    ds_read_b64_tr_b16 v[198:199], v113 offset:47360
    v_mfma_f32_16x16x32_bf16 v[40:43], v[172:175], v[140:143], v[40:43]
    ds_read_b64_tr_b16 v[200:201], v114 offset:46080
    ds_read_b64_tr_b16 v[202:203], v114 offset:47360
    v_mfma_f32_16x16x32_bf16 v[20:23], v[172:175], v[208:211], v[20:23]
    ds_read_b64_tr_b16 v[204:205], v115 offset:46080
    ds_read_b64_tr_b16 v[206:207], v115 offset:47360
    s_waitcnt lgkmcnt(12)
    v_mfma_f32_16x16x32_bf16 v[24:27], v[176:179], v[208:211], v[24:27]
    s_add_u32 s15, s15, 1
    v_mfma_f32_16x16x32_bf16 v[28:31], v[180:183], v[208:211], v[28:31]
    v_add_u32 v116, 40960, v116
    v_add_u32 v117, 40960, v117
    v_mfma_f32_16x16x32_bf16 v[32:35], v[184:187], v[208:211], v[32:35]
    s_cmp_lt_u32 s15, 10
    s_waitcnt lgkmcnt(6)
    s_cbranch_scc1 Q_L
    v_mfma_f32_16x16x32_bf16 v[108:111], v[212:215], v[212:215], v[108:111]
    s_mov_b32 s10, 0x3acccccd
    v_mfma_f32_16x16x32_bf16 v[104:107], v[140:143], v[212:215], v[104:107]
    v_mfma_f32_16x16x32_bf16 v[36:39], v[188:191], v[140:143], v[36:39]
    v_mfma_f32_16x16x32_bf16 v[16:19], v[188:191], v[212:215], v[16:19]
    v_mfma_f32_16x16x32_bf16 v[40:43], v[192:195], v[140:143], v[40:43]
    s_nop 4
    v_cndmask_b32 v105, 0, v108, s[28:29]
    v_cndmask_b32 v105, v105, v109, s[30:31]
    v_mfma_f32_16x16x32_bf16 v[20:23], v[192:195], v[212:215], v[20:23]
    v_cndmask_b32 v105, v105, v110, s[32:33]
    v_cndmask_b32 v105, v105, v111, s[34:35]
    s_waitcnt lgkmcnt(0)
    v_mfma_f32_16x16x32_bf16 v[24:27], v[196:199], v[212:215], v[24:27]
    v_mul_f32 v104, s10, v104
    v_mul_f32 v105, s10, v105
    ds_write_b128 v118, v[16:19] offset:0
    v_mfma_f32_16x16x32_bf16 v[28:31], v[200:203], v[212:215], v[28:31]
    v_fma_f32 v105, -v104, v104, v105
    v_max_f32 v105, 0, v105
    v_mfma_f32_16x16x32_bf16 v[32:35], v[204:207], v[212:215], v[32:35]
    ds_write_b128 v118, v[20:23] offset:64
    v_add_f32 v105, 0x3727c5ac, v105
    v_rsq_f32 v105, v105
    ds_write_b128 v119, v[24:27] offset:0
    v_mul_f32 v105, 0x3ea52b5c, v105
    ds_write_b128 v123, v[36:39] offset:0
    ds_write_b128 v123, v[40:43] offset:64
    ds_write_b128 v120, v[28:31] offset:0
    ds_write_b64 v122, v[104:105]
    ds_write_b128 v121, v[32:35] offset:0
    s_branch P1_END
P1_X:
    s_load_dword s28, s[68:69], s79
    s_add_u32 s10, s79, 327680
    s_load_dword s29, s[68:69], s10
    s_mov_b32 s10, 18874368
    s_load_dword s30, s[68:69], s10
    s_mov_b32 s10, 20971520
    s_load_dword s31, s[68:69], s10
    s_mul_i32 s10, s6, 81920
    s_load_dword s32, s[60:61], s10
    s_load_dword s33, s[24:25], 0
    s_load_dword s34, s[52:53], 0
    s_load_dword s35, s[56:57], 0
    s_add_u32 s10, s5, 1
    s_lshr_b32 s10, s10, 3
    s_mov_b64 exec, 0
    s_cmp_eq_u32 s10, 1
    s_cbranch_scc1 WARMB1
    s_branch WARMB0
WRETB:
    s_mov_b64 exec, -1
    s_branch P1_END
P1_KV:
    v_mov_b32 v26, 0
    s_lshr_b32 s82, s5, 1
    s_and_b32 s83, s82, 1
    s_lshl_b32 s81, s6, 1
    s_lshr_b32 s11, s82, 1
    s_add_u32 s81, s81, s11
    v_mov_b32 v44, 0x40000000
    v_lshrrev_b32 v45, 1, v131
    v_and_b32 v46, 1, v131
    v_cmp_eq_u32 s[22:23], 1, v46
    s_bitcmp1_b32 s5, 0
    s_cbranch_scc1 KV_AV
    s_add_u32 s12, s81, 62
WST6144:
    s_cbranch_execz WRETA
    s_lshl_b32 s11, s83, 8
    v_lshl_add_u32 v18, v132, 4, s11
    v_add_u32 v47, 2560, v18
    v_lshl_add_u32 v18, v45, 9, v18
    v_cndmask_b32 v18, v18, v47, s[22:23]
    v_cmp_eq_u32 vcc, 3, v131
    s_branch KV_AJ
KV_AV:
    s_add_u32 s12, s81, 63
    s_add_u32 s12, s12, s83
    v_and_b32 v18, 31, v1
    v_mul_u32_u24 v47, 384, v45
    v_lshl_add_u32 v18, v18, 4, v47
    s_mul_i32 s13, s83, 768
    s_add_u32 s13, s13, 1024
    v_add_u32 v18, s13, v18
    v_mul_u32_u24 v19, 80, v132
    v_lshl_add_u32 v19, v131, 3, v19
    v_add_u32 v19, 134144, v19
    v_lshl_add_u32 v20, v45, 3, v133
    v_mul_u32_u24 v20, 80, v20
    v_lshl_add_u32 v20, v46, 5, v20
    v_lshl_add_u32 v20, v134, 3, v20
    v_add_u32 v20, 134144, v20
    v_and_b32 v47, 24, v1
    v_cmp_eq_u32 vcc, 24, v47
KV_AJ:
    s_nop 1
    v_cndmask_b32 v18, v18, v44, vcc
    s_barrier
    buffer_load_dword v22, v26, s[64:67], 0 offen sc1
    s_bfe_u32 s13, s12, 0x30003
    s_and_b32 s12, s12, 7
    s_lshl_b32 s13, s13, 15
    s_mul_i32 s12, s12, 3072
    s_add_u32 s12, s12, s13
    s_add_u32 s12, s12, 524288
    s_mov_b32 s11, 137984
    v_add_u32 v45, s11, v15
    v_lshl_add_u32 v46, v1, 3, s11
    v_min_u32 v21, 4, v1
    v_lshlrev_b32 v21, 2, v21
    v_add_u32 v21, 133960, v21
    s_setprio 3
KV_S:
    ds_read_b32 v24, v21
    s_sub_i32 s9, s9, 1
    s_cmp_lt_i32 s9, 0
    s_cbranch_scc1 KV_SG
    s_waitcnt lgkmcnt(0)
    v_cmp_gt_i32 vcc, 1, v24
    s_cbranch_vccnz KV_S
KV_SG:
    ds_read_b64 v[32:33], v46 offset:3072
    ds_read_b64 v[34:35], v46 offset:8192
    ds_read_b64 v[36:37], v46 offset:13312
    ds_read_b64 v[38:39], v46 offset:18432
    ds_read_b64 v[40:41], v46 offset:23552
    ds_read_b128 v[144:147], v45 offset:0
    ds_read_b128 v[148:151], v45 offset:1024
    ds_read_b128 v[152:155], v45 offset:2048
    ds_read_b128 v[160:163], v45 offset:5120
    ds_read_b128 v[164:167], v45 offset:6144
    ds_read_b128 v[168:171], v45 offset:7168
    ds_read_b128 v[176:179], v45 offset:10240
    ds_read_b128 v[180:183], v45 offset:11264
    ds_read_b128 v[184:187], v45 offset:12288
    ds_read_b128 v[192:195], v45 offset:15360
    s_waitcnt lgkmcnt(10)
    v_add_f32 v32, v32, v34
    v_add_f32 v33, v33, v35
    v_add_f32 v36, v36, v38
    v_add_f32 v37, v37, v39
    v_add_f32 v32, v32, v40
    v_add_f32 v33, v33, v41
    v_add_f32 v32, v32, v36
    v_add_f32 v33, v33, v37
    ds_read_b128 v[196:199], v45 offset:16384
    ds_read_b128 v[200:203], v45 offset:17408
    ds_read_b128 v[208:211], v45 offset:20480
    ds_read_b128 v[212:215], v45 offset:21504
    ds_read_b128 v[216:219], v45 offset:22528
    v_mov_b32 v24, v33
    v_mul_f32 v44, 0x3acccccd, v32
    s_nop 0
    v_permlane16_swap_b32 v24, v33
    v_add_f32 v24, v24, v33
    v_mov_b32 v25, v24
    s_waitcnt lgkmcnt(9)
    v_add_f32 v144, v144, v160
    v_add_f32 v145, v145, v161
    v_add_f32 v146, v146, v162
    v_add_f32 v147, v147, v163
    v_add_f32 v148, v148, v164
    v_add_f32 v149, v149, v165
    v_add_f32 v150, v150, v166
    v_add_f32 v151, v151, v167
    v_add_f32 v152, v152, v168
    v_add_f32 v153, v153, v169
    v_add_f32 v154, v154, v170
    v_add_f32 v155, v155, v171
    v_permlane32_swap_b32 v24, v25
    v_add_f32 v24, v24, v25
    v_mul_f32 v24, 0x3acccccd, v24
    v_fma_f32 v24, -v44, v44, v24
    v_max_f32 v24, 0, v24
    v_add_f32 v24, 0x3727c5ac, v24
    v_rsq_f32 v24, v24
    s_waitcnt lgkmcnt(6)
    v_add_f32 v144, v144, v176
    v_add_f32 v145, v145, v177
    v_add_f32 v146, v146, v178
    v_add_f32 v147, v147, v179
    v_add_f32 v148, v148, v180
    v_add_f32 v149, v149, v181
    v_add_f32 v150, v150, v182
    v_add_f32 v151, v151, v183
    v_add_f32 v152, v152, v184
    v_add_f32 v153, v153, v185
    v_add_f32 v154, v154, v186
    v_add_f32 v155, v155, v187
    s_waitcnt lgkmcnt(3)
    v_add_f32 v144, v144, v192
    v_add_f32 v145, v145, v193
    v_add_f32 v146, v146, v194
    v_add_f32 v147, v147, v195
    v_add_f32 v148, v148, v196
    v_add_f32 v149, v149, v197
    v_add_f32 v150, v150, v198
    v_add_f32 v151, v151, v199
    v_add_f32 v152, v152, v200
    v_add_f32 v153, v153, v201
    v_add_f32 v154, v154, v202
    v_add_f32 v155, v155, v203
    s_waitcnt lgkmcnt(0)
    v_add_f32 v144, v144, v208
    v_add_f32 v145, v145, v209
    v_add_f32 v146, v146, v210
    v_add_f32 v147, v147, v211
    v_add_f32 v148, v148, v212
    v_add_f32 v149, v149, v213
    v_add_f32 v150, v150, v214
    v_add_f32 v151, v151, v215
    v_add_f32 v152, v152, v216
    v_add_f32 v153, v153, v217
    v_add_f32 v154, v154, v218
    v_add_f32 v155, v155, v219
    v_permlane16_swap_b32 v148, v156
    v_permlane16_swap_b32 v149, v157
    v_permlane16_swap_b32 v150, v158
    v_permlane16_swap_b32 v151, v159
    v_fma_f32 v144, -v44, v152, v144
    v_fma_f32 v145, -v44, v153, v145
    v_fma_f32 v146, -v44, v154, v146
    v_fma_f32 v147, -v44, v155, v147
    v_fma_f32 v148, -v44, v156, v148
    v_fma_f32 v149, -v44, v157, v149
    v_fma_f32 v150, -v44, v158, v150
    v_fma_f32 v151, -v44, v159, v151
    v_mul_f32 v144, v144, v24
    v_mul_f32 v145, v145, v24
    v_cvt_pk_bf16_f32 v28, v144, v145
    v_mul_f32 v146, v146, v24
    v_mul_f32 v147, v147, v24
    v_cvt_pk_bf16_f32 v29, v146, v147
    v_mul_f32 v148, v148, v24
    v_mul_f32 v149, v149, v24
    v_cvt_pk_bf16_f32 v30, v148, v149
    v_mul_f32 v150, v150, v24
    v_mul_f32 v151, v151, v24
    v_cvt_pk_bf16_f32 v31, v150, v151
    s_bitcmp1_b32 s5, 0
    s_cbranch_scc1 KV_SV
    v_permlane16_swap_b32 v28, v30
    v_permlane16_swap_b32 v29, v31
    s_branch KV_ST
KV_SV:
    ds_write_b64 v19, v[28:29]
    v_cndmask_b32 v30, v30, v140, s[22:23]
    v_cndmask_b32 v31, v31, v140, s[22:23]
    ds_write_b64 v19, v[30:31] offset:32
    ds_read_b64_tr_b16 v[28:29], v20
    ds_read_b64_tr_b16 v[30:31], v20 offset:320
    s_waitcnt lgkmcnt(0)
KV_ST:
    buffer_store_dwordx4 v[28:31], v18, s[68:71], s12 offen sc1
    s_lshl3_add_u32 s10, s6, s5
    s_lshl_b32 s10, s10, 4
    s_lshr_b32 s11, s6, 2
    s_lshl_b32 s12, s11, 9
    v_min_u32 v19, 39, v1
    v_lshl_add_u32 v19, v19, 4, s12
    v_and_b32 v19, 4095, v19
WST7168:
    s_cbranch_execz WRETA
    s_waitcnt vmcnt(1)
    v_readfirstlane_b32 s4, v22
    s_cmp_lg_u32 s4, 0
    s_cbranch_scc1 EPOK_1
    v_mov_b32 v23, 0
EPL_2:
    buffer_load_dword v22, v23, s[64:67], 0 offen sc1
    s_waitcnt vmcnt(0)
    v_readfirstlane_b32 s4, v22
    s_cmp_lg_u32 s4, 0
    s_cbranch_scc1 EPOK_1
    s_sub_i32 s9, s9, 1
    s_cmp_gt_i32 s9, 0
    s_cbranch_scc1 EPL_2
EPOK_1:
    v_mov_b32 v23, s8
    v_mov_b32 v21, 133952
    s_mov_b64 exec, 1
    ds_write_b32 v21, v22 offset:64
    s_waitcnt vmcnt(0)
    buffer_store_dwordx2 v[22:23], v15, s[68:71], s10 offen sc1
    s_mov_b64 exec, -1
    s_add_u32 s12, s11, 7
    s_and_b32 s12, s12, 7
    s_lshl_b32 s12, s12, 15
    s_add_u32 s12, s12, 542720
    s_lshl_b32 s11, s11, 15
    s_add_u32 s11, s11, 524288
    s_mov_b32 m0, 134144
    s_waitcnt vmcnt(0)
KV_P:
    ds_read_b32 v24, v21
    s_sub_i32 s9, s9, 1
    s_cmp_lt_i32 s9, 0
    s_cbranch_scc1 KV_PG
    s_waitcnt lgkmcnt(0)
    v_cmp_gt_i32 vcc, 8, v24
    s_cbranch_vccnz KV_P
KV_PG:
POLL_3:
    buffer_load_dword v24, v19, s[68:71], 0 offen sc1
    s_waitcnt vmcnt(0)
    v_cmp_ne_u32 vcc, s4, v24
    s_cbranch_vccz POLLD_4
    s_sleep 1
    s_sub_i32 s9, s9, 1
    s_cmp_gt_i32 s9, 0
    s_cbranch_scc1 POLL_3
POLLD_4:
    buffer_load_dword v28, v15, s[68:71], 0 offen sc1
    buffer_load_dword v29, v15, s[68:71], 0 offen offset:1024 sc1
    buffer_load_dword v30, v15, s[68:71], 0 offen offset:2048 sc1
    buffer_load_dword v31, v15, s[68:71], 0 offen offset:3072 sc1
    buffer_load_dwordx4 v15, s[68:71], s12 offen offset:0 sc1 lds
    s_mov_b32 m0, 135168
    s_add_u32 s12, s12, 2048
    buffer_load_dwordx4 v15, s[68:71], s12 offen offset:0 sc1 lds
    buffer_load_dwordx4 v15, s[68:71], s12 offen offset:1024 sc1 lds
    buffer_load_dwordx4 v15, s[68:71], s12 offen offset:2048 sc1 lds
    buffer_load_dwordx4 v15, s[68:71], s12 offen offset:3072 sc1 lds
    s_mov_b32 m0, 139264
KV_F:
    s_nop 0
    buffer_load_dwordx4 v15, s[68:71], s11 offen offset:0 sc1 lds
    buffer_load_dwordx4 v15, s[68:71], s11 offen offset:1024 sc1 lds
    buffer_load_dwordx4 v15, s[68:71], s11 offen offset:2048 sc1 lds
    buffer_load_dwordx4 v15, s[68:71], s11 offen offset:3072 sc1 lds
    s_add_u32 m0, m0, 4096
    s_add_u32 s11, s11, 4096
    s_cmp_lt_u32 m0, 163840
    s_cbranch_scc1 KV_F
    s_mul_i32 s11, s6, 7
    s_add_u32 s11, s11, s5
    s_mul_i32 s11, s11, 10240
    s_mov_b32 exec_hi, 0xff
    buffer_load_dwordx2 v[254:255], v10, s[52:55], s11 offen offset:124 sc1
    buffer_load_dwordx2 v[254:255], v10, s[56:59], s11 offen offset:124 sc1
    s_mov_b32 exec_hi, -1
    s_waitcnt vmcnt(14)
    v_xor_b32 v28, s4, v28
    v_xor_b32 v29, s4, v29
    v_xor_b32 v30, s4, v30
    v_xor_b32 v31, s4, v31
    v_or3_b32 v28, v28, v29, v30
    v_or_b32 v28, v28, v31
    v_cmp_ne_u32 vcc, 0, v28
    s_cbranch_vccnz KVC
P1_END:
    s_waitcnt lgkmcnt(0)
    s_barrier
    ds_read_b64 v[2:3], v94
    ds_read_b128 v[16:19], v90
    ds_read_b128 v[32:35], v92
    ds_read_b128 v[20:23], v90 offset:16
    ds_read_b128 v[36:39], v92 offset:16
    ds_read_b64 v[24:25], v91 offset:64
    ds_read_b64 v[40:41], v93 offset:64
    ds_read_b128 v[72:75], v85 offset:19456
    ds_read_b32 v70, v86 offset:18432
    ds_read_b32 v8, v95
    ds_read_b128 v[76:79], v87 offset:21504
    s_waitcnt lgkmcnt(8)
    v_pk_fma_f32 v[16:17], v[2:3], v[32:33], v[16:17] op_sel_hi:[0,1,1] neg_lo:[1,0,0] neg_hi:[1,0,0]
    v_pk_fma_f32 v[18:19], v[2:3], v[34:35], v[18:19] op_sel_hi:[0,1,1] neg_lo:[1,0,0] neg_hi:[1,0,0]
    s_waitcnt lgkmcnt(6)
    v_pk_fma_f32 v[20:21], v[2:3], v[36:37], v[20:21] op_sel_hi:[0,1,1] neg_lo:[1,0,0] neg_hi:[1,0,0]
    v_pk_fma_f32 v[22:23], v[2:3], v[38:39], v[22:23] op_sel_hi:[0,1,1] neg_lo:[1,0,0] neg_hi:[1,0,0]
    s_waitcnt lgkmcnt(4)
    v_pk_fma_f32 v[24:25], v[2:3], v[40:41], v[24:25] op_sel_hi:[0,1,1] neg_lo:[1,0,0] neg_hi:[1,0,0]
    v_pk_mul_f32 v[16:17], v[16:17], v[2:3] op_sel:[0,1] op_sel_hi:[1,1]
    v_cvt_pk_bf16_f32 v64, v16, v17
    v_pk_mul_f32 v[18:19], v[18:19], v[2:3] op_sel:[0,1] op_sel_hi:[1,1]
    v_cvt_pk_bf16_f32 v65, v18, v19
    v_pk_mul_f32 v[20:21], v[20:21], v[2:3] op_sel:[0,1] op_sel_hi:[1,1]
    v_cvt_pk_bf16_f32 v66, v20, v21
    v_pk_mul_f32 v[22:23], v[22:23], v[2:3] op_sel:[0,1] op_sel_hi:[1,1]
    v_cvt_pk_bf16_f32 v67, v22, v23
    v_pk_mul_f32 v[24:25], v[24:25], v[2:3] op_sel:[0,1] op_sel_hi:[1,1]
    v_cvt_pk_bf16_f32 v68, v24, v25
    s_waitcnt lgkmcnt(1)
    v_mfma_f32_32x32x16_bf16 v[16:31], v[72:75], v[64:67], 0
    v_mfma_f32_32x32x8_bf16 v[16:31], v[70:71], v[68:69], v[16:31]
    v_readfirstlane_b32 s4, v8
    ds_read_b128 v[72:75], v85 offset:21504
    ds_read_b32 v70, v86 offset:21504
    s_nop 8
    v_max3_f32 v6, v16, v17, v18
    v_max3_f32 v7, v19, v20, v21
    v_max3_f32 v7, v7, v22, v23
    v_max3_f32 v6, v6, v24, v25
    v_max3_f32 v7, v7, v26, v27
    v_max3_f32 v6, v6, v28, v29
    v_max3_f32 v7, v7, v30, v31
    v_max_f32 v6, v6, v7
    v_mov_b32 v7, v6
    s_nop 1
    v_permlane32_swap_b32 v6, v7
    v_max_f32 v6, v6, v7
    v_cvt_pk_bf16_f32 v7, -v6, -v6
    v_lshlrev_b32 v7, 16, v7
    v_sub_f32 v4, -v6, v7
    v_cvt_pk_bf16_f32 v69, -v6, v4
    v_and_b32 v4, 0xffff0000, v69
    v_add_f32 v4, v4, v7
    v_pk_add_f32 v[16:17], v[16:17], v[4:5] op_sel_hi:[1,0]
    v_pk_add_f32 v[18:19], v[18:19], v[4:5] op_sel_hi:[1,0]
    v_pk_add_f32 v[20:21], v[20:21], v[4:5] op_sel_hi:[1,0]
    v_pk_add_f32 v[22:23], v[22:23], v[4:5] op_sel_hi:[1,0]
    v_pk_add_f32 v[24:25], v[24:25], v[4:5] op_sel_hi:[1,0]
    v_pk_add_f32 v[26:27], v[26:27], v[4:5] op_sel_hi:[1,0]
    v_pk_add_f32 v[28:29], v[28:29], v[4:5] op_sel_hi:[1,0]
    v_pk_add_f32 v[30:31], v[30:31], v[4:5] op_sel_hi:[1,0]
    s_setprio 3
    ds_read_b128 v[80:83], v87 offset:25344
    v_exp_f32 v16, v16
    v_exp_f32 v17, v17
    v_exp_f32 v18, v18
    v_exp_f32 v19, v19
    s_waitcnt lgkmcnt(1)
    v_mfma_f32_32x32x16_bf16 v[32:47], v[72:75], v[64:67], 0
    ds_read_b128 v[72:75], v85 offset:24576
    v_exp_f32 v20, v20
    v_exp_f32 v21, v21
    v_exp_f32 v22, v22
    v_exp_f32 v23, v23
    v_mfma_f32_32x32x8_bf16 v[32:47], v[70:71], v[68:69], v[32:47]
    ds_read_b32 v70, v86 offset:24576
    v_exp_f32 v24, v24
    v_exp_f32 v25, v25
    v_exp_f32 v26, v26
    v_exp_f32 v27, v27
    v_smfmac_f32_32x32x32_bf16 v[48:63], v[76:79], v[16:23], v84
    ds_read_b128 v[76:79], v87 offset:24576
WST8192:
    s_cbranch_execz WST20480
    v_exp_f32 v28, v28
    v_exp_f32 v29, v29
    v_exp_f32 v30, v30
    v_exp_f32 v31, v31
    s_setprio 2
    s_waitcnt lgkmcnt(3)
    v_smfmac_f32_32x32x32_bf16 v[48:63], v[80:83], v[24:31], v84
    ds_read_b128 v[80:83], v87 offset:28416
    v_exp_f32 v32, v32
    v_exp_f32 v33, v33
    v_exp_f32 v34, v34
    v_exp_f32 v35, v35
    s_waitcnt lgkmcnt(3)
    v_mfma_f32_32x32x16_bf16 v[16:31], v[72:75], v[64:67], 0
    ds_read_b128 v[72:75], v85 offset:27648
    v_exp_f32 v36, v36
    v_exp_f32 v37, v37
    v_exp_f32 v38, v38
    v_exp_f32 v39, v39
    s_waitcnt lgkmcnt(3)
    v_mfma_f32_32x32x8_bf16 v[16:31], v[70:71], v[68:69], v[16:31]
    ds_read_b32 v70, v86 offset:27648
    v_exp_f32 v40, v40
    v_exp_f32 v41, v41
    v_exp_f32 v42, v42
    v_exp_f32 v43, v43
    s_waitcnt lgkmcnt(3)
    v_smfmac_f32_32x32x32_bf16 v[48:63], v[76:79], v[32:39], v84
    ds_read_b128 v[76:79], v87 offset:27648
    v_exp_f32 v44, v44
    v_exp_f32 v45, v45
    v_exp_f32 v46, v46
    v_exp_f32 v47, v47
    s_setprio 1
    s_waitcnt lgkmcnt(3)
    v_smfmac_f32_32x32x32_bf16 v[48:63], v[80:83], v[40:47], v84
    ds_read_b128 v[80:83], v87 offset:31488
    v_exp_f32 v16, v16
    v_exp_f32 v17, v17
    v_exp_f32 v18, v18
    v_exp_f32 v19, v19
    s_waitcnt lgkmcnt(3)
    v_mfma_f32_32x32x16_bf16 v[32:47], v[72:75], v[64:67], 0
    ds_read_b128 v[72:75], v85 offset:30720
    v_exp_f32 v20, v20
    v_exp_f32 v21, v21
    v_exp_f32 v22, v22
    v_exp_f32 v23, v23
    s_waitcnt lgkmcnt(3)
    v_mfma_f32_32x32x8_bf16 v[32:47], v[70:71], v[68:69], v[32:47]
    ds_read_b32 v70, v86 offset:30720
    v_exp_f32 v24, v24
    v_exp_f32 v25, v25
    v_exp_f32 v26, v26
    v_exp_f32 v27, v27
    s_waitcnt lgkmcnt(3)
    v_smfmac_f32_32x32x32_bf16 v[48:63], v[76:79], v[16:23], v84
    ds_read_b128 v[76:79], v87 offset:30720
    v_exp_f32 v28, v28
    v_exp_f32 v29, v29
    v_exp_f32 v30, v30
    v_exp_f32 v31, v31
    s_setprio 0
    s_waitcnt lgkmcnt(3)
    v_smfmac_f32_32x32x32_bf16 v[48:63], v[80:83], v[24:31], v84
    ds_read_b128 v[80:83], v87 offset:34560
    v_exp_f32 v32, v32
    v_exp_f32 v33, v33
    v_exp_f32 v34, v34
    v_exp_f32 v35, v35
    s_waitcnt lgkmcnt(3)
    v_mfma_f32_32x32x16_bf16 v[16:31], v[72:75], v[64:67], 0
    ds_read_b128 v[72:75], v85 offset:33792
    v_exp_f32 v36, v36
    v_exp_f32 v37, v37
    v_exp_f32 v38, v38
    v_exp_f32 v39, v39
    s_waitcnt lgkmcnt(3)
    v_mfma_f32_32x32x8_bf16 v[16:31], v[70:71], v[68:69], v[16:31]
    ds_read_b32 v70, v86 offset:33792
    v_exp_f32 v40, v40
    v_exp_f32 v41, v41
    v_exp_f32 v42, v42
    v_exp_f32 v43, v43
    s_waitcnt lgkmcnt(3)
    v_smfmac_f32_32x32x32_bf16 v[48:63], v[76:79], v[32:39], v84
    ds_read_b128 v[76:79], v87 offset:33792
    v_exp_f32 v44, v44
    v_exp_f32 v45, v45
    v_exp_f32 v46, v46
    v_exp_f32 v47, v47
    s_waitcnt vmcnt(2) lgkmcnt(0)
    s_barrier
    s_setprio 3
    v_smfmac_f32_32x32x32_bf16 v[48:63], v[80:83], v[40:47], v84
    ds_read_b128 v[80:83], v87 offset:37632
    v_exp_f32 v16, v16
    v_exp_f32 v17, v17
    v_exp_f32 v18, v18
    v_exp_f32 v19, v19
    v_mfma_f32_32x32x16_bf16 v[32:47], v[72:75], v[64:67], 0
    ds_read_b128 v[72:75], v85 offset:36864
    s_add_u32 s72, s72, 32768
    s_bitset0_b32 s72, 18
    s_add_u32 m0, s73, 114688
    s_nop 0
    buffer_load_dwordx4 v15, s[68:71], s72 offen offset:0 sc1 lds
    v_exp_f32 v20, v20
    v_exp_f32 v21, v21
    v_exp_f32 v22, v22
    v_exp_f32 v23, v23
    v_mfma_f32_32x32x8_bf16 v[32:47], v[70:71], v[68:69], v[32:47]
    ds_read_b32 v70, v86 offset:36864
    v_exp_f32 v24, v24
    v_exp_f32 v25, v25
    v_exp_f32 v26, v26
    v_exp_f32 v27, v27
    v_smfmac_f32_32x32x32_bf16 v[48:63], v[76:79], v[16:23], v84
    ds_read_b128 v[76:79], v87 offset:36864
    buffer_load_dwordx4 v15, s[68:71], s72 offen offset:1024 sc1 lds
    v_exp_f32 v28, v28
    v_exp_f32 v29, v29
    v_exp_f32 v30, v30
    v_exp_f32 v31, v31
    s_setprio 2
    s_waitcnt lgkmcnt(3)
    v_smfmac_f32_32x32x32_bf16 v[48:63], v[80:83], v[24:31], v84
    ds_read_b128 v[80:83], v87 offset:40704
    v_exp_f32 v32, v32
    v_exp_f32 v33, v33
    v_exp_f32 v34, v34
    v_exp_f32 v35, v35
    s_waitcnt lgkmcnt(3)
    v_mfma_f32_32x32x16_bf16 v[16:31], v[72:75], v[64:67], 0
    ds_read_b128 v[72:75], v85 offset:39936
    buffer_load_dwordx4 v15, s[68:71], s72 offen offset:2048 sc1 lds
    v_exp_f32 v36, v36
    v_exp_f32 v37, v37
    v_exp_f32 v38, v38
    v_exp_f32 v39, v39
    s_waitcnt lgkmcnt(3)
    v_mfma_f32_32x32x8_bf16 v[16:31], v[70:71], v[68:69], v[16:31]
    ds_read_b32 v70, v86 offset:39936
    v_exp_f32 v40, v40
    v_exp_f32 v41, v41
    v_exp_f32 v42, v42
    v_exp_f32 v43, v43
    s_waitcnt lgkmcnt(3)
    v_smfmac_f32_32x32x32_bf16 v[48:63], v[76:79], v[32:39], v84
    ds_read_b128 v[76:79], v87 offset:39936
    s_add_u32 m0, s17, 81920
    s_nop 0
    buffer_load_dwordx4 v14, s[52:55], s75 offen offset:0 lds
    v_exp_f32 v44, v44
    v_exp_f32 v45, v45
    v_exp_f32 v46, v46
    v_exp_f32 v47, v47
    s_setprio 1
    s_waitcnt lgkmcnt(3)
    v_smfmac_f32_32x32x32_bf16 v[48:63], v[80:83], v[40:47], v84
    ds_read_b128 v[80:83], v87 offset:43776
    v_exp_f32 v16, v16
    v_exp_f32 v17, v17
    v_exp_f32 v18, v18
    v_exp_f32 v19, v19
    s_waitcnt lgkmcnt(3)
    v_mfma_f32_32x32x16_bf16 v[32:47], v[72:75], v[64:67], 0
    ds_read_b128 v[72:75], v85 offset:43008
    buffer_load_dwordx4 v9, s[52:55], s75 offen offset:1024 lds
    s_add_u32 s75, s75, s78
    v_exp_f32 v20, v20
    v_exp_f32 v21, v21
    v_exp_f32 v22, v22
    v_exp_f32 v23, v23
    s_waitcnt lgkmcnt(3)
    v_mfma_f32_32x32x8_bf16 v[32:47], v[70:71], v[68:69], v[32:47]
    ds_read_b32 v70, v86 offset:43008
    v_exp_f32 v24, v24
    v_exp_f32 v25, v25
    v_exp_f32 v26, v26
    v_exp_f32 v27, v27
    s_waitcnt lgkmcnt(3)
    v_smfmac_f32_32x32x32_bf16 v[48:63], v[76:79], v[16:23], v84
    ds_read_b128 v[76:79], v87 offset:43008
    s_add_u32 m0, s17, 98304
    s_nop 0
    buffer_load_dwordx4 v14, s[56:59], s76 offen offset:0 lds
    v_exp_f32 v28, v28
    v_exp_f32 v29, v29
    v_exp_f32 v30, v30
    v_exp_f32 v31, v31
    s_setprio 0
    s_waitcnt lgkmcnt(3)
    v_smfmac_f32_32x32x32_bf16 v[48:63], v[80:83], v[24:31], v84
    ds_read_b128 v[80:83], v87 offset:46848
    v_exp_f32 v32, v32
    v_exp_f32 v33, v33
    v_exp_f32 v34, v34
    v_exp_f32 v35, v35
    s_waitcnt lgkmcnt(3)
    v_mfma_f32_32x32x16_bf16 v[16:31], v[72:75], v[64:67], 0
    ds_read_b128 v[72:75], v85 offset:46080
    buffer_load_dwordx4 v9, s[56:59], s76 offen offset:1024 lds
    s_add_u32 s76, s76, s78
    v_exp_f32 v36, v36
    v_exp_f32 v37, v37
    v_exp_f32 v38, v38
    v_exp_f32 v39, v39
    s_waitcnt lgkmcnt(3)
    v_mfma_f32_32x32x8_bf16 v[16:31], v[70:71], v[68:69], v[16:31]
    ds_read_b32 v70, v86 offset:46080
    v_exp_f32 v40, v40
    v_exp_f32 v41, v41
    v_exp_f32 v42, v42
    v_exp_f32 v43, v43
    s_waitcnt lgkmcnt(3)
    v_smfmac_f32_32x32x32_bf16 v[48:63], v[76:79], v[32:39], v84
    ds_read_b128 v[76:79], v87 offset:46080
    v_exp_f32 v44, v44
    v_exp_f32 v45, v45
    v_exp_f32 v46, v46
    v_exp_f32 v47, v47
    s_waitcnt vmcnt(4) lgkmcnt(0)
    s_barrier
    s_setprio 3
    v_smfmac_f32_32x32x32_bf16 v[48:63], v[80:83], v[40:47], v84
    ds_read_b128 v[80:83], v87 offset:768
    v_exp_f32 v16, v16
    v_exp_f32 v17, v17
    v_exp_f32 v18, v18
    v_exp_f32 v19, v19
    v_mfma_f32_32x32x16_bf16 v[32:47], v[72:75], v[64:67], 0
    ds_read_b128 v[72:75], v85 offset:0
    s_add_u32 s72, s72, 32768
    s_bitset0_b32 s72, 18
    s_add_u32 m0, s73, 139264
    s_nop 0
    buffer_load_dwordx4 v15, s[68:71], s72 offen offset:0 sc1 lds
    v_exp_f32 v20, v20
    v_exp_f32 v21, v21
    v_exp_f32 v22, v22
    v_exp_f32 v23, v23
    v_mfma_f32_32x32x8_bf16 v[32:47], v[70:71], v[68:69], v[32:47]
    ds_read_b32 v70, v86 offset:0
    v_exp_f32 v24, v24
    v_exp_f32 v25, v25
    v_exp_f32 v26, v26
    v_exp_f32 v27, v27
    v_smfmac_f32_32x32x32_bf16 v[48:63], v[76:79], v[16:23], v84
    ds_read_b128 v[76:79], v87 offset:0
    buffer_load_dwordx4 v15, s[68:71], s72 offen offset:1024 sc1 lds
    v_exp_f32 v28, v28
    v_exp_f32 v29, v29
    v_exp_f32 v30, v30
    v_exp_f32 v31, v31
    s_setprio 2
    s_waitcnt lgkmcnt(3)
    v_smfmac_f32_32x32x32_bf16 v[48:63], v[80:83], v[24:31], v84
    ds_read_b128 v[80:83], v87 offset:3840
    v_exp_f32 v32, v32
    v_exp_f32 v33, v33
    v_exp_f32 v34, v34
    v_exp_f32 v35, v35
    s_waitcnt lgkmcnt(3)
    v_mfma_f32_32x32x16_bf16 v[16:31], v[72:75], v[64:67], 0
    ds_read_b128 v[72:75], v85 offset:3072
    buffer_load_dwordx4 v15, s[68:71], s72 offen offset:2048 sc1 lds
    v_exp_f32 v36, v36
    v_exp_f32 v37, v37
    v_exp_f32 v38, v38
    v_exp_f32 v39, v39
    s_waitcnt lgkmcnt(3)
    v_mfma_f32_32x32x8_bf16 v[16:31], v[70:71], v[68:69], v[16:31]
    ds_read_b32 v70, v86 offset:3072
    v_exp_f32 v40, v40
    v_exp_f32 v41, v41
    v_exp_f32 v42, v42
    v_exp_f32 v43, v43
    s_waitcnt lgkmcnt(3)
    v_smfmac_f32_32x32x32_bf16 v[48:63], v[76:79], v[32:39], v84
    ds_read_b128 v[76:79], v87 offset:3072
    s_add_u32 m0, s17, 16384
    s_nop 0
    buffer_load_dwordx4 v14, s[52:55], s75 offen offset:0 lds
    v_exp_f32 v44, v44
    v_exp_f32 v45, v45
    v_exp_f32 v46, v46
    v_exp_f32 v47, v47
    s_setprio 1
    s_waitcnt lgkmcnt(3)
    v_smfmac_f32_32x32x32_bf16 v[48:63], v[80:83], v[40:47], v84
    ds_read_b128 v[80:83], v87 offset:6912
    v_exp_f32 v16, v16
    v_exp_f32 v17, v17
    v_exp_f32 v18, v18
    v_exp_f32 v19, v19
    s_waitcnt lgkmcnt(3)
    v_mfma_f32_32x32x16_bf16 v[32:47], v[72:75], v[64:67], 0
    ds_read_b128 v[72:75], v85 offset:6144
    buffer_load_dwordx4 v9, s[52:55], s75 offen offset:1024 lds
    s_add_u32 s75, s75, s78
    v_exp_f32 v20, v20
    v_exp_f32 v21, v21
    v_exp_f32 v22, v22
    v_exp_f32 v23, v23
    s_waitcnt lgkmcnt(3)
    v_mfma_f32_32x32x8_bf16 v[32:47], v[70:71], v[68:69], v[32:47]
    ds_read_b32 v70, v86 offset:6144
    v_exp_f32 v24, v24
    v_exp_f32 v25, v25
    v_exp_f32 v26, v26
    v_exp_f32 v27, v27
    s_waitcnt lgkmcnt(3)
    v_smfmac_f32_32x32x32_bf16 v[48:63], v[76:79], v[16:23], v84
    ds_read_b128 v[76:79], v87 offset:6144
    s_add_u32 m0, s17, 32768
    s_nop 0
    buffer_load_dwordx4 v14, s[56:59], s76 offen offset:0 lds
    v_exp_f32 v28, v28
    v_exp_f32 v29, v29
    v_exp_f32 v30, v30
    v_exp_f32 v31, v31
    s_setprio 0
    s_waitcnt lgkmcnt(3)
    v_smfmac_f32_32x32x32_bf16 v[48:63], v[80:83], v[24:31], v84
    ds_read_b128 v[80:83], v87 offset:9984
    v_exp_f32 v32, v32
    v_exp_f32 v33, v33
    v_exp_f32 v34, v34
    v_exp_f32 v35, v35
    s_waitcnt lgkmcnt(3)
    v_mfma_f32_32x32x16_bf16 v[16:31], v[72:75], v[64:67], 0
    ds_read_b128 v[72:75], v85 offset:9216
    buffer_load_dwordx4 v9, s[56:59], s76 offen offset:1024 lds
    s_add_u32 s76, s76, s78
    v_exp_f32 v36, v36
    v_exp_f32 v37, v37
    v_exp_f32 v38, v38
    v_exp_f32 v39, v39
    s_waitcnt lgkmcnt(3)
    v_mfma_f32_32x32x8_bf16 v[16:31], v[70:71], v[68:69], v[16:31]
    ds_read_b32 v70, v86 offset:9216
    v_exp_f32 v40, v40
    v_exp_f32 v41, v41
    v_exp_f32 v42, v42
    v_exp_f32 v43, v43
    s_waitcnt lgkmcnt(3)
    v_smfmac_f32_32x32x32_bf16 v[48:63], v[76:79], v[32:39], v84
    ds_read_b128 v[76:79], v87 offset:9216
    v_exp_f32 v44, v44
    v_exp_f32 v45, v45
    v_exp_f32 v46, v46
    v_exp_f32 v47, v47
    s_waitcnt vmcnt(7) lgkmcnt(0)
    s_barrier
    s_setprio 3
    v_smfmac_f32_32x32x32_bf16 v[48:63], v[80:83], v[40:47], v84
    ds_read_b128 v[80:83], v87 offset:13056
    s_lshl_b32 s14, s3, 8
    s_add_u32 s14, s14, s2
    s_mul_i32 s14, s14, 2560
    v_exp_f32 v16, v16
    v_exp_f32 v17, v17
    v_exp_f32 v18, v18
    v_exp_f32 v19, v19
    v_mfma_f32_32x32x16_bf16 v[32:47], v[72:75], v[64:67], 0
    ds_read_b128 v[72:75], v85 offset:12288
    s_add_u32 m0, s17, 49152
    s_nop 0
    buffer_load_dwordx4 v14, s[52:55], s75 offen offset:0 lds
    v_exp_f32 v20, v20
    v_exp_f32 v21, v21
    v_exp_f32 v22, v22
    v_exp_f32 v23, v23
    v_mfma_f32_32x32x8_bf16 v[32:47], v[70:71], v[68:69], v[32:47]
    ds_read_b32 v70, v86 offset:12288
    v_exp_f32 v24, v24
    v_exp_f32 v25, v25
    v_exp_f32 v26, v26
    v_exp_f32 v27, v27
    v_smfmac_f32_32x32x32_bf16 v[48:63], v[76:79], v[16:23], v84
    ds_read_b64_tr_b16 v[96:97], v12 offset:0
    ds_read_b64_tr_b16 v[98:99], v12 offset:1024
    ds_read_b128 v[76:79], v87 offset:12288
    v_exp_f32 v28, v28
    v_exp_f32 v29, v29
    v_exp_f32 v30, v30
    v_exp_f32 v31, v31
    s_setprio 2
    s_waitcnt lgkmcnt(3)
    v_smfmac_f32_32x32x32_bf16 v[48:63], v[80:83], v[24:31], v84
    ds_read_b128 v[80:83], v87 offset:16128
    v_exp_f32 v32, v32
    v_exp_f32 v33, v33
    v_exp_f32 v34, v34
    v_exp_f32 v35, v35
    s_waitcnt lgkmcnt(3)
    v_mfma_f32_32x32x16_bf16 v[16:31], v[72:75], v[64:67], 0
    ds_read_b128 v[72:75], v85 offset:15360
    buffer_load_dwordx4 v9, s[52:55], s75 offen offset:1024 lds
    s_add_u32 s75, s75, s78
    v_exp_f32 v36, v36
    v_exp_f32 v37, v37
    v_exp_f32 v38, v38
    v_exp_f32 v39, v39
    s_waitcnt lgkmcnt(3)
    v_mfma_f32_32x32x8_bf16 v[16:31], v[70:71], v[68:69], v[16:31]
    ds_read_b32 v70, v86 offset:15360
    v_exp_f32 v40, v40
    v_exp_f32 v41, v41
    v_exp_f32 v42, v42
    v_exp_f32 v43, v43
    s_waitcnt lgkmcnt(3)
    v_smfmac_f32_32x32x32_bf16 v[48:63], v[76:79], v[32:39], v84
    ds_read_b64_tr_b16 v[100:101], v12 offset:16384
    ds_read_b64_tr_b16 v[102:103], v12 offset:17408
    ds_read_b128 v[76:79], v87 offset:15360
    v_exp_f32 v44, v44
    v_exp_f32 v45, v45
    v_exp_f32 v46, v46
    v_exp_f32 v47, v47
    s_setprio 1
    s_waitcnt lgkmcnt(3)
    v_smfmac_f32_32x32x32_bf16 v[48:63], v[80:83], v[40:47], v84
    ds_read_b128 v[80:83], v87 offset:19200
    v_exp_f32 v16, v16
    v_exp_f32 v17, v17
    v_exp_f32 v18, v18
    v_exp_f32 v19, v19
    s_waitcnt lgkmcnt(3)
    v_mfma_f32_32x32x16_bf16 v[32:47], v[72:75], v[64:67], 0
    ds_read_b128 v[72:75], v85 offset:18432
    s_add_u32 m0, s17, 65536
    s_nop 0
    buffer_load_dwordx4 v14, s[56:59], s76 offen offset:0 lds
    v_exp_f32 v20, v20
    v_exp_f32 v21, v21
    v_exp_f32 v22, v22
    v_exp_f32 v23, v23
    s_waitcnt lgkmcnt(3)
    v_mfma_f32_32x32x8_bf16 v[32:47], v[70:71], v[68:69], v[32:47]
    ds_read_b32 v70, v86 offset:18432
    v_exp_f32 v24, v24
    v_exp_f32 v25, v25
    v_exp_f32 v26, v26
    v_exp_f32 v27, v27
    s_waitcnt lgkmcnt(3)
    v_smfmac_f32_32x32x32_bf16 v[48:63], v[76:79], v[16:23], v84
    ds_read_b64_tr_b16 v[104:105], v12 offset:8192
    ds_read_b64_tr_b16 v[106:107], v12 offset:9216
    ds_read_b128 v[76:79], v87 offset:18432
    v_exp_f32 v28, v28
    v_exp_f32 v29, v29
    v_exp_f32 v30, v30
    v_exp_f32 v31, v31
    s_setprio 0
    s_waitcnt lgkmcnt(3)
    v_smfmac_f32_32x32x32_bf16 v[48:63], v[80:83], v[24:31], v84
    ds_read_b128 v[80:83], v87 offset:22272
    v_exp_f32 v32, v32
    v_exp_f32 v33, v33
    v_exp_f32 v34, v34
    v_exp_f32 v35, v35
    s_waitcnt lgkmcnt(3)
    v_mfma_f32_32x32x16_bf16 v[16:31], v[72:75], v[64:67], 0
    ds_read_b128 v[72:75], v85 offset:21504
    buffer_load_dwordx4 v9, s[56:59], s76 offen offset:1024 lds
    s_add_u32 s76, s76, s78
    v_exp_f32 v36, v36
    v_exp_f32 v37, v37
    v_exp_f32 v38, v38
    v_exp_f32 v39, v39
    s_waitcnt lgkmcnt(3)
    v_mfma_f32_32x32x8_bf16 v[16:31], v[70:71], v[68:69], v[16:31]
    ds_read_b32 v70, v86 offset:21504
    v_exp_f32 v40, v40
    v_exp_f32 v41, v41
    v_exp_f32 v42, v42
    v_exp_f32 v43, v43
    s_waitcnt lgkmcnt(3)
    v_smfmac_f32_32x32x32_bf16 v[48:63], v[76:79], v[32:39], v84
    ds_read_b64_tr_b16 v[108:109], v12 offset:24576
    ds_read_b64_tr_b16 v[110:111], v12 offset:25600
    ds_read_b128 v[76:79], v87 offset:21504
    v_exp_f32 v44, v44
    v_exp_f32 v45, v45
    v_exp_f32 v46, v46
    v_exp_f32 v47, v47
    s_waitcnt vmcnt(4) lgkmcnt(0)
    s_cmp_eq_u32 s5, 7
    s_cbranch_scc1 P2J
P2S:
    s_barrier
    s_setprio 3
    v_smfmac_f32_32x32x32_bf16 v[48:63], v[80:83], v[40:47], v84
    ds_read_b128 v[80:83], v87 offset:25344
    v_exp_f32 v16, v16
    v_exp_f32 v17, v17
    v_exp_f32 v18, v18
    v_exp_f32 v19, v19
    v_mfma_f32_32x32x16_bf16 v[32:47], v[72:75], v[64:67], 0
    ds_read_b128 v[72:75], v85 offset:24576
    s_add_u32 s72, s72, 32768
    s_bitset0_b32 s72, 18
    s_add_u32 m0, s73, 114688
    s_nop 0
    buffer_load_dwordx4 v15, s[68:71], s72 offen offset:0 sc1 lds
    v_exp_f32 v20, v20
    v_exp_f32 v21, v21
    v_exp_f32 v22, v22
    v_exp_f32 v23, v23
    v_mfma_f32_32x32x8_bf16 v[32:47], v[70:71], v[68:69], v[32:47]
    ds_read_b32 v70, v86 offset:24576
    v_exp_f32 v24, v24
    v_exp_f32 v25, v25
    v_exp_f32 v26, v26
    v_exp_f32 v27, v27
    v_smfmac_f32_32x32x32_bf16 v[48:63], v[76:79], v[16:23], v84
    ds_read_b64_tr_b16 v[112:113], v13 offset:0
    ds_read_b64_tr_b16 v[114:115], v13 offset:1024
    ds_read_b128 v[76:79], v87 offset:24576
    buffer_load_dwordx4 v15, s[68:71], s72 offen offset:1024 sc1 lds
    v_exp_f32 v28, v28
    v_exp_f32 v29, v29
    v_exp_f32 v30, v30
    v_exp_f32 v31, v31
    s_setprio 2
    s_waitcnt lgkmcnt(3)
    v_smfmac_f32_32x32x32_bf16 v[48:63], v[80:83], v[24:31], v84
    ds_read_b128 v[80:83], v87 offset:28416
    v_exp_f32 v32, v32
    v_exp_f32 v33, v33
    v_exp_f32 v34, v34
    v_exp_f32 v35, v35
    s_waitcnt lgkmcnt(3)
    v_mfma_f32_32x32x16_bf16 v[16:31], v[72:75], v[64:67], 0
    ds_read_b128 v[72:75], v85 offset:27648
    buffer_load_dwordx4 v15, s[68:71], s72 offen offset:2048 sc1 lds
    v_exp_f32 v36, v36
    v_exp_f32 v37, v37
    v_exp_f32 v38, v38
    v_exp_f32 v39, v39
    s_waitcnt lgkmcnt(3)
    v_mfma_f32_32x32x8_bf16 v[16:31], v[70:71], v[68:69], v[16:31]
    ds_read_b32 v70, v86 offset:27648
    v_exp_f32 v40, v40
    v_exp_f32 v41, v41
    v_exp_f32 v42, v42
    v_exp_f32 v43, v43
    s_waitcnt lgkmcnt(3)
    v_smfmac_f32_32x32x32_bf16 v[48:63], v[76:79], v[32:39], v84
    ds_read_b64_tr_b16 v[116:117], v13 offset:16384
    ds_read_b64_tr_b16 v[118:119], v13 offset:17408
    ds_read_b128 v[76:79], v87 offset:27648
    s_add_u32 m0, s17, 81920
    s_nop 0
    buffer_load_dwordx4 v14, s[52:55], s75 offen offset:0 lds
    v_exp_f32 v44, v44
    v_exp_f32 v45, v45
    v_exp_f32 v46, v46
    v_exp_f32 v47, v47
    s_setprio 1
    s_waitcnt lgkmcnt(3)
    v_smfmac_f32_32x32x32_bf16 v[48:63], v[80:83], v[40:47], v84
    ds_read_b128 v[80:83], v87 offset:31488
    v_exp_f32 v16, v16
    v_exp_f32 v17, v17
    v_exp_f32 v18, v18
    v_exp_f32 v19, v19
    s_waitcnt lgkmcnt(3)
    v_mfma_f32_32x32x16_bf16 v[32:47], v[72:75], v[64:67], 0
    ds_read_b128 v[72:75], v85 offset:30720
    buffer_load_dwordx4 v9, s[52:55], s75 offen offset:1024 lds
    v_exp_f32 v20, v20
    v_exp_f32 v21, v21
    v_exp_f32 v22, v22
    v_exp_f32 v23, v23
    s_waitcnt lgkmcnt(3)
    v_mfma_f32_32x32x8_bf16 v[32:47], v[70:71], v[68:69], v[32:47]
    ds_read_b32 v70, v86 offset:30720
    v_exp_f32 v24, v24
    v_exp_f32 v25, v25
    v_exp_f32 v26, v26
    v_exp_f32 v27, v27
    s_waitcnt lgkmcnt(3)
    v_smfmac_f32_32x32x32_bf16 v[48:63], v[76:79], v[16:23], v84
    ds_read_b64_tr_b16 v[120:121], v13 offset:8192
    ds_read_b64_tr_b16 v[122:123], v13 offset:9216
    ds_read_b128 v[76:79], v87 offset:30720
    s_add_u32 m0, s17, 98304
    s_nop 0
    buffer_load_dwordx4 v14, s[56:59], s75 offen offset:0 lds
    v_exp_f32 v28, v28
    v_exp_f32 v29, v29
    v_exp_f32 v30, v30
    v_exp_f32 v31, v31
    s_setprio 0
    s_waitcnt lgkmcnt(3)
    v_smfmac_f32_32x32x32_bf16 v[48:63], v[80:83], v[24:31], v84
    ds_read_b128 v[80:83], v87 offset:34560
    v_exp_f32 v32, v32
    v_exp_f32 v33, v33
    v_exp_f32 v34, v34
    v_exp_f32 v35, v35
    s_waitcnt lgkmcnt(3)
    v_mfma_f32_32x32x16_bf16 v[16:31], v[72:75], v[64:67], 0
    ds_read_b128 v[72:75], v85 offset:33792
    buffer_load_dwordx4 v9, s[56:59], s75 offen offset:1024 lds
    s_add_u32 s75, s75, s78
    v_exp_f32 v36, v36
    v_exp_f32 v37, v37
    v_exp_f32 v38, v38
    v_exp_f32 v39, v39
    s_waitcnt lgkmcnt(3)
    v_mfma_f32_32x32x8_bf16 v[16:31], v[70:71], v[68:69], v[16:31]
    ds_read_b32 v70, v86 offset:33792
    v_exp_f32 v40, v40
    v_exp_f32 v41, v41
    v_exp_f32 v42, v42
    v_exp_f32 v43, v43
    s_waitcnt lgkmcnt(3)
    v_smfmac_f32_32x32x32_bf16 v[48:63], v[76:79], v[32:39], v84
    ds_read_b64_tr_b16 v[124:125], v13 offset:24576
    ds_read_b64_tr_b16 v[126:127], v13 offset:25600
    ds_read_b128 v[76:79], v87 offset:33792
    v_exp_f32 v44, v44
    v_exp_f32 v45, v45
    v_exp_f32 v46, v46
    v_exp_f32 v47, v47
    s_waitcnt vmcnt(7) lgkmcnt(0)
    s_barrier
    s_setprio 3
    v_smfmac_f32_32x32x32_bf16 v[48:63], v[80:83], v[40:47], v84
    ds_read_b128 v[80:83], v87 offset:37632
    v_exp_f32 v16, v16
    v_exp_f32 v17, v17
    v_exp_f32 v18, v18
    v_exp_f32 v19, v19
    v_mfma_f32_32x32x16_bf16 v[32:47], v[72:75], v[64:67], 0
    ds_read_b128 v[72:75], v85 offset:36864
    s_add_u32 m0, s17, 16384
    s_nop 0
    buffer_load_dwordx4 v14, s[52:55], s75 offen offset:0 lds
    v_exp_f32 v20, v20
    v_exp_f32 v21, v21
    v_exp_f32 v22, v22
    v_exp_f32 v23, v23
    v_mfma_f32_32x32x8_bf16 v[32:47], v[70:71], v[68:69], v[32:47]
    ds_read_b32 v70, v86 offset:36864
    v_exp_f32 v24, v24
    v_exp_f32 v25, v25
    v_exp_f32 v26, v26
    v_exp_f32 v27, v27
    v_smfmac_f32_32x32x32_bf16 v[48:63], v[76:79], v[16:23], v84
    ds_read_b64_tr_b16 v[128:129], v13 offset:32768
    ds_read_b64_tr_b16 v[130:131], v13 offset:33792
    ds_read_b128 v[76:79], v87 offset:36864
    buffer_load_dwordx4 v9, s[52:55], s75 offen offset:1024 lds
    v_exp_f32 v28, v28
    v_exp_f32 v29, v29
    v_exp_f32 v30, v30
    v_exp_f32 v31, v31
    s_setprio 2
    s_waitcnt lgkmcnt(3)
    v_smfmac_f32_32x32x32_bf16 v[48:63], v[80:83], v[24:31], v84
    ds_read_b128 v[80:83], v87 offset:40704
    v_exp_f32 v32, v32
    v_exp_f32 v33, v33
    v_exp_f32 v34, v34
    v_exp_f32 v35, v35
    s_waitcnt lgkmcnt(3)
    v_mfma_f32_32x32x16_bf16 v[16:31], v[72:75], v[64:67], 0
    ds_read_b128 v[72:75], v85 offset:39936
    s_add_u32 m0, s17, 32768
    s_nop 0
    buffer_load_dwordx4 v14, s[56:59], s75 offen offset:0 lds
    v_exp_f32 v36, v36
    v_exp_f32 v37, v37
    v_exp_f32 v38, v38
    v_exp_f32 v39, v39
    s_waitcnt lgkmcnt(3)
    v_mfma_f32_32x32x8_bf16 v[16:31], v[70:71], v[68:69], v[16:31]
    ds_read_b32 v70, v86 offset:39936
    v_exp_f32 v40, v40
    v_exp_f32 v41, v41
    v_exp_f32 v42, v42
    v_exp_f32 v43, v43
    s_waitcnt lgkmcnt(3)
    v_smfmac_f32_32x32x32_bf16 v[48:63], v[76:79], v[32:39], v84
    ds_read_b64_tr_b16 v[132:133], v13 offset:49152
    ds_read_b64_tr_b16 v[134:135], v13 offset:50176
    ds_read_b128 v[76:79], v87 offset:39936
    v_exp_f32 v44, v44
    v_exp_f32 v45, v45
    v_exp_f32 v46, v46
    v_exp_f32 v47, v47
    s_setprio 1
    s_waitcnt lgkmcnt(3)
    v_smfmac_f32_32x32x32_bf16 v[48:63], v[80:83], v[40:47], v84
    ds_read_b128 v[80:83], v87 offset:43776
    v_exp_f32 v16, v16
    v_exp_f32 v17, v17
    v_exp_f32 v18, v18
    v_exp_f32 v19, v19
    s_waitcnt lgkmcnt(3)
    v_mfma_f32_32x32x16_bf16 v[32:47], v[72:75], v[64:67], 0
    ds_read_b128 v[72:75], v85 offset:43008
    buffer_load_dwordx4 v9, s[56:59], s75 offen offset:1024 lds
    s_add_u32 s75, s75, s78
    v_exp_f32 v20, v20
    v_exp_f32 v21, v21
    v_exp_f32 v22, v22
    v_exp_f32 v23, v23
    s_waitcnt lgkmcnt(3)
    v_mfma_f32_32x32x8_bf16 v[32:47], v[70:71], v[68:69], v[32:47]
    ds_read_b32 v70, v86 offset:43008
    v_exp_f32 v24, v24
    v_exp_f32 v25, v25
    v_exp_f32 v26, v26
    v_exp_f32 v27, v27
    s_waitcnt lgkmcnt(3)
    v_smfmac_f32_32x32x32_bf16 v[48:63], v[76:79], v[16:23], v84
    ds_read_b64_tr_b16 v[136:137], v13 offset:40960
    ds_read_b64_tr_b16 v[138:139], v13 offset:41984
    ds_read_b128 v[76:79], v87 offset:43008
    v_exp_f32 v28, v28
    v_exp_f32 v29, v29
    v_exp_f32 v30, v30
    v_exp_f32 v31, v31
    s_setprio 0
    s_waitcnt lgkmcnt(3)
    v_smfmac_f32_32x32x32_bf16 v[48:63], v[80:83], v[24:31], v84
    ds_read_b128 v[80:83], v87 offset:46848
    v_exp_f32 v32, v32
    v_exp_f32 v33, v33
    v_exp_f32 v34, v34
    v_exp_f32 v35, v35
    s_waitcnt lgkmcnt(3)
    v_mfma_f32_32x32x16_bf16 v[16:31], v[72:75], v[64:67], 0
    ds_read_b128 v[72:75], v85 offset:46080
    s_mov_b64 exec, 0x3ff
    buffer_load_dwordx2 v[6:7], v10, s[24:27], s14 offen offset:124 sc1
    s_mov_b64 exec, -1
    v_exp_f32 v36, v36
    v_exp_f32 v37, v37
    v_exp_f32 v38, v38
    v_exp_f32 v39, v39
    s_waitcnt lgkmcnt(3)
    v_mfma_f32_32x32x8_bf16 v[16:31], v[70:71], v[68:69], v[16:31]
    ds_read_b32 v70, v86 offset:46080
    v_exp_f32 v40, v40
    v_exp_f32 v41, v41
    v_exp_f32 v42, v42
    v_exp_f32 v43, v43
    s_waitcnt lgkmcnt(3)
    v_smfmac_f32_32x32x32_bf16 v[48:63], v[76:79], v[32:39], v84
    ds_read_b64_tr_b16 v[140:141], v13 offset:57344
    ds_read_b64_tr_b16 v[142:143], v13 offset:58368
    ds_read_b128 v[76:79], v87 offset:46080
    v_exp_f32 v44, v44
    v_exp_f32 v45, v45
    v_exp_f32 v46, v46
    v_exp_f32 v47, v47
    s_waitcnt vmcnt(5) lgkmcnt(0)
    s_barrier
    s_setprio 3
    v_smfmac_f32_32x32x32_bf16 v[48:63], v[80:83], v[40:47], v84
WST12288:
WARMB0:
    s_cbranch_execz WST16384
    ds_read_b128 v[80:83], v87 offset:768
    s_and_b32 s14, s6, 1
    s_lshl3_add_u32 s14, s14, s5
    s_lshl3_add_u32 s14, s14, s3
    s_mul_i32 s14, s14, 3328
    s_add_u32 s14, s14, s79
    v_exp_f32 v16, v16
    v_exp_f32 v17, v17
    v_exp_f32 v18, v18
    v_exp_f32 v19, v19
    v_mfma_f32_32x32x16_bf16 v[32:47], v[72:75], v[64:67], 0
    ds_read_b128 v[72:75], v85 offset:0
    s_add_u32 s72, s72, 32768
    s_bitset0_b32 s72, 18
    s_add_u32 m0, s73, 139264
    s_nop 0
    buffer_load_dwordx4 v15, s[68:71], s72 offen offset:0 sc1 lds
    v_exp_f32 v20, v20
    v_exp_f32 v21, v21
    v_exp_f32 v22, v22
    v_exp_f32 v23, v23
    v_mfma_f32_32x32x8_bf16 v[32:47], v[70:71], v[68:69], v[32:47]
    ds_read_b32 v70, v86 offset:0
    v_exp_f32 v24, v24
    v_exp_f32 v25, v25
    v_exp_f32 v26, v26
    v_exp_f32 v27, v27
    v_smfmac_f32_32x32x32_bf16 v[48:63], v[76:79], v[16:23], v84
    ds_read_b64_tr_b16 v[144:145], v12 offset:0
    ds_read_b64_tr_b16 v[146:147], v12 offset:1024
    ds_read_b128 v[76:79], v87 offset:0
    buffer_load_dwordx4 v15, s[68:71], s72 offen offset:1024 sc1 lds
    v_exp_f32 v28, v28
    v_exp_f32 v29, v29
    v_exp_f32 v30, v30
    v_exp_f32 v31, v31
    s_setprio 2
    s_waitcnt lgkmcnt(3)
    v_smfmac_f32_32x32x32_bf16 v[48:63], v[80:83], v[24:31], v84
    ds_read_b128 v[80:83], v87 offset:3840
    v_exp_f32 v32, v32
    v_exp_f32 v33, v33
    v_exp_f32 v34, v34
    v_exp_f32 v35, v35
    s_waitcnt lgkmcnt(3)
    v_mfma_f32_32x32x16_bf16 v[16:31], v[72:75], v[64:67], 0
    ds_read_b128 v[72:75], v85 offset:3072
    buffer_load_dwordx4 v15, s[68:71], s72 offen offset:2048 sc1 lds
    v_exp_f32 v36, v36
    v_exp_f32 v37, v37
    v_exp_f32 v38, v38
    v_exp_f32 v39, v39
    s_waitcnt lgkmcnt(3)
    v_mfma_f32_32x32x8_bf16 v[16:31], v[70:71], v[68:69], v[16:31]
    ds_read_b32 v70, v86 offset:3072
    v_exp_f32 v40, v40
    v_exp_f32 v41, v41
    v_exp_f32 v42, v42
    v_exp_f32 v43, v43
    s_waitcnt lgkmcnt(3)
    v_smfmac_f32_32x32x32_bf16 v[48:63], v[76:79], v[32:39], v84
    ds_read_b64_tr_b16 v[148:149], v12 offset:16384
    ds_read_b64_tr_b16 v[150:151], v12 offset:17408
    ds_read_b128 v[76:79], v87 offset:3072
    s_add_u32 m0, s17, 49152
    s_nop 0
    buffer_load_dwordx4 v14, s[52:55], s75 offen offset:0 lds
    v_exp_f32 v44, v44
    v_exp_f32 v45, v45
    v_exp_f32 v46, v46
    v_exp_f32 v47, v47
    s_setprio 1
    s_waitcnt lgkmcnt(3)
    v_smfmac_f32_32x32x32_bf16 v[48:63], v[80:83], v[40:47], v84
    ds_read_b128 v[80:83], v87 offset:6912
    v_exp_f32 v16, v16
    v_exp_f32 v17, v17
    v_exp_f32 v18, v18
    v_exp_f32 v19, v19
    s_waitcnt lgkmcnt(3)
    v_mfma_f32_32x32x16_bf16 v[32:47], v[72:75], v[64:67], 0
    ds_read_b128 v[72:75], v85 offset:6144
    buffer_load_dwordx4 v9, s[52:55], s75 offen offset:1024 lds
    v_exp_f32 v20, v20
    v_exp_f32 v21, v21
    v_exp_f32 v22, v22
    v_exp_f32 v23, v23
    s_waitcnt lgkmcnt(3)
    v_mfma_f32_32x32x8_bf16 v[32:47], v[70:71], v[68:69], v[32:47]
    ds_read_b32 v70, v86 offset:6144
    v_exp_f32 v24, v24
    v_exp_f32 v25, v25
    v_exp_f32 v26, v26
    v_exp_f32 v27, v27
    s_waitcnt lgkmcnt(3)
    v_smfmac_f32_32x32x32_bf16 v[48:63], v[76:79], v[16:23], v84
    ds_read_b64_tr_b16 v[152:153], v12 offset:8192
    ds_read_b64_tr_b16 v[154:155], v12 offset:9216
    ds_read_b128 v[76:79], v87 offset:6144
    s_add_u32 m0, s17, 65536
    s_nop 0
    buffer_load_dwordx4 v14, s[56:59], s75 offen offset:0 lds
    v_exp_f32 v28, v28
    v_exp_f32 v29, v29
    v_exp_f32 v30, v30
    v_exp_f32 v31, v31
    s_setprio 0
    s_waitcnt lgkmcnt(3)
    v_smfmac_f32_32x32x32_bf16 v[48:63], v[80:83], v[24:31], v84
    ds_read_b128 v[80:83], v87 offset:9984
    v_exp_f32 v32, v32
    v_exp_f32 v33, v33
    v_exp_f32 v34, v34
    v_exp_f32 v35, v35
    s_waitcnt lgkmcnt(3)
    v_mfma_f32_32x32x16_bf16 v[16:31], v[72:75], v[64:67], 0
    ds_read_b128 v[72:75], v85 offset:9216
    buffer_load_dwordx4 v9, s[56:59], s75 offen offset:1024 lds
    s_add_u32 s75, s75, s78
    v_exp_f32 v36, v36
    v_exp_f32 v37, v37
    v_exp_f32 v38, v38
    v_exp_f32 v39, v39
    s_waitcnt lgkmcnt(3)
    v_mfma_f32_32x32x8_bf16 v[16:31], v[70:71], v[68:69], v[16:31]
    ds_read_b32 v70, v86 offset:9216
    v_exp_f32 v40, v40
    v_exp_f32 v41, v41
    v_exp_f32 v42, v42
    v_exp_f32 v43, v43
    s_waitcnt lgkmcnt(3)
    v_smfmac_f32_32x32x32_bf16 v[48:63], v[76:79], v[32:39], v84
    ds_read_b64_tr_b16 v[156:157], v12 offset:24576
    ds_read_b64_tr_b16 v[158:159], v12 offset:25600
    ds_read_b128 v[76:79], v87 offset:9216
    v_exp_f32 v44, v44
    v_exp_f32 v45, v45
    v_exp_f32 v46, v46
    v_exp_f32 v47, v47
    s_waitcnt vmcnt(8) lgkmcnt(0)
    s_barrier
    s_setprio 3
    v_smfmac_f32_32x32x32_bf16 v[48:63], v[80:83], v[40:47], v84
    ds_read_b128 v[80:83], v87 offset:13056
    v_exp_f32 v16, v16
    v_exp_f32 v17, v17
    v_exp_f32 v18, v18
    v_exp_f32 v19, v19
    v_mfma_f32_32x32x16_bf16 v[32:47], v[72:75], v[64:67], 0
    ds_read_b128 v[72:75], v85 offset:12288
    s_add_u32 m0, s17, 81920
    s_nop 0
    buffer_load_dwordx4 v14, s[52:55], s75 offen offset:0 lds
    v_exp_f32 v20, v20
    v_exp_f32 v21, v21
    v_exp_f32 v22, v22
    v_exp_f32 v23, v23
    v_mfma_f32_32x32x8_bf16 v[32:47], v[70:71], v[68:69], v[32:47]
    ds_read_b32 v70, v86 offset:12288
    v_exp_f32 v24, v24
    v_exp_f32 v25, v25
    v_exp_f32 v26, v26
    v_exp_f32 v27, v27
    v_smfmac_f32_32x32x32_bf16 v[48:63], v[76:79], v[16:23], v84
    ds_read_b64_tr_b16 v[160:161], v13 offset:0
    ds_read_b64_tr_b16 v[162:163], v13 offset:1024
    ds_read_b128 v[76:79], v87 offset:12288
    buffer_load_dwordx4 v9, s[52:55], s75 offen offset:1024 lds
    v_exp_f32 v28, v28
    v_exp_f32 v29, v29
    v_exp_f32 v30, v30
    v_exp_f32 v31, v31
    s_setprio 2
    s_waitcnt lgkmcnt(3)
    v_smfmac_f32_32x32x32_bf16 v[48:63], v[80:83], v[24:31], v84
    ds_read_b128 v[80:83], v87 offset:16128
    v_exp_f32 v32, v32
    v_exp_f32 v33, v33
    v_exp_f32 v34, v34
    v_exp_f32 v35, v35
    s_waitcnt lgkmcnt(3)
    v_mfma_f32_32x32x16_bf16 v[16:31], v[72:75], v[64:67], 0
    ds_read_b128 v[72:75], v85 offset:15360
    s_add_u32 m0, s17, 98304
    s_nop 0
    buffer_load_dwordx4 v14, s[56:59], s75 offen offset:0 lds
    v_exp_f32 v36, v36
    v_exp_f32 v37, v37
    v_exp_f32 v38, v38
    v_exp_f32 v39, v39
    s_waitcnt lgkmcnt(3)
    v_mfma_f32_32x32x8_bf16 v[16:31], v[70:71], v[68:69], v[16:31]
    ds_read_b32 v70, v86 offset:15360
    v_exp_f32 v40, v40
    v_exp_f32 v41, v41
    v_exp_f32 v42, v42
    v_exp_f32 v43, v43
    s_waitcnt lgkmcnt(3)
    v_smfmac_f32_32x32x32_bf16 v[48:63], v[76:79], v[32:39], v84
    ds_read_b64_tr_b16 v[164:165], v13 offset:16384
    ds_read_b64_tr_b16 v[166:167], v13 offset:17408
    ds_read_b128 v[76:79], v87 offset:15360
    v_exp_f32 v44, v44
    v_exp_f32 v45, v45
    v_exp_f32 v46, v46
    v_exp_f32 v47, v47
    s_setprio 1
    s_waitcnt lgkmcnt(3)
    v_smfmac_f32_32x32x32_bf16 v[48:63], v[80:83], v[40:47], v84
    ds_read_b128 v[80:83], v87 offset:19200
    v_exp_f32 v16, v16
    v_exp_f32 v17, v17
    v_exp_f32 v18, v18
    v_exp_f32 v19, v19
    s_waitcnt lgkmcnt(3)
    v_mfma_f32_32x32x16_bf16 v[32:47], v[72:75], v[64:67], 0
    ds_read_b128 v[72:75], v85 offset:18432
    buffer_load_dwordx4 v9, s[56:59], s75 offen offset:1024 lds
    s_add_u32 s75, s75, s78
    v_exp_f32 v20, v20
    v_exp_f32 v21, v21
    v_exp_f32 v22, v22
    v_exp_f32 v23, v23
    s_waitcnt lgkmcnt(3)
    v_mfma_f32_32x32x8_bf16 v[32:47], v[70:71], v[68:69], v[32:47]
    ds_read_b32 v70, v86 offset:18432
    v_exp_f32 v24, v24
    v_exp_f32 v25, v25
    v_exp_f32 v26, v26
    v_exp_f32 v27, v27
    s_waitcnt lgkmcnt(3)
    v_smfmac_f32_32x32x32_bf16 v[48:63], v[76:79], v[16:23], v84
    ds_read_b64_tr_b16 v[168:169], v13 offset:8192
    ds_read_b64_tr_b16 v[170:171], v13 offset:9216
    ds_read_b128 v[76:79], v87 offset:18432
    v_exp_f32 v28, v28
    v_exp_f32 v29, v29
    v_exp_f32 v30, v30
    v_exp_f32 v31, v31
    s_setprio 0
    s_waitcnt lgkmcnt(3)
    v_smfmac_f32_32x32x32_bf16 v[48:63], v[80:83], v[24:31], v84
    ds_read_b128 v[80:83], v87 offset:22272
    v_exp_f32 v32, v32
    v_exp_f32 v33, v33
    v_exp_f32 v34, v34
    v_exp_f32 v35, v35
    s_waitcnt lgkmcnt(3)
    v_mfma_f32_32x32x16_bf16 v[16:31], v[72:75], v[64:67], 0
    ds_read_b128 v[72:75], v85 offset:21504
    s_add_u32 m0, s19, 0
    s_nop 0
    buffer_load_dwordx4 v11, s[24:27], s18 offen lds
    s_add_u32 s18, s18, 61440
    v_exp_f32 v36, v36
    v_exp_f32 v37, v37
    v_exp_f32 v38, v38
    v_exp_f32 v39, v39
    s_waitcnt lgkmcnt(3)
    v_mfma_f32_32x32x8_bf16 v[16:31], v[70:71], v[68:69], v[16:31]
    ds_read_b32 v70, v86 offset:21504
    v_exp_f32 v40, v40
    v_exp_f32 v41, v41
    v_exp_f32 v42, v42
    v_exp_f32 v43, v43
    s_waitcnt lgkmcnt(3)
    v_smfmac_f32_32x32x32_bf16 v[48:63], v[76:79], v[32:39], v84
    ds_read_b64_tr_b16 v[172:173], v13 offset:24576
    ds_read_b64_tr_b16 v[174:175], v13 offset:25600
    ds_read_b128 v[76:79], v87 offset:21504
    v_exp_f32 v44, v44
    v_exp_f32 v45, v45
    v_exp_f32 v46, v46
    v_exp_f32 v47, v47
    s_waitcnt vmcnt(5) lgkmcnt(0)
    s_barrier
    s_setprio 3
    v_smfmac_f32_32x32x32_bf16 v[48:63], v[80:83], v[40:47], v84
    ds_read_b128 v[80:83], v87 offset:25344
    s_lshl_b32 s39, s3, 2
    s_lshr_b32 s39, 0x76325410, s39
    s_and_b32 s39, s39, 7
    s_and_b32 s15, s39, 3
    s_lshl2_add_u32 s15, s6, s15
    s_mul_i32 s15, s15, 20480
    s_mul_i32 s10, s5, 160
    s_add_u32 s15, s15, s10
    s_lshr_b32 s13, s6, 1
    s_lshl_b32 s13, s13, 8
    v_and_b32 v3, 0xf0, v15
    v_lshrrev_b32 v5, 4, v1
    v_mul_u32_u24 v4, 80, v3
    v_lshl_add_u32 v2, v5, 3, v4
    v_exp_f32 v16, v16
    v_exp_f32 v17, v17
    v_exp_f32 v18, v18
    v_exp_f32 v19, v19
    v_mfma_f32_32x32x16_bf16 v[32:47], v[72:75], v[64:67], 0
    ds_read_b128 v[72:75], v85 offset:24576
    s_add_u32 s72, s72, 32768
    s_bitset0_b32 s72, 18
    s_add_u32 m0, s73, 114688
    s_nop 0
    buffer_load_dwordx4 v15, s[68:71], s72 offen offset:0 sc1 lds
    v_exp_f32 v20, v20
    v_exp_f32 v21, v21
    v_exp_f32 v22, v22
    v_exp_f32 v23, v23
    v_mfma_f32_32x32x8_bf16 v[32:47], v[70:71], v[68:69], v[32:47]
    ds_read_b32 v70, v86 offset:24576
    v_exp_f32 v24, v24
    v_exp_f32 v25, v25
    v_exp_f32 v26, v26
    v_exp_f32 v27, v27
    v_smfmac_f32_32x32x32_bf16 v[48:63], v[76:79], v[16:23], v84
    ds_read_b64_tr_b16 v[176:177], v13 offset:32768
    ds_read_b64_tr_b16 v[178:179], v13 offset:33792
    ds_read_b128 v[76:79], v87 offset:24576
    buffer_load_dwordx4 v15, s[68:71], s72 offen offset:1024 sc1 lds
    v_exp_f32 v28, v28
    v_exp_f32 v29, v29
    v_exp_f32 v30, v30
    v_exp_f32 v31, v31
    s_setprio 2
    s_waitcnt lgkmcnt(3)
    v_smfmac_f32_32x32x32_bf16 v[48:63], v[80:83], v[24:31], v84
    ds_read_b128 v[80:83], v87 offset:28416
    v_exp_f32 v32, v32
    v_exp_f32 v33, v33
    v_exp_f32 v34, v34
    v_exp_f32 v35, v35
    s_waitcnt lgkmcnt(3)
    v_mfma_f32_32x32x16_bf16 v[16:31], v[72:75], v[64:67], 0
    ds_read_b128 v[72:75], v85 offset:27648
    buffer_load_dwordx4 v15, s[68:71], s72 offen offset:2048 sc1 lds
    v_exp_f32 v36, v36
    v_exp_f32 v37, v37
    v_exp_f32 v38, v38
    v_exp_f32 v39, v39
    s_waitcnt lgkmcnt(3)
    v_mfma_f32_32x32x8_bf16 v[16:31], v[70:71], v[68:69], v[16:31]
    ds_read_b32 v70, v86 offset:27648
    v_exp_f32 v40, v40
    v_exp_f32 v41, v41
    v_exp_f32 v42, v42
    v_exp_f32 v43, v43
    s_waitcnt lgkmcnt(3)
    v_smfmac_f32_32x32x32_bf16 v[48:63], v[76:79], v[32:39], v84
    ds_read_b64_tr_b16 v[180:181], v13 offset:49152
    ds_read_b64_tr_b16 v[182:183], v13 offset:50176
    ds_read_b128 v[76:79], v87 offset:27648
    s_add_u32 m0, s17, 16384
    s_nop 0
    buffer_load_dwordx4 v14, s[52:55], s75 offen offset:0 lds
    v_exp_f32 v44, v44
    v_exp_f32 v45, v45
    v_exp_f32 v46, v46
    v_exp_f32 v47, v47
    s_setprio 1
    s_waitcnt lgkmcnt(3)
    v_smfmac_f32_32x32x32_bf16 v[48:63], v[80:83], v[40:47], v84
    ds_read_b128 v[80:83], v87 offset:31488
    v_exp_f32 v16, v16
    v_exp_f32 v17, v17
    v_exp_f32 v18, v18
    v_exp_f32 v19, v19
    s_waitcnt lgkmcnt(3)
    v_mfma_f32_32x32x16_bf16 v[32:47], v[72:75], v[64:67], 0
    ds_read_b128 v[72:75], v85 offset:30720
    buffer_load_dwordx4 v9, s[52:55], s75 offen offset:1024 lds
    v_exp_f32 v20, v20
    v_exp_f32 v21, v21
    v_exp_f32 v22, v22
    v_exp_f32 v23, v23
    s_waitcnt lgkmcnt(3)
    v_mfma_f32_32x32x8_bf16 v[32:47], v[70:71], v[68:69], v[32:47]
    ds_read_b32 v70, v86 offset:30720
    v_exp_f32 v24, v24
    v_exp_f32 v25, v25
    v_exp_f32 v26, v26
    v_exp_f32 v27, v27
    s_waitcnt lgkmcnt(3)
    v_smfmac_f32_32x32x32_bf16 v[48:63], v[76:79], v[16:23], v84
    ds_read_b64_tr_b16 v[184:185], v13 offset:40960
    ds_read_b64_tr_b16 v[186:187], v13 offset:41984
    ds_read_b128 v[76:79], v87 offset:30720
    s_add_u32 m0, s17, 32768
    s_nop 0
    buffer_load_dwordx4 v14, s[56:59], s75 offen offset:0 lds
    v_exp_f32 v28, v28
    v_exp_f32 v29, v29
    v_exp_f32 v30, v30
    v_exp_f32 v31, v31
    s_setprio 0
    s_waitcnt lgkmcnt(3)
    v_smfmac_f32_32x32x32_bf16 v[48:63], v[80:83], v[24:31], v84
    ds_read_b128 v[80:83], v87 offset:34560
    v_exp_f32 v32, v32
    v_exp_f32 v33, v33
    v_exp_f32 v34, v34
    v_exp_f32 v35, v35
    s_waitcnt lgkmcnt(3)
    v_mfma_f32_32x32x16_bf16 v[16:31], v[72:75], v[64:67], 0
    ds_read_b128 v[72:75], v85 offset:33792
    buffer_load_dwordx4 v9, s[56:59], s75 offen offset:1024 lds
    s_add_u32 s75, s75, s78
    v_exp_f32 v36, v36
    v_exp_f32 v37, v37
    v_exp_f32 v38, v38
    v_exp_f32 v39, v39
    s_waitcnt lgkmcnt(3)
    v_mfma_f32_32x32x8_bf16 v[16:31], v[70:71], v[68:69], v[16:31]
    ds_read_b32 v70, v86 offset:33792
    v_exp_f32 v40, v40
    v_exp_f32 v41, v41
    v_exp_f32 v42, v42
    v_exp_f32 v43, v43
    s_waitcnt lgkmcnt(3)
    v_smfmac_f32_32x32x32_bf16 v[48:63], v[76:79], v[32:39], v84
    ds_read_b64_tr_b16 v[188:189], v13 offset:57344
    ds_read_b64_tr_b16 v[190:191], v13 offset:58368
    ds_read_b128 v[76:79], v87 offset:33792
    buffer_load_dword v4, v3, s[68:71], s13 offen offset:4 sc1
    v_exp_f32 v44, v44
    v_exp_f32 v45, v45
    v_exp_f32 v46, v46
    v_exp_f32 v47, v47
    s_waitcnt vmcnt(9) lgkmcnt(0)
    s_barrier
    s_setprio 3
    v_smfmac_f32_32x32x32_bf16 v[48:63], v[80:83], v[40:47], v84
    ds_read_b128 v[80:83], v87 offset:37632
    v_exp_f32 v16, v16
    v_exp_f32 v17, v17
    v_exp_f32 v18, v18
    v_exp_f32 v19, v19
    v_mfma_f32_32x32x16_bf16 v[32:47], v[72:75], v[64:67], 0
    ds_read_b128 v[72:75], v85 offset:36864
    s_add_u32 m0, s17, 49152
    s_nop 0
    buffer_load_dwordx4 v14, s[52:55], s75 offen offset:0 lds
    v_exp_f32 v20, v20
    v_exp_f32 v21, v21
    v_exp_f32 v22, v22
    v_exp_f32 v23, v23
    v_mfma_f32_32x32x8_bf16 v[32:47], v[70:71], v[68:69], v[32:47]
    ds_read_b32 v70, v86 offset:36864
    v_exp_f32 v24, v24
    v_exp_f32 v25, v25
    v_exp_f32 v26, v26
    v_exp_f32 v27, v27
    v_smfmac_f32_32x32x32_bf16 v[48:63], v[76:79], v[16:23], v84
    ds_read_b64_tr_b16 v[192:193], v12 offset:0
    ds_read_b64_tr_b16 v[194:195], v12 offset:1024
    ds_read_b128 v[76:79], v87 offset:36864
    buffer_load_dwordx4 v9, s[52:55], s75 offen offset:1024 lds
    v_exp_f32 v28, v28
    v_exp_f32 v29, v29
    v_exp_f32 v30, v30
    v_exp_f32 v31, v31
    s_setprio 2
    s_waitcnt lgkmcnt(3)
    v_smfmac_f32_32x32x32_bf16 v[48:63], v[80:83], v[24:31], v84
    ds_read_b128 v[80:83], v87 offset:40704
    v_exp_f32 v32, v32
    v_exp_f32 v33, v33
    v_exp_f32 v34, v34
    v_exp_f32 v35, v35
    s_waitcnt lgkmcnt(3)
    v_mfma_f32_32x32x16_bf16 v[16:31], v[72:75], v[64:67], 0
    ds_read_b128 v[72:75], v85 offset:39936
    s_add_u32 m0, s17, 65536
    s_nop 0
    buffer_load_dwordx4 v14, s[56:59], s75 offen offset:0 lds
    v_exp_f32 v36, v36
    v_exp_f32 v37, v37
    v_exp_f32 v38, v38
    v_exp_f32 v39, v39
    s_waitcnt lgkmcnt(3)
    v_mfma_f32_32x32x8_bf16 v[16:31], v[70:71], v[68:69], v[16:31]
    ds_read_b32 v70, v86 offset:39936
    v_exp_f32 v40, v40
    v_exp_f32 v41, v41
    v_exp_f32 v42, v42
    v_exp_f32 v43, v43
    s_waitcnt lgkmcnt(3)
    v_smfmac_f32_32x32x32_bf16 v[48:63], v[76:79], v[32:39], v84
    ds_read_b64_tr_b16 v[196:197], v12 offset:16384
    ds_read_b64_tr_b16 v[198:199], v12 offset:17408
    ds_read_b128 v[76:79], v87 offset:39936
    buffer_load_dwordx4 v9, s[56:59], s75 offen offset:1024 lds
    s_add_u32 s75, s75, s78
    v_exp_f32 v44, v44
    v_exp_f32 v45, v45
    v_exp_f32 v46, v46
    v_exp_f32 v47, v47
    s_setprio 1
    s_waitcnt lgkmcnt(3)
    v_smfmac_f32_32x32x32_bf16 v[48:63], v[80:83], v[40:47], v84
    ds_read_b128 v[80:83], v87 offset:43776
    v_exp_f32 v16, v16
    v_exp_f32 v17, v17
    v_exp_f32 v18, v18
    v_exp_f32 v19, v19
    s_waitcnt lgkmcnt(3)
    v_mfma_f32_32x32x16_bf16 v[32:47], v[72:75], v[64:67], 0
    ds_read_b128 v[72:75], v85 offset:43008
    s_add_u32 m0, s19, 7680
    s_nop 0
    buffer_load_dwordx4 v11, s[24:27], s18 offen lds
    s_add_u32 s18, s18, 61440
    v_exp_f32 v20, v20
    v_exp_f32 v21, v21
    v_exp_f32 v22, v22
    v_exp_f32 v23, v23
    s_waitcnt lgkmcnt(3)
    v_mfma_f32_32x32x8_bf16 v[32:47], v[70:71], v[68:69], v[32:47]
    ds_read_b32 v70, v86 offset:43008
    v_exp_f32 v24, v24
    v_exp_f32 v25, v25
    v_exp_f32 v26, v26
    v_exp_f32 v27, v27
    s_waitcnt lgkmcnt(3)
    v_smfmac_f32_32x32x32_bf16 v[48:63], v[76:79], v[16:23], v84
    ds_read_b64_tr_b16 v[200:201], v12 offset:8192
    ds_read_b64_tr_b16 v[202:203], v12 offset:9216
    ds_read_b128 v[76:79], v87 offset:43008
    v_exp_f32 v28, v28
    v_exp_f32 v29, v29
    v_exp_f32 v30, v30
    v_exp_f32 v31, v31
    s_setprio 0
    s_waitcnt lgkmcnt(3)
    v_smfmac_f32_32x32x32_bf16 v[48:63], v[80:83], v[24:31], v84
    ds_read_b128 v[80:83], v87 offset:46848
    v_exp_f32 v32, v32
    v_exp_f32 v33, v33
    v_exp_f32 v34, v34
    v_exp_f32 v35, v35
    s_waitcnt lgkmcnt(3)
    v_mfma_f32_32x32x16_bf16 v[16:31], v[72:75], v[64:67], 0
    ds_read_b128 v[72:75], v85 offset:46080
    buffer_load_dwordx2 v[92:93], v2, s[40:43], s15 offen offset:64
    s_and_b32 s10, s39, 4
    s_mul_i32 s10, s10, 24
    s_add_u32 s15, s15, s10
    v_exp_f32 v36, v36
    v_exp_f32 v37, v37
    v_exp_f32 v38, v38
    v_exp_f32 v39, v39
    s_waitcnt lgkmcnt(3)
    v_mfma_f32_32x32x8_bf16 v[16:31], v[70:71], v[68:69], v[16:31]
    ds_read_b32 v70, v86 offset:46080
    v_exp_f32 v40, v40
    v_exp_f32 v41, v41
    v_exp_f32 v42, v42
    v_exp_f32 v43, v43
    s_waitcnt lgkmcnt(3)
    v_smfmac_f32_32x32x32_bf16 v[48:63], v[76:79], v[32:39], v84
    ds_read_b64_tr_b16 v[204:205], v12 offset:24576
    ds_read_b64_tr_b16 v[206:207], v12 offset:25600
    ds_read_b128 v[76:79], v87 offset:46080
    v_exp_f32 v44, v44
    v_exp_f32 v45, v45
    v_exp_f32 v46, v46
    v_exp_f32 v47, v47
    s_waitcnt vmcnt(7) lgkmcnt(0)
    s_barrier
    s_setprio 3
    v_smfmac_f32_32x32x32_bf16 v[48:63], v[80:83], v[40:47], v84
    ds_read_b128 v[80:83], v87 offset:768
    v_exp_f32 v16, v16
    v_exp_f32 v17, v17
    v_exp_f32 v18, v18
    v_exp_f32 v19, v19
    v_mfma_f32_32x32x16_bf16 v[32:47], v[72:75], v[64:67], 0
    ds_read_b128 v[72:75], v85 offset:0
    s_add_u32 s72, s72, 32768
    s_bitset0_b32 s72, 18
    s_add_u32 m0, s73, 139264
    s_nop 0
    buffer_load_dwordx4 v15, s[68:71], s72 offen offset:0 sc1 lds
    v_exp_f32 v20, v20
    v_exp_f32 v21, v21
    v_exp_f32 v22, v22
    v_exp_f32 v23, v23
    v_mfma_f32_32x32x8_bf16 v[32:47], v[70:71], v[68:69], v[32:47]
    ds_read_b32 v70, v86 offset:0
    v_exp_f32 v24, v24
    v_exp_f32 v25, v25
    v_exp_f32 v26, v26
    v_exp_f32 v27, v27
    v_smfmac_f32_32x32x32_bf16 v[48:63], v[76:79], v[16:23], v84
    ds_read_b64_tr_b16 v[208:209], v13 offset:0
    ds_read_b64_tr_b16 v[210:211], v13 offset:1024
    ds_read_b128 v[76:79], v87 offset:0
    buffer_load_dwordx4 v15, s[68:71], s72 offen offset:1024 sc1 lds
    v_exp_f32 v28, v28
    v_exp_f32 v29, v29
    v_exp_f32 v30, v30
    v_exp_f32 v31, v31
    s_setprio 2
    s_waitcnt lgkmcnt(3)
    v_smfmac_f32_32x32x32_bf16 v[48:63], v[80:83], v[24:31], v84
    ds_read_b128 v[80:83], v87 offset:3840
    v_exp_f32 v32, v32
    v_exp_f32 v33, v33
    v_exp_f32 v34, v34
    v_exp_f32 v35, v35
    s_waitcnt lgkmcnt(3)
    v_mfma_f32_32x32x16_bf16 v[16:31], v[72:75], v[64:67], 0
    ds_read_b128 v[72:75], v85 offset:3072
    buffer_load_dwordx4 v15, s[68:71], s72 offen offset:2048 sc1 lds
    v_exp_f32 v36, v36
    v_exp_f32 v37, v37
    v_exp_f32 v38, v38
    v_exp_f32 v39, v39
    s_waitcnt lgkmcnt(3)
    v_mfma_f32_32x32x8_bf16 v[16:31], v[70:71], v[68:69], v[16:31]
    ds_read_b32 v70, v86 offset:3072
    v_exp_f32 v40, v40
    v_exp_f32 v41, v41
    v_exp_f32 v42, v42
    v_exp_f32 v43, v43
    s_waitcnt lgkmcnt(3)
    v_smfmac_f32_32x32x32_bf16 v[48:63], v[76:79], v[32:39], v84
    ds_read_b64_tr_b16 v[212:213], v13 offset:16384
    ds_read_b64_tr_b16 v[214:215], v13 offset:17408
    ds_read_b128 v[76:79], v87 offset:3072
    s_add_u32 m0, s17, 81920
    s_nop 0
    buffer_load_dwordx4 v14, s[52:55], s75 offen offset:0 lds
    v_exp_f32 v44, v44
    v_exp_f32 v45, v45
    v_exp_f32 v46, v46
    v_exp_f32 v47, v47
    s_setprio 1
    s_waitcnt lgkmcnt(3)
    v_smfmac_f32_32x32x32_bf16 v[48:63], v[80:83], v[40:47], v84
    ds_read_b128 v[80:83], v87 offset:6912
    v_exp_f32 v16, v16
    v_exp_f32 v17, v17
    v_exp_f32 v18, v18
    v_exp_f32 v19, v19
    s_waitcnt lgkmcnt(3)
    v_mfma_f32_32x32x16_bf16 v[32:47], v[72:75], v[64:67], 0
    ds_read_b128 v[72:75], v85 offset:6144
    buffer_load_dwordx4 v9, s[52:55], s75 offen offset:1024 lds
    v_exp_f32 v20, v20
    v_exp_f32 v21, v21
    v_exp_f32 v22, v22
    v_exp_f32 v23, v23
    s_waitcnt lgkmcnt(3)
    v_mfma_f32_32x32x8_bf16 v[32:47], v[70:71], v[68:69], v[32:47]
    ds_read_b32 v70, v86 offset:6144
    v_exp_f32 v24, v24
    v_exp_f32 v25, v25
    v_exp_f32 v26, v26
    v_exp_f32 v27, v27
    s_waitcnt lgkmcnt(3)
    v_smfmac_f32_32x32x32_bf16 v[48:63], v[76:79], v[16:23], v84
    ds_read_b64_tr_b16 v[216:217], v13 offset:8192
    ds_read_b64_tr_b16 v[218:219], v13 offset:9216
    ds_read_b128 v[76:79], v87 offset:6144
    s_add_u32 m0, s17, 98304
    s_nop 0
    buffer_load_dwordx4 v14, s[56:59], s75 offen offset:0 lds
    v_exp_f32 v28, v28
    v_exp_f32 v29, v29
    v_exp_f32 v30, v30
    v_exp_f32 v31, v31
    s_setprio 0
    s_waitcnt lgkmcnt(3)
    v_smfmac_f32_32x32x32_bf16 v[48:63], v[80:83], v[24:31], v84
    ds_read_b128 v[80:83], v87 offset:9984
    v_exp_f32 v32, v32
    v_exp_f32 v33, v33
    v_exp_f32 v34, v34
    v_exp_f32 v35, v35
    s_waitcnt lgkmcnt(3)
    v_mfma_f32_32x32x16_bf16 v[16:31], v[72:75], v[64:67], 0
    ds_read_b128 v[72:75], v85 offset:9216
    buffer_load_dwordx4 v9, s[56:59], s75 offen offset:1024 lds
    v_exp_f32 v36, v36
    v_exp_f32 v37, v37
    v_exp_f32 v38, v38
    v_exp_f32 v39, v39
    s_waitcnt lgkmcnt(3)
    v_mfma_f32_32x32x8_bf16 v[16:31], v[70:71], v[68:69], v[16:31]
    ds_read_b32 v70, v86 offset:9216
    v_exp_f32 v40, v40
    v_exp_f32 v41, v41
    v_exp_f32 v42, v42
    v_exp_f32 v43, v43
    s_waitcnt lgkmcnt(3)
    v_smfmac_f32_32x32x32_bf16 v[48:63], v[76:79], v[32:39], v84
    ds_read_b64_tr_b16 v[220:221], v13 offset:24576
    ds_read_b64_tr_b16 v[222:223], v13 offset:25600
    ds_read_b128 v[76:79], v87 offset:9216
    v_exp_f32 v44, v44
    v_exp_f32 v45, v45
    v_exp_f32 v46, v46
    v_exp_f32 v47, v47
    s_waitcnt vmcnt(9) lgkmcnt(0)
    s_barrier
    s_setprio 3
    v_smfmac_f32_32x32x32_bf16 v[48:63], v[80:83], v[40:47], v84
    ds_read_b128 v[80:83], v87 offset:13056
    v_cmp_ne_u32 vcc, s8, v4
    s_cmp_eq_u64 vcc, 0
    s_cselect_b32 s7, 1, 0
    v_and_b32 v3, 0x1f0, v15
    s_movk_i32 s13, 4096
    v_exp_f32 v16, v16
    v_exp_f32 v17, v17
    v_exp_f32 v18, v18
    v_exp_f32 v19, v19
    v_mfma_f32_32x32x16_bf16 v[32:47], v[72:75], v[64:67], 0
    ds_read_b128 v[72:75], v85 offset:12288
    s_add_u32 m0, s19, 15360
    s_nop 0
    buffer_load_dwordx4 v11, s[24:27], s18 offen lds
    s_add_u32 s18, s18, 61440
    v_exp_f32 v20, v20
    v_exp_f32 v21, v21
    v_exp_f32 v22, v22
    v_exp_f32 v23, v23
    v_mfma_f32_32x32x8_bf16 v[32:47], v[70:71], v[68:69], v[32:47]
    ds_read_b32 v70, v86 offset:12288
    v_exp_f32 v24, v24
    v_exp_f32 v25, v25
    v_exp_f32 v26, v26
    v_exp_f32 v27, v27
    v_smfmac_f32_32x32x32_bf16 v[48:63], v[76:79], v[16:23], v84
    ds_read_b64_tr_b16 v[224:225], v13 offset:32768
    ds_read_b64_tr_b16 v[226:227], v13 offset:33792
    ds_read_b128 v[76:79], v87 offset:12288
    s_add_u32 m0, s19, 23040
    s_nop 0
    buffer_load_dwordx4 v11, s[24:27], s18 offen lds
    s_add_u32 s18, s18, 61440
    v_exp_f32 v28, v28
    v_exp_f32 v29, v29
    v_exp_f32 v30, v30
    v_exp_f32 v31, v31
    s_setprio 2
    s_waitcnt lgkmcnt(3)
    v_smfmac_f32_32x32x32_bf16 v[48:63], v[80:83], v[24:31], v84
WST16384:
    s_cbranch_execz WST24576
    ds_read_b128 v[80:83], v87 offset:16128
    v_exp_f32 v32, v32
    v_exp_f32 v33, v33
    v_exp_f32 v34, v34
    v_exp_f32 v35, v35
    s_waitcnt lgkmcnt(3)
    v_mfma_f32_32x32x16_bf16 v[16:31], v[72:75], v[64:67], 0
    ds_read_b128 v[72:75], v85 offset:15360
    s_add_u32 m0, s19, 30720
    s_nop 0
    buffer_load_dwordx4 v11, s[24:27], s18 offen lds
    s_add_u32 s18, s18, 61440
    v_exp_f32 v36, v36
    v_exp_f32 v37, v37
    v_exp_f32 v38, v38
    v_exp_f32 v39, v39
    s_waitcnt lgkmcnt(3)
    v_mfma_f32_32x32x8_bf16 v[16:31], v[70:71], v[68:69], v[16:31]
    ds_read_b32 v70, v86 offset:15360
    v_exp_f32 v40, v40
    v_exp_f32 v41, v41
    v_exp_f32 v42, v42
    v_exp_f32 v43, v43
    s_waitcnt lgkmcnt(3)
    v_smfmac_f32_32x32x32_bf16 v[48:63], v[76:79], v[32:39], v84
    ds_read_b64_tr_b16 v[228:229], v13 offset:49152
    ds_read_b64_tr_b16 v[230:231], v13 offset:50176
    ds_read_b128 v[76:79], v87 offset:15360
    s_add_u32 m0, s19, 38400
    s_nop 0
    buffer_load_dwordx4 v11, s[24:27], s18 offen lds
    s_add_u32 s18, s18, 61440
    v_exp_f32 v44, v44
    v_exp_f32 v45, v45
    v_exp_f32 v46, v46
    v_exp_f32 v47, v47
    s_setprio 1
    s_waitcnt lgkmcnt(3)
    v_smfmac_f32_32x32x32_bf16 v[48:63], v[80:83], v[40:47], v84
    ds_read_b128 v[80:83], v87 offset:19200
    v_exp_f32 v16, v16
    v_exp_f32 v17, v17
    v_exp_f32 v18, v18
    v_exp_f32 v19, v19
    s_waitcnt lgkmcnt(3)
    v_mfma_f32_32x32x16_bf16 v[32:47], v[72:75], v[64:67], 0
    ds_read_b128 v[72:75], v85 offset:18432
    buffer_load_dwordx2 v[88:89], v2, s[40:43], s15 offen offset:0
    v_exp_f32 v20, v20
    v_exp_f32 v21, v21
    v_exp_f32 v22, v22
    v_exp_f32 v23, v23
    s_waitcnt lgkmcnt(3)
    v_mfma_f32_32x32x8_bf16 v[32:47], v[70:71], v[68:69], v[32:47]
    ds_read_b32 v70, v86 offset:18432
    v_exp_f32 v24, v24
    v_exp_f32 v25, v25
    v_exp_f32 v26, v26
    v_exp_f32 v27, v27
    s_waitcnt lgkmcnt(3)
    v_smfmac_f32_32x32x32_bf16 v[48:63], v[76:79], v[16:23], v84
    ds_read_b64_tr_b16 v[232:233], v13 offset:40960
    ds_read_b64_tr_b16 v[234:235], v13 offset:41984
    ds_read_b128 v[76:79], v87 offset:18432
    v_exp_f32 v28, v28
    v_exp_f32 v29, v29
    v_exp_f32 v30, v30
    v_exp_f32 v31, v31
    s_setprio 0
    s_waitcnt lgkmcnt(3)
    v_smfmac_f32_32x32x32_bf16 v[48:63], v[80:83], v[24:31], v84
    ds_read_b128 v[80:83], v87 offset:22272
    v_exp_f32 v32, v32
    v_exp_f32 v33, v33
    v_exp_f32 v34, v34
    v_exp_f32 v35, v35
    s_waitcnt lgkmcnt(3)
    v_mfma_f32_32x32x16_bf16 v[16:31], v[72:75], v[64:67], 0
    ds_read_b128 v[72:75], v85 offset:21504
    buffer_load_dwordx2 v[90:91], v2, s[40:43], s15 offen offset:32
    v_exp_f32 v36, v36
    v_exp_f32 v37, v37
    v_exp_f32 v38, v38
    v_exp_f32 v39, v39
    s_waitcnt lgkmcnt(3)
    v_mfma_f32_32x32x8_bf16 v[16:31], v[70:71], v[68:69], v[16:31]
    ds_read_b32 v70, v86 offset:21504
    v_exp_f32 v40, v40
    v_exp_f32 v41, v41
    v_exp_f32 v42, v42
    v_exp_f32 v43, v43
    s_waitcnt lgkmcnt(3)
    v_smfmac_f32_32x32x32_bf16 v[48:63], v[76:79], v[32:39], v84
    ds_read_b64_tr_b16 v[236:237], v13 offset:57344
    ds_read_b64_tr_b16 v[238:239], v13 offset:58368
    ds_read_b128 v[76:79], v87 offset:21504
    v_exp_f32 v44, v44
    v_exp_f32 v45, v45
    v_exp_f32 v46, v46
    v_exp_f32 v47, v47
    s_waitcnt vmcnt(6) lgkmcnt(0)
    s_barrier
    s_setprio 3
    v_smfmac_f32_32x32x32_bf16 v[48:63], v[80:83], v[40:47], v84
    ds_read_b128 v[80:83], v87 offset:25344
    s_mul_i32 s15, s16, 1280
    s_add_u32 s15, s15, s79
    s_add_u32 s15, s15, 36864
    s_lshl2_add_u32 s16, s16, s79
    v_lshlrev_b32 v8, 3, v1
    v_exp_f32 v16, v16
    v_exp_f32 v17, v17
    v_exp_f32 v18, v18
    v_exp_f32 v19, v19
    v_mfma_f32_32x32x16_bf16 v[32:47], v[72:75], v[64:67], 0
    ds_read_b128 v[72:75], v85 offset:24576
    buffer_load_dword v4, v3, s[68:71], s13 offen sc1
    v_exp_f32 v20, v20
    v_exp_f32 v21, v21
    v_exp_f32 v22, v22
    v_exp_f32 v23, v23
    v_mfma_f32_32x32x8_bf16 v[32:47], v[70:71], v[68:69], v[32:47]
    ds_read_b32 v70, v86 offset:24576
    v_exp_f32 v24, v24
    v_exp_f32 v25, v25
    v_exp_f32 v26, v26
    v_exp_f32 v27, v27
    v_smfmac_f32_32x32x32_bf16 v[48:63], v[76:79], v[16:23], v84
    ds_read_b64_tr_b16 v[240:241], v12 offset:0
    ds_read_b64_tr_b16 v[242:243], v12 offset:1024
    ds_read_b128 v[76:79], v87 offset:24576
    s_add_u32 s72, s72, 32768
    s_bitset0_b32 s72, 18
    s_add_u32 m0, s73, 114688
    s_nop 0
    buffer_load_dwordx4 v15, s[68:71], s72 offen offset:0 sc1 lds
    v_exp_f32 v28, v28
    v_exp_f32 v29, v29
    v_exp_f32 v30, v30
    v_exp_f32 v31, v31
    s_setprio 2
    s_waitcnt lgkmcnt(3)
    v_smfmac_f32_32x32x32_bf16 v[48:63], v[80:83], v[24:31], v84
    ds_read_b128 v[80:83], v87 offset:28416
    v_exp_f32 v32, v32
    v_exp_f32 v33, v33
    v_exp_f32 v34, v34
    v_exp_f32 v35, v35
    s_waitcnt lgkmcnt(3)
    v_mfma_f32_32x32x16_bf16 v[16:31], v[72:75], v[64:67], 0
    ds_read_b128 v[72:75], v85 offset:27648
    buffer_load_dwordx4 v15, s[68:71], s72 offen offset:1024 sc1 lds
    v_exp_f32 v36, v36
    v_exp_f32 v37, v37
    v_exp_f32 v38, v38
    v_exp_f32 v39, v39
    s_waitcnt lgkmcnt(3)
    v_mfma_f32_32x32x8_bf16 v[16:31], v[70:71], v[68:69], v[16:31]
    ds_read_b32 v70, v86 offset:27648
    v_exp_f32 v40, v40
    v_exp_f32 v41, v41
    v_exp_f32 v42, v42
    v_exp_f32 v43, v43
    s_waitcnt lgkmcnt(3)
    v_smfmac_f32_32x32x32_bf16 v[48:63], v[76:79], v[32:39], v84
    ds_read_b64_tr_b16 v[244:245], v12 offset:16384
    ds_read_b64_tr_b16 v[246:247], v12 offset:17408
    ds_read_b128 v[76:79], v87 offset:27648
    buffer_load_dwordx4 v15, s[68:71], s72 offen offset:2048 sc1 lds
    v_exp_f32 v44, v44
    v_exp_f32 v45, v45
    v_exp_f32 v46, v46
    v_exp_f32 v47, v47
    s_setprio 1
    s_waitcnt lgkmcnt(3)
    v_smfmac_f32_32x32x32_bf16 v[48:63], v[80:83], v[40:47], v84
    ds_read_b128 v[80:83], v87 offset:31488
    v_exp_f32 v16, v16
    v_exp_f32 v17, v17
    v_exp_f32 v18, v18
    v_exp_f32 v19, v19
    s_waitcnt lgkmcnt(3)
    v_mfma_f32_32x32x16_bf16 v[32:47], v[72:75], v[64:67], 0
    ds_read_b128 v[72:75], v85 offset:30720
    s_add_u32 m0, s19, 46080
    s_nop 0
    buffer_load_dwordx4 v11, s[24:27], s18 offen lds
    s_add_u32 s18, s18, 61440
    v_exp_f32 v20, v20
    v_exp_f32 v21, v21
    v_exp_f32 v22, v22
    v_exp_f32 v23, v23
    s_waitcnt lgkmcnt(3)
    v_mfma_f32_32x32x8_bf16 v[32:47], v[70:71], v[68:69], v[32:47]
    ds_read_b32 v70, v86 offset:30720
    v_exp_f32 v24, v24
    v_exp_f32 v25, v25
    v_exp_f32 v26, v26
    v_exp_f32 v27, v27
    s_waitcnt lgkmcnt(3)
    v_smfmac_f32_32x32x32_bf16 v[48:63], v[76:79], v[16:23], v84
    ds_read_b64_tr_b16 v[248:249], v12 offset:8192
    ds_read_b64_tr_b16 v[250:251], v12 offset:9216
    ds_read_b128 v[76:79], v87 offset:30720
    s_add_u32 m0, s19, 53760
    s_nop 0
    buffer_load_dwordx4 v11, s[24:27], s18 offen lds
    s_add_u32 s18, s18, 61440
    v_exp_f32 v28, v28
    v_exp_f32 v29, v29
    v_exp_f32 v30, v30
    v_exp_f32 v31, v31
    s_setprio 0
    s_waitcnt lgkmcnt(3)
    v_smfmac_f32_32x32x32_bf16 v[48:63], v[80:83], v[24:31], v84
    ds_read_b128 v[80:83], v87 offset:34560
    v_exp_f32 v32, v32
    v_exp_f32 v33, v33
    v_exp_f32 v34, v34
    v_exp_f32 v35, v35
    s_waitcnt lgkmcnt(3)
    v_mfma_f32_32x32x16_bf16 v[16:31], v[72:75], v[64:67], 0
    ds_read_b128 v[72:75], v85 offset:33792
    s_add_u32 m0, s19, 61440
    s_nop 0
    buffer_load_dwordx4 v11, s[24:27], s18 offen lds
    s_add_u32 s18, s18, 61440
    v_exp_f32 v36, v36
    v_exp_f32 v37, v37
    v_exp_f32 v38, v38
    v_exp_f32 v39, v39
    s_waitcnt lgkmcnt(3)
    v_mfma_f32_32x32x8_bf16 v[16:31], v[70:71], v[68:69], v[16:31]
    ds_read_b32 v70, v86 offset:33792
    v_exp_f32 v40, v40
    v_exp_f32 v41, v41
    v_exp_f32 v42, v42
    v_exp_f32 v43, v43
    s_waitcnt lgkmcnt(3)
    v_smfmac_f32_32x32x32_bf16 v[48:63], v[76:79], v[32:39], v84
    ds_read_b64_tr_b16 v[252:253], v12 offset:24576
    ds_read_b64_tr_b16 v[254:255], v12 offset:25600
    ds_read_b128 v[76:79], v87 offset:33792
    s_add_u32 m0, s19, 69120
    s_nop 0
    buffer_load_dwordx4 v11, s[24:27], s18 offen lds
    s_add_u32 s18, s18, 61440
    v_exp_f32 v44, v44
    v_exp_f32 v45, v45
    v_exp_f32 v46, v46
    v_exp_f32 v47, v47
    s_waitcnt lgkmcnt(0)
    s_barrier
    s_setprio 3
    v_smfmac_f32_32x32x32_bf16 v[48:63], v[80:83], v[40:47], v84
    ds_read_b128 v[80:83], v87 offset:37632
    v_exp_f32 v16, v16
    v_exp_f32 v17, v17
    v_exp_f32 v18, v18
    v_exp_f32 v19, v19
    v_mfma_f32_32x32x16_bf16 v[32:47], v[72:75], v[64:67], 0
    ds_read_b128 v[72:75], v85 offset:36864
    s_add_u32 m0, s19, 76800
    s_nop 0
    buffer_load_dwordx4 v11, s[24:27], s18 offen lds
    s_add_u32 s18, s18, 61440
    v_exp_f32 v20, v20
    v_exp_f32 v21, v21
    v_exp_f32 v22, v22
    v_exp_f32 v23, v23
    v_mfma_f32_32x32x8_bf16 v[32:47], v[70:71], v[68:69], v[32:47]
    ds_read_b32 v70, v86 offset:36864
    v_exp_f32 v24, v24
    v_exp_f32 v25, v25
    v_exp_f32 v26, v26
    v_exp_f32 v27, v27
    v_smfmac_f32_32x32x32_bf16 v[48:63], v[76:79], v[16:23], v84
    ds_read_b128 v[76:79], v87 offset:36864
    s_add_u32 m0, s19, 84480
    s_nop 0
    buffer_load_dwordx4 v11, s[24:27], s18 offen lds
    s_add_u32 s18, s18, 61440
    v_exp_f32 v28, v28
    v_exp_f32 v29, v29
    v_exp_f32 v30, v30
    v_exp_f32 v31, v31
    s_setprio 2
    s_waitcnt lgkmcnt(3)
    v_smfmac_f32_32x32x32_bf16 v[48:63], v[80:83], v[24:31], v84
    ds_read_b128 v[80:83], v87 offset:40704
    v_exp_f32 v32, v32
    v_exp_f32 v33, v33
    v_exp_f32 v34, v34
    v_exp_f32 v35, v35
    s_waitcnt lgkmcnt(3)
    v_mfma_f32_32x32x16_bf16 v[16:31], v[72:75], v[64:67], 0
    ds_read_b128 v[72:75], v85 offset:39936
    s_add_u32 m0, s19, 92160
    s_nop 0
    buffer_load_dwordx4 v11, s[24:27], s18 offen lds
    s_add_u32 s18, s18, 61440
    v_exp_f32 v36, v36
    v_exp_f32 v37, v37
    v_exp_f32 v38, v38
    v_exp_f32 v39, v39
    s_waitcnt lgkmcnt(3)
    v_mfma_f32_32x32x8_bf16 v[16:31], v[70:71], v[68:69], v[16:31]
    ds_read_b32 v70, v86 offset:39936
    v_exp_f32 v40, v40
    v_exp_f32 v41, v41
    v_exp_f32 v42, v42
    v_exp_f32 v43, v43
    s_waitcnt lgkmcnt(3)
    v_smfmac_f32_32x32x32_bf16 v[48:63], v[76:79], v[32:39], v84
    ds_read_b128 v[76:79], v87 offset:39936
    s_add_u32 m0, s19, 99840
    s_nop 0
    buffer_load_dwordx4 v11, s[24:27], s18 offen lds
    s_add_u32 s18, s18, 61440
    v_exp_f32 v44, v44
    v_exp_f32 v45, v45
    v_exp_f32 v46, v46
    v_exp_f32 v47, v47
    s_setprio 1
    s_waitcnt lgkmcnt(3)
    v_smfmac_f32_32x32x32_bf16 v[48:63], v[80:83], v[40:47], v84
    ds_read_b128 v[80:83], v87 offset:43776
    v_exp_f32 v16, v16
    v_exp_f32 v17, v17
    v_exp_f32 v18, v18
    v_exp_f32 v19, v19
    s_waitcnt lgkmcnt(3)
    v_mfma_f32_32x32x16_bf16 v[32:47], v[72:75], v[64:67], 0
    ds_read_b128 v[72:75], v85 offset:43008
    s_mov_b64 exec, 0x1fff
    buffer_load_dwordx2 v[6:7], v10, s[68:71], s14 offen offset:124 sc1
    s_mov_b64 exec, -1
    v_exp_f32 v20, v20
    v_exp_f32 v21, v21
    v_exp_f32 v22, v22
    v_exp_f32 v23, v23
    s_waitcnt lgkmcnt(3)
    v_mfma_f32_32x32x8_bf16 v[32:47], v[70:71], v[68:69], v[32:47]
    ds_read_b32 v70, v86 offset:43008
    v_exp_f32 v24, v24
    v_exp_f32 v25, v25
    v_exp_f32 v26, v26
    v_exp_f32 v27, v27
    s_waitcnt lgkmcnt(3)
    v_smfmac_f32_32x32x32_bf16 v[48:63], v[76:79], v[16:23], v84
    ds_read_b128 v[76:79], v87 offset:43008
    v_exp_f32 v28, v28
    v_exp_f32 v29, v29
    v_exp_f32 v30, v30
    v_exp_f32 v31, v31
    s_setprio 0
    s_waitcnt lgkmcnt(3)
    v_smfmac_f32_32x32x32_bf16 v[48:63], v[80:83], v[24:31], v84
    ds_read_b128 v[80:83], v87 offset:46848
    v_exp_f32 v32, v32
    v_exp_f32 v33, v33
    v_exp_f32 v34, v34
    v_exp_f32 v35, v35
    s_waitcnt lgkmcnt(3)
    v_mfma_f32_32x32x16_bf16 v[16:31], v[72:75], v[64:67], 0
    ds_read_b128 v[72:75], v85 offset:46080
    v_exp_f32 v36, v36
    v_exp_f32 v37, v37
    v_exp_f32 v38, v38
    v_exp_f32 v39, v39
    s_waitcnt lgkmcnt(3)
    v_mfma_f32_32x32x8_bf16 v[16:31], v[70:71], v[68:69], v[16:31]
    ds_read_b32 v70, v86 offset:46080
    v_exp_f32 v40, v40
    v_exp_f32 v41, v41
    v_exp_f32 v42, v42
    v_exp_f32 v43, v43
    s_waitcnt lgkmcnt(3)
    v_smfmac_f32_32x32x32_bf16 v[48:63], v[76:79], v[32:39], v84
    ds_read_b128 v[76:79], v87 offset:46080
    v_exp_f32 v44, v44
    v_exp_f32 v45, v45
    v_exp_f32 v46, v46
    v_exp_f32 v47, v47
    s_waitcnt vmcnt(9) lgkmcnt(0)
    s_barrier
    s_setprio 3
    v_smfmac_f32_32x32x32_bf16 v[48:63], v[80:83], v[40:47], v84
    ds_read_b128 v[80:83], v87 offset:768
    v_cmp_ne_u32 vcc, s4, v4
    s_cbranch_vccnz W2C_5
W2CB_6:
    v_exp_f32 v16, v16
    v_exp_f32 v17, v17
    v_exp_f32 v18, v18
    v_exp_f32 v19, v19
    v_mfma_f32_32x32x16_bf16 v[32:47], v[72:75], v[64:67], 0
    ds_read_b128 v[72:75], v85 offset:0
    v_exp_f32 v20, v20
    v_exp_f32 v21, v21
    v_exp_f32 v22, v22
    v_exp_f32 v23, v23
    v_mfma_f32_32x32x8_bf16 v[32:47], v[70:71], v[68:69], v[32:47]
    ds_read_b32 v70, v86 offset:0
    v_exp_f32 v24, v24
    v_exp_f32 v25, v25
    v_exp_f32 v26, v26
    v_exp_f32 v27, v27
    v_smfmac_f32_32x32x32_bf16 v[48:63], v[76:79], v[16:23], v84
    ds_read_b128 v[76:79], v87 offset:0
    v_exp_f32 v28, v28
    v_exp_f32 v29, v29
    v_exp_f32 v30, v30
    v_exp_f32 v31, v31
    s_setprio 2
    s_waitcnt lgkmcnt(3)
    v_smfmac_f32_32x32x32_bf16 v[48:63], v[80:83], v[24:31], v84
    ds_read_b128 v[80:83], v87 offset:3840
    v_exp_f32 v32, v32
    v_exp_f32 v33, v33
    v_exp_f32 v34, v34
    v_exp_f32 v35, v35
    s_waitcnt lgkmcnt(3)
    v_mfma_f32_32x32x16_bf16 v[16:31], v[72:75], v[64:67], 0
    ds_read_b128 v[72:75], v85 offset:3072
    v_exp_f32 v36, v36
    v_exp_f32 v37, v37
    v_exp_f32 v38, v38
    v_exp_f32 v39, v39
    s_waitcnt lgkmcnt(3)
    v_mfma_f32_32x32x8_bf16 v[16:31], v[70:71], v[68:69], v[16:31]
    ds_read_b32 v70, v86 offset:3072
    v_exp_f32 v40, v40
    v_exp_f32 v41, v41
    v_exp_f32 v42, v42
    v_exp_f32 v43, v43
    s_waitcnt lgkmcnt(3)
    v_smfmac_f32_32x32x32_bf16 v[48:63], v[76:79], v[32:39], v84
    ds_read_b128 v[76:79], v87 offset:3072
    v_exp_f32 v44, v44
    v_exp_f32 v45, v45
    v_exp_f32 v46, v46
    v_exp_f32 v47, v47
    s_setprio 1
    s_waitcnt lgkmcnt(3)
    v_smfmac_f32_32x32x32_bf16 v[48:63], v[80:83], v[40:47], v84
    ds_read_b128 v[80:83], v87 offset:6912
    v_exp_f32 v16, v16
    v_exp_f32 v17, v17
    v_exp_f32 v18, v18
    v_exp_f32 v19, v19
    s_waitcnt lgkmcnt(3)
    v_mfma_f32_32x32x16_bf16 v[32:47], v[72:75], v[64:67], 0
    ds_read_b128 v[72:75], v85 offset:6144
    v_exp_f32 v20, v20
    v_exp_f32 v21, v21
    v_exp_f32 v22, v22
    v_exp_f32 v23, v23
    s_waitcnt lgkmcnt(3)
    v_mfma_f32_32x32x8_bf16 v[32:47], v[70:71], v[68:69], v[32:47]
    ds_read_b32 v70, v86 offset:6144
    v_exp_f32 v24, v24
    v_exp_f32 v25, v25
    v_exp_f32 v26, v26
    v_exp_f32 v27, v27
    s_waitcnt lgkmcnt(3)
    v_smfmac_f32_32x32x32_bf16 v[48:63], v[76:79], v[16:23], v84
    ds_read_b128 v[76:79], v87 offset:6144
    v_exp_f32 v28, v28
    v_exp_f32 v29, v29
    v_exp_f32 v30, v30
    v_exp_f32 v31, v31
    s_setprio 0
    s_waitcnt lgkmcnt(3)
    v_smfmac_f32_32x32x32_bf16 v[48:63], v[80:83], v[24:31], v84
    ds_read_b128 v[80:83], v87 offset:9984
    v_exp_f32 v32, v32
    v_exp_f32 v33, v33
    v_exp_f32 v34, v34
    v_exp_f32 v35, v35
    s_waitcnt lgkmcnt(3)
    v_mfma_f32_32x32x16_bf16 v[16:31], v[72:75], v[64:67], 0
    ds_read_b128 v[72:75], v85 offset:9216
    v_exp_f32 v36, v36
    v_exp_f32 v37, v37
    v_exp_f32 v38, v38
    v_exp_f32 v39, v39
    s_waitcnt lgkmcnt(3)
    v_mfma_f32_32x32x8_bf16 v[16:31], v[70:71], v[68:69], v[16:31]
    ds_read_b32 v70, v86 offset:9216
    v_exp_f32 v40, v40
    v_exp_f32 v41, v41
    v_exp_f32 v42, v42
    v_exp_f32 v43, v43
    s_waitcnt lgkmcnt(3)
    v_smfmac_f32_32x32x32_bf16 v[48:63], v[76:79], v[32:39], v84
    ds_read_b128 v[76:79], v87 offset:9216
    v_exp_f32 v44, v44
    v_exp_f32 v45, v45
    v_exp_f32 v46, v46
    v_exp_f32 v47, v47
    s_waitcnt lgkmcnt(0)
    s_barrier
    s_setprio 3
    v_smfmac_f32_32x32x32_bf16 v[48:63], v[80:83], v[40:47], v84
    ds_read_b128 v[80:83], v87 offset:13056
    v_exp_f32 v16, v16
    v_exp_f32 v17, v17
    v_exp_f32 v18, v18
    v_exp_f32 v19, v19
    v_mfma_f32_32x32x16_bf16 v[32:47], v[72:75], v[64:67], 0
    ds_read_b128 v[72:75], v85 offset:12288
    v_exp_f32 v20, v20
    v_exp_f32 v21, v21
    v_exp_f32 v22, v22
    v_exp_f32 v23, v23
    v_mfma_f32_32x32x8_bf16 v[32:47], v[70:71], v[68:69], v[32:47]
    ds_read_b32 v70, v86 offset:12288
    v_exp_f32 v24, v24
    v_exp_f32 v25, v25
    v_exp_f32 v26, v26
    v_exp_f32 v27, v27
    v_smfmac_f32_32x32x32_bf16 v[48:63], v[76:79], v[16:23], v84
    ds_read_b128 v[76:79], v87 offset:12288
    v_exp_f32 v28, v28
    v_exp_f32 v29, v29
    v_exp_f32 v30, v30
    v_exp_f32 v31, v31
    s_setprio 2
    s_waitcnt lgkmcnt(3)
    v_smfmac_f32_32x32x32_bf16 v[48:63], v[80:83], v[24:31], v84
    ds_read_b128 v[80:83], v87 offset:16128
    v_exp_f32 v32, v32
    v_exp_f32 v33, v33
    v_exp_f32 v34, v34
    v_exp_f32 v35, v35
    s_waitcnt lgkmcnt(3)
    v_mfma_f32_32x32x16_bf16 v[16:31], v[72:75], v[64:67], 0
    ds_read_b128 v[72:75], v85 offset:15360
    v_exp_f32 v36, v36
    v_exp_f32 v37, v37
    v_exp_f32 v38, v38
    v_exp_f32 v39, v39
    s_waitcnt lgkmcnt(3)
    v_mfma_f32_32x32x8_bf16 v[16:31], v[70:71], v[68:69], v[16:31]
    ds_read_b32 v70, v86 offset:15360
    v_exp_f32 v40, v40
    v_exp_f32 v41, v41
    v_exp_f32 v42, v42
    v_exp_f32 v43, v43
    s_waitcnt lgkmcnt(3)
    v_smfmac_f32_32x32x32_bf16 v[48:63], v[76:79], v[32:39], v84
    ds_read_b128 v[76:79], v87 offset:15360
    v_exp_f32 v44, v44
    v_exp_f32 v45, v45
    v_exp_f32 v46, v46
    v_exp_f32 v47, v47
    s_setprio 1
    s_waitcnt lgkmcnt(3)
    v_smfmac_f32_32x32x32_bf16 v[48:63], v[80:83], v[40:47], v84
    ds_read_b128 v[80:83], v87 offset:19200
    v_exp_f32 v16, v16
    v_exp_f32 v17, v17
    v_exp_f32 v18, v18
    v_exp_f32 v19, v19
    s_waitcnt lgkmcnt(3)
    v_mfma_f32_32x32x16_bf16 v[32:47], v[72:75], v[64:67], 0
    ds_read_b128 v[72:75], v85 offset:18432
    v_exp_f32 v20, v20
    v_exp_f32 v21, v21
    v_exp_f32 v22, v22
    v_exp_f32 v23, v23
    s_waitcnt lgkmcnt(3)
    v_mfma_f32_32x32x8_bf16 v[32:47], v[70:71], v[68:69], v[32:47]
    ds_read_b32 v70, v86 offset:18432
    v_exp_f32 v24, v24
    v_exp_f32 v25, v25
    v_exp_f32 v26, v26
    v_exp_f32 v27, v27
    s_waitcnt lgkmcnt(3)
    v_smfmac_f32_32x32x32_bf16 v[48:63], v[76:79], v[16:23], v84
    ds_read_b128 v[76:79], v87 offset:18432
    v_exp_f32 v28, v28
    v_exp_f32 v29, v29
    v_exp_f32 v30, v30
    v_exp_f32 v31, v31
    s_waitcnt lgkmcnt(3)
    s_nop 0
    v_smfmac_f32_32x32x32_bf16 v[48:63], v[80:83], v[24:31], v84
    ds_read_b128 v[80:83], v87 offset:22272
    v_exp_f32 v32, v32
    v_exp_f32 v33, v33
    v_exp_f32 v34, v34
    v_exp_f32 v35, v35
    v_exp_f32 v36, v36
    v_exp_f32 v37, v37
    v_exp_f32 v38, v38
    v_exp_f32 v39, v39
    v_exp_f32 v40, v40
    v_exp_f32 v41, v41
    v_exp_f32 v42, v42
    v_exp_f32 v43, v43
    s_waitcnt lgkmcnt(1)
    v_smfmac_f32_32x32x32_bf16 v[48:63], v[76:79], v[32:39], v84
    v_exp_f32 v44, v44
    v_exp_f32 v45, v45
    v_exp_f32 v46, v46
    v_exp_f32 v47, v47
P2E:
WST19601:
    s_cbranch_execz WST8192
    s_waitcnt lgkmcnt(0)
    s_nop 0
    v_smfmac_f32_32x32x32_bf16 v[48:63], v[80:83], v[40:47], v84
O_EPI:
    s_mov_b32 s12, 0x53800000
    v_mov_b32 v4, 0
    v_mov_b32 v5, 0
    s_nop 8
    v_rcp_f32 v2, v60
    v_pk_fma_f32 v[4:5], v[48:49], 0, v[4:5]
    v_pk_fma_f32 v[4:5], v[50:51], 0, v[4:5]
    v_pk_fma_f32 v[4:5], v[52:53], 0, v[4:5]
    v_pk_fma_f32 v[4:5], v[54:55], 0, v[4:5]
    v_pk_fma_f32 v[4:5], v[56:57], 0, v[4:5]
    v_pk_fma_f32 v[4:5], v[58:59], 0, v[4:5]
    v_add_f32 v4, v4, v5
    v_add_f32 v4, v4, v60
    v_cmp_nlt_f32 vcc, v4, s12
    v_pk_mul_f32 v[16:17], v[48:49], v[2:3] op_sel_hi:[1,0]
    v_cvt_pk_bf16_f32 v32, v16, v17
    v_pk_mul_f32 v[18:19], v[50:51], v[2:3] op_sel_hi:[1,0]
    v_cvt_pk_bf16_f32 v33, v18, v19
    v_pk_mul_f32 v[20:21], v[52:53], v[2:3] op_sel_hi:[1,0]
    v_cvt_pk_bf16_f32 v34, v20, v21
    v_pk_mul_f32 v[22:23], v[54:55], v[2:3] op_sel_hi:[1,0]
    v_cvt_pk_bf16_f32 v35, v22, v23
    v_pk_mul_f32 v[24:25], v[56:57], v[2:3] op_sel_hi:[1,0]
    v_cvt_pk_bf16_f32 v36, v24, v25
    v_pk_mul_f32 v[26:27], v[58:59], v[2:3] op_sel_hi:[1,0]
    v_cvt_pk_bf16_f32 v37, v26, v27
    s_cbranch_vccnz FALLBACK
O_ST:
    s_cmp_eq_u32 s7, 0
    s_cbranch_scc1 XS_7
    buffer_store_dwordx4 v[32:35], v15, s[68:71], s15 offen
    s_mov_b32 exec_hi, 0
    buffer_store_dwordx2 v[36:37], v8, s[68:71], s15 offen offset:1024
    s_mov_b32 exec_hi, -1
XB_8:
    s_setprio 0
    v_mov_b32 v76, 0x3f803f80
    v_mov_b32 v77, 0x3f803f80
    v_mov_b32 v78, 0x3f803f80
    v_mov_b32 v79, 0x3f803f80
    s_nop 1
    v_mfma_f32_16x16x32_bf16 v[64:67], v[96:99], v[76:79], 0
    v_mov_b32 v38, s4
    s_and_b32 s17, s6, 1
    s_bfe_u32 s11, s39, 0x10001
    s_lshl1_add_u32 s11, s17, s11
    v_mfma_f32_16x16x32_bf16 v[68:71], v[100:103], v[76:79], 0
    s_lshr_b32 s12, s39, 2
    s_lshl1_add_u32 s11, s11, s12
    s_lshl_b32 s19, s11, 6
    s_add_u32 s19, s19, s79
    s_mul_i32 s18, s11, 20480
    v_mfma_f32_16x16x32_bf16 v[64:67], v[104:107], v[76:79], v[64:67]
    s_add_u32 s18, s18, s79
    s_add_u32 s18, s18, 36864
    s_and_b32 s13, s39, 1
    v_lshrrev_b32 v4, 4, v1
    v_mfma_f32_16x16x32_bf16 v[68:71], v[108:111], v[76:79], v[68:71]
    v_lshrrev_b32 v5, 5, v1
    v_bfe_u32 v10, v1, 4, 1
    v_and_b32 v11, 15, v1
    v_lshl_add_u32 v8, s13, 4, v11
    v_mul_u32_u24 v12, 1280, v5
    v_mfma_f32_16x16x32_bf16 v[64:67], v[112:115], v[76:79], v[64:67]
    v_lshl_add_u32 v12, v10, 9, v12
    v_lshl_add_u32 v12, v8, 4, v12
    v_mul_u32_u24 v13, 1280, v4
    v_lshl_add_u32 v13, v8, 3, v13
    v_bfe_u32 v8, v1, 2, 2
    v_mfma_f32_16x16x32_bf16 v[68:71], v[116:119], v[76:79], v[68:71]
    v_and_b32 v9, 3, v1
    s_mul_i32 s14, s12, 96
    s_mul_i32 s12, s12, 51200
    v_lshl_add_u32 v9, v9, 3, s12
    v_mfma_f32_16x16x32_bf16 v[64:67], v[120:123], v[76:79], v[64:67]
    v_mad_u32_u24 v2, v5, 20, v8
    v_lshl_add_u32 v2, v10, 2, v2
    s_movk_i32 s11, 160
    v_mad_u32_u24 v2, v2, s11, v9
    v_mad_u32_u24 v3, v4, 20, v8
    v_mfma_f32_16x16x32_bf16 v[68:71], v[124:127], v[76:79], v[68:71]
    v_mad_u32_u24 v3, v3, s11, v9
    v_sub_u32 v3, v3, v2
    v_add_u32 v0, s14, v2
    v_subrev_u32 v14, s14, v2
    v_lshlrev_b32 v37, 2, v11
    s_waitcnt vmcnt(0)
    s_mov_b64 exec, 1
    s_cmp_eq_u32 s7, 0
    s_cbranch_scc1 XS_9
    buffer_store_dword v38, v15, s[68:71], s16 offen offset:0
XB_10:
    s_mov_b64 exec, -1
    s_barrier
    buffer_load_dword v36, v37, s[68:71], s19 offen sc1
    s_setprio 3
    v_mfma_f32_16x16x32_bf16 v[64:67], v[128:131], v[76:79], v[64:67]
    ds_read_b64_tr_b16 v[16:17], v0 offset:0
    ds_read_b64_tr_b16 v[18:19], v0 offset:1280
    ds_read_b64_tr_b16 v[20:21], v0 offset:32
    ds_read_b64_tr_b16 v[22:23], v0 offset:1312
    v_mfma_f32_16x16x32_bf16 v[68:71], v[132:135], v[76:79], v[68:71]
    ds_read_b64_tr_b16 v[24:25], v2 offset:64
    ds_read_b64_tr_b16 v[26:27], v2 offset:1344
    ds_read_b64_tr_b16 v[28:29], v14 offset:96
    ds_read_b64_tr_b16 v[30:31], v14 offset:1376
    v_mfma_f32_16x16x32_bf16 v[64:67], v[136:139], v[76:79], v[64:67]
    ds_read_b64_tr_b16 v[32:33], v14 offset:128
    ds_read_b64_tr_b16 v[34:35], v14 offset:1408
    ds_read_b64_tr_b16 v[4:5], v0 offset:6400
    ds_read_b64_tr_b16 v[6:7], v0 offset:7680
    v_mfma_f32_16x16x32_bf16 v[68:71], v[140:143], v[76:79], v[68:71]
    ds_read_b64_tr_b16 v[8:9], v0 offset:6432
    ds_read_b64_tr_b16 v[10:11], v0 offset:7712
    ds_read_b64_tr_b16 v[52:53], v2 offset:6464
    ds_read_b64_tr_b16 v[54:55], v2 offset:7744
    v_mfma_f32_16x16x32_bf16 v[64:67], v[144:147], v[76:79], v[64:67]
    ds_read_b64_tr_b16 v[56:57], v14 offset:6496
    ds_read_b64_tr_b16 v[58:59], v14 offset:7776
    ds_read_b64_tr_b16 v[60:61], v14 offset:6528
    ds_read_b64_tr_b16 v[62:63], v14 offset:7808
    v_mfma_f32_16x16x32_bf16 v[68:71], v[148:151], v[76:79], v[68:71]
    ds_read_b64_tr_b16 v[72:73], v0 offset:12800
    ds_read_b64_tr_b16 v[74:75], v0 offset:14080
    ds_read_b64_tr_b16 v[80:81], v0 offset:12832
    ds_read_b64_tr_b16 v[82:83], v0 offset:14112
WST20480:
    s_cbranch_execz WST28672
    v_mfma_f32_16x16x32_bf16 v[64:67], v[152:155], v[76:79], v[64:67]
    ds_read_b64_tr_b16 v[84:85], v2 offset:12864
    ds_read_b64_tr_b16 v[86:87], v2 offset:14144
    s_add_u32 s36, s18, 5120
    v_mfma_f32_16x16x32_bf16 v[68:71], v[156:159], v[76:79], v[68:71]
    s_add_u32 s37, s18, 10240
    s_add_u32 s38, s18, 15360
    s_waitcnt vmcnt(0)
    v_cmp_ne_u32 vcc, s4, v36
    s_cbranch_vccz O_OK
POLL_11:
    buffer_load_dword v36, v37, s[68:71], s19 offen sc1
    s_waitcnt vmcnt(0)
    v_cmp_ne_u32 vcc, s4, v36
    s_cbranch_vccz POLLD_12
    s_sleep 1
    s_sub_i32 s9, s9, 1
    s_cmp_gt_i32 s9, 0
    s_cbranch_scc1 POLL_11
POLLD_12:
O_OK:
    buffer_load_dwordx4 v[36:39], v12, s[68:71], s18 offen offset:0 sc1
    buffer_load_dwordx4 v[40:43], v12, s[68:71], s18 offen offset:2560 sc1
    buffer_load_dwordx4 v[44:47], v12, s[68:71], s36 offen offset:0 sc1
    v_mfma_f32_16x16x32_bf16 v[64:67], v[160:163], v[76:79], v[64:67]
    s_mul_i32 s12, s39, 3072
    s_add_u32 s12, s12, 122880
    s_xor_b32 s13, s39, 4
    s_mul_i32 s13, s13, 3072
    s_add_u32 s13, s13, 122880
    s_and_b32 s10, s39, 3
    v_mfma_f32_16x16x32_bf16 v[68:71], v[164:167], v[76:79], v[68:71]
    s_lshl2_add_u32 s10, s17, s10
    s_lshl3_add_u32 s10, s10, s5
    s_mul_i32 s20, s10, 2560
    s_add_u32 s20, s20, s79
    s_add_u32 s20, s20, 258048
    s_lshl4_add_u32 s23, s14, s20
    v_mfma_f32_16x16x32_bf16 v[64:67], v[168:171], v[76:79], v[64:67]
    s_lshl1_add_u32 s10, s5, s17
    s_lshl3_add_u32 s10, s10, s39
    s_lshl_b32 s21, s10, 8
    s_add_u32 s11, s79, 4096
    s_add_u32 s21, s21, s11
    s_lshl1_add_u32 s10, s3, s17
    v_mfma_f32_16x16x32_bf16 v[68:71], v[172:175], v[76:79], v[68:71]
    s_lshl_b32 s22, s10, 11
    s_add_u32 s22, s22, s11
    s_cmp_lt_u32 s39, 4
    s_cselect_b32 s14, -1, 0
    s_not_b32 s15, s14
    s_mov_b32 s10, 0xffff0000
    s_waitcnt vmcnt(2) lgkmcnt(15)
    v_mfma_f32_16x16x32_bf16 v[16:19], v[16:19], v[36:39], 0
    buffer_load_dwordx4 v[48:51], v12, s[68:71], s36 offen offset:2560 sc1
    v_mfma_f32_16x16x32_bf16 v[20:23], v[20:23], v[36:39], 0
    v_mfma_f32_16x16x32_bf16 v[24:27], v[24:27], v[36:39], 0
    s_waitcnt lgkmcnt(15)
    v_mfma_f32_16x16x32_bf16 v[28:31], v[28:31], v[36:39], 0
    v_mfma_f32_16x16x32_bf16 v[32:35], v[32:35], v[36:39], 0
    s_waitcnt vmcnt(2) lgkmcnt(10)
    v_mfma_f32_16x16x32_bf16 v[16:19], v[4:7], v[40:43], v[16:19]
    buffer_load_dwordx4 v[36:39], v12, s[68:71], s37 offen offset:0 sc1
    ds_read_b64_tr_b16 v[4:5], v14 offset:12896
    ds_read_b64_tr_b16 v[6:7], v14 offset:14176
    v_mfma_f32_16x16x32_bf16 v[20:23], v[8:11], v[40:43], v[20:23]
    ds_read_b64_tr_b16 v[8:9], v14 offset:12928
    ds_read_b64_tr_b16 v[10:11], v14 offset:14208
    v_mfma_f32_16x16x32_bf16 v[24:27], v[52:55], v[40:43], v[24:27]
    ds_read_b64_tr_b16 v[52:53], v0 offset:19200
    ds_read_b64_tr_b16 v[54:55], v0 offset:20480
    s_waitcnt lgkmcnt(12)
    v_mfma_f32_16x16x32_bf16 v[28:31], v[56:59], v[40:43], v[28:31]
    ds_read_b64_tr_b16 v[56:57], v0 offset:19232
    ds_read_b64_tr_b16 v[58:59], v0 offset:20512
    v_mfma_f32_16x16x32_bf16 v[32:35], v[60:63], v[40:43], v[32:35]
    ds_read_b64_tr_b16 v[60:61], v2 offset:19264
    ds_read_b64_tr_b16 v[62:63], v2 offset:20544
    s_waitcnt vmcnt(2) lgkmcnt(10)
    v_mfma_f32_16x16x32_bf16 v[16:19], v[72:75], v[44:47], v[16:19]
    buffer_load_dwordx4 v[40:43], v12, s[68:71], s37 offen offset:2560 sc1
    ds_read_b64_tr_b16 v[72:73], v14 offset:19296
    ds_read_b64_tr_b16 v[74:75], v14 offset:20576
    v_mfma_f32_16x16x32_bf16 v[20:23], v[80:83], v[44:47], v[20:23]
    ds_read_b64_tr_b16 v[80:81], v14 offset:19328
    ds_read_b64_tr_b16 v[82:83], v14 offset:20608
    v_mfma_f32_16x16x32_bf16 v[24:27], v[84:87], v[44:47], v[24:27]
    ds_read_b64_tr_b16 v[84:85], v0 offset:25600
    ds_read_b64_tr_b16 v[86:87], v0 offset:26880
    s_waitcnt lgkmcnt(12)
    v_mfma_f32_16x16x32_bf16 v[28:31], v[4:7], v[44:47], v[28:31]
    ds_read_b64_tr_b16 v[4:5], v0 offset:25632
    ds_read_b64_tr_b16 v[6:7], v0 offset:26912
    v_mfma_f32_16x16x32_bf16 v[32:35], v[8:11], v[44:47], v[32:35]
    ds_read_b64_tr_b16 v[8:9], v2 offset:25664
    ds_read_b64_tr_b16 v[10:11], v2 offset:26944
    s_setprio 2
    s_waitcnt vmcnt(2) lgkmcnt(10)
    v_mfma_f32_16x16x32_bf16 v[16:19], v[52:55], v[48:51], v[16:19]
    buffer_load_dwordx4 v[44:47], v12, s[68:71], s38 offen offset:0 sc1
    ds_read_b64_tr_b16 v[52:53], v14 offset:25696
    ds_read_b64_tr_b16 v[54:55], v14 offset:26976
    v_mfma_f32_16x16x32_bf16 v[20:23], v[56:59], v[48:51], v[20:23]
    ds_read_b64_tr_b16 v[56:57], v14 offset:25728
    ds_read_b64_tr_b16 v[58:59], v14 offset:27008
    v_mfma_f32_16x16x32_bf16 v[24:27], v[60:63], v[48:51], v[24:27]
    ds_read_b64_tr_b16 v[60:61], v0 offset:32000
    ds_read_b64_tr_b16 v[62:63], v0 offset:33280
    s_waitcnt lgkmcnt(12)
    v_mfma_f32_16x16x32_bf16 v[28:31], v[72:75], v[48:51], v[28:31]
    ds_read_b64_tr_b16 v[72:73], v0 offset:32032
    ds_read_b64_tr_b16 v[74:75], v0 offset:33312
    v_mfma_f32_16x16x32_bf16 v[32:35], v[80:83], v[48:51], v[32:35]
    ds_read_b64_tr_b16 v[80:81], v2 offset:32064
    ds_read_b64_tr_b16 v[82:83], v2 offset:33344
    s_waitcnt vmcnt(2) lgkmcnt(10)
    v_mfma_f32_16x16x32_bf16 v[16:19], v[84:87], v[36:39], v[16:19]
    buffer_load_dwordx4 v[48:51], v12, s[68:71], s38 offen offset:2560 sc1
    ds_read_b64_tr_b16 v[84:85], v14 offset:32096
    ds_read_b64_tr_b16 v[86:87], v14 offset:33376
    v_mfma_f32_16x16x32_bf16 v[20:23], v[4:7], v[36:39], v[20:23]
    ds_read_b64_tr_b16 v[4:5], v14 offset:32128
    ds_read_b64_tr_b16 v[6:7], v14 offset:33408
    v_mfma_f32_16x16x32_bf16 v[24:27], v[8:11], v[36:39], v[24:27]
    ds_read_b64_tr_b16 v[8:9], v0 offset:38400
    ds_read_b64_tr_b16 v[10:11], v0 offset:39680
    s_waitcnt lgkmcnt(12)
    v_mfma_f32_16x16x32_bf16 v[28:31], v[52:55], v[36:39], v[28:31]
    ds_read_b64_tr_b16 v[52:53], v0 offset:38432
    ds_read_b64_tr_b16 v[54:55], v0 offset:39712
    v_mfma_f32_16x16x32_bf16 v[32:35], v[56:59], v[36:39], v[32:35]
    ds_read_b64_tr_b16 v[56:57], v2 offset:38464
    ds_read_b64_tr_b16 v[58:59], v2 offset:39744
    s_waitcnt vmcnt(2) lgkmcnt(10)
    v_mfma_f32_16x16x32_bf16 v[16:19], v[60:63], v[40:43], v[16:19]
    buffer_load_dwordx2 v[36:37], v13, s[68:71], s18 offen offset:1024 sc1
    buffer_load_dwordx2 v[38:39], v13, s[68:71], s36 offen offset:1024 sc1
    ds_read_b64_tr_b16 v[60:61], v14 offset:38496
    ds_read_b64_tr_b16 v[62:63], v14 offset:39776
    v_mfma_f32_16x16x32_bf16 v[20:23], v[72:75], v[40:43], v[20:23]
    ds_read_b64_tr_b16 v[72:73], v14 offset:38528
    ds_read_b64_tr_b16 v[74:75], v14 offset:39808
    v_mfma_f32_16x16x32_bf16 v[24:27], v[80:83], v[40:43], v[24:27]
    ds_read_b64_tr_b16 v[80:81], v0 offset:44800
    ds_read_b64_tr_b16 v[82:83], v0 offset:46080
    s_waitcnt lgkmcnt(12)
    v_mfma_f32_16x16x32_bf16 v[28:31], v[84:87], v[40:43], v[28:31]
    ds_read_b64_tr_b16 v[84:85], v0 offset:44832
    ds_read_b64_tr_b16 v[86:87], v0 offset:46112
    v_mfma_f32_16x16x32_bf16 v[32:35], v[4:7], v[40:43], v[32:35]
    ds_read_b64_tr_b16 v[4:5], v2 offset:44864
    ds_read_b64_tr_b16 v[6:7], v2 offset:46144
    s_setprio 1
    s_waitcnt vmcnt(3) lgkmcnt(10)
    v_mfma_f32_16x16x32_bf16 v[16:19], v[8:11], v[44:47], v[16:19]
    buffer_load_dwordx2 v[40:41], v13, s[68:71], s37 offen offset:1024 sc1
    buffer_load_dwordx2 v[42:43], v13, s[68:71], s38 offen offset:1024 sc1
    ds_read_b64_tr_b16 v[8:9], v14 offset:44896
    ds_read_b64_tr_b16 v[10:11], v14 offset:46176
    v_mfma_f32_16x16x32_bf16 v[20:23], v[52:55], v[44:47], v[20:23]
    v_add_u32 v12, s12, v15
    v_add_u32 v13, s13, v15
    ds_read_b64_tr_b16 v[52:53], v14 offset:44928
    ds_read_b64_tr_b16 v[54:55], v14 offset:46208
    v_mfma_f32_16x16x32_bf16 v[24:27], v[56:59], v[44:47], v[24:27]
    v_add_u32 v14, v3, v14
    v_add_u32 v2, v3, v2
    v_add_u32 v0, v3, v0
    ds_read_b64_tr_b16 v[56:57], v14 offset:2656
    ds_read_b64_tr_b16 v[58:59], v14 offset:15456
    s_waitcnt lgkmcnt(12)
    v_mfma_f32_16x16x32_bf16 v[28:31], v[60:63], v[44:47], v[28:31]
    ds_read_b64_tr_b16 v[60:61], v14 offset:2688
    ds_read_b64_tr_b16 v[62:63], v14 offset:15488
    v_mfma_f32_16x16x32_bf16 v[32:35], v[72:75], v[44:47], v[32:35]
    ds_read_b64_tr_b16 v[72:73], v14 offset:28256
    ds_read_b64_tr_b16 v[74:75], v14 offset:41056
    ds_read_b64_tr_b16 v[44:45], v14 offset:28288
    ds_read_b64_tr_b16 v[46:47], v14 offset:41088
    s_waitcnt vmcnt(4) lgkmcnt(12)
    v_mfma_f32_16x16x32_bf16 v[16:19], v[80:83], v[48:51], v[16:19]
    ds_read_b64_tr_b16 v[80:81], v2 offset:2624
    ds_read_b64_tr_b16 v[82:83], v2 offset:15424
    v_mfma_f32_16x16x32_bf16 v[20:23], v[84:87], v[48:51], v[20:23]
    ds_read_b64_tr_b16 v[84:85], v0 offset:2560
    ds_read_b64_tr_b16 v[86:87], v0 offset:15360
    v_mfma_f32_16x16x32_bf16 v[24:27], v[4:7], v[48:51], v[24:27]
    ds_read_b64_tr_b16 v[4:5], v2 offset:28224
    ds_read_b64_tr_b16 v[6:7], v2 offset:41024
    s_waitcnt lgkmcnt(14)
    v_mfma_f32_16x16x32_bf16 v[28:31], v[8:11], v[48:51], v[28:31]
    ds_read_b64_tr_b16 v[8:9], v0 offset:2592
    ds_read_b64_tr_b16 v[10:11], v0 offset:15392
    v_mfma_f32_16x16x32_bf16 v[32:35], v[52:55], v[48:51], v[32:35]
    ds_read_b64_tr_b16 v[52:53], v0 offset:28160
    ds_read_b64_tr_b16 v[54:55], v0 offset:40960
    ds_read_b64_tr_b16 v[48:49], v0 offset:28192
    ds_read_b64_tr_b16 v[50:51], v0 offset:40992
    s_waitcnt vmcnt(2) lgkmcnt(14)
    v_mfma_f32_16x16x32_bf16 v[28:31], v[56:59], v[36:39], v[28:31]
    v_and_b32 v2, 0xf0, v15
    v_lshrrev_b32 v3, 5, v1
    v_mfma_f32_16x16x32_bf16 v[32:35], v[60:63], v[36:39], v[32:35]
    v_lshl_add_u32 v2, v3, 8, v2
    v_bfe_u32 v3, v1, 4, 1
    s_waitcnt vmcnt(0)
    v_mfma_f32_16x16x32_bf16 v[28:31], v[72:75], v[40:43], v[28:31]
    v_lshl_add_u32 v0, v3, 9, v2
    v_lshl_add_u32 v14, v3, 3, v2
    s_waitcnt lgkmcnt(10)
    v_mfma_f32_16x16x32_bf16 v[32:35], v[44:47], v[40:43], v[32:35]
    v_lshlrev_b32 v56, 16, v88
    v_and_b32 v57, s10, v88
    v_mfma_f32_16x16x32_bf16 v[24:27], v[80:83], v[36:39], v[24:27]
    v_lshlrev_b32 v58, 16, v89
    v_and_b32 v59, s10, v89
    s_setprio 0
    s_waitcnt lgkmcnt(4)
    v_mfma_f32_16x16x32_bf16 v[16:19], v[84:87], v[36:39], v[16:19]
    ds_write_b128 v12, v[28:31] offset:0
    v_mfma_f32_16x16x32_bf16 v[24:27], v[4:7], v[40:43], v[24:27]
    ds_write_b128 v12, v[32:35] offset:1024
    v_mfma_f32_16x16x32_bf16 v[20:23], v[8:11], v[36:39], v[20:23]
    v_lshlrev_b32 v60, 16, v90
    v_and_b32 v61, s10, v90
    s_waitcnt lgkmcnt(2)
    v_mfma_f32_16x16x32_bf16 v[16:19], v[52:55], v[40:43], v[16:19]
    v_lshlrev_b32 v62, 16, v91
    v_and_b32 v63, s10, v91
    v_mfma_f32_16x16x32_bf16 v[20:23], v[48:51], v[40:43], v[20:23]
    ds_write_b128 v12, v[24:27] offset:2048
    v_lshlrev_b32 v72, 16, v92
    v_and_b32 v73, s10, v92
    v_lshlrev_b32 v74, 16, v93
    v_and_b32 v75, s10, v93
    v_mov_b32 v8, 0
    v_mov_b32 v9, 0
    v_mov_b32 v10, s4
    v_mov_b32 v11, 0x3f803f80
    v_pk_add_f32 v[72:73], v[72:73], v[24:25]
    v_pk_add_f32 v[74:75], v[74:75], v[26:27]
    s_waitcnt lgkmcnt(0)
    s_barrier
    ds_read_b128 v[44:47], v13 offset:0
    ds_read_b128 v[80:83], v13 offset:1024
    ds_read_b128 v[84:87], v13 offset:2048
    v_pk_add_f32 v[56:57], v[56:57], v[16:17]
    v_pk_add_f32 v[58:59], v[58:59], v[18:19]
    v_pk_add_f32 v[60:61], v[60:61], v[20:21]
    v_pk_add_f32 v[62:63], v[62:63], v[22:23]
    s_waitcnt lgkmcnt(2)
    v_pk_add_f32 v[56:57], v[56:57], v[44:45]
    v_pk_add_f32 v[58:59], v[58:59], v[46:47]
    v_cvt_pk_bf16_f32 v88, v56, v57
    v_cvt_pk_bf16_f32 v89, v58, v59
    s_waitcnt lgkmcnt(1)
    v_pk_add_f32 v[60:61], v[60:61], v[80:81]
    v_pk_add_f32 v[62:63], v[62:63], v[82:83]
    v_cvt_pk_bf16_f32 v90, v60, v61
    v_cvt_pk_bf16_f32 v91, v62, v63
    s_waitcnt lgkmcnt(0)
    v_pk_add_f32 v[72:73], v[72:73], v[84:85]
    v_pk_add_f32 v[74:75], v[74:75], v[86:87]
    v_cvt_pk_bf16_f32 v92, v72, v73
    v_cvt_pk_bf16_f32 v93, v74, v75
    v_permlane16_swap_b32 v88, v90
    v_permlane16_swap_b32 v89, v91
    s_cmp_eq_u32 s7, 0
    s_cbranch_scc1 XS_13
    buffer_store_dwordx4 v[88:91], v0, s[68:71], s23 offen
    s_mov_b64 exec, s[14:15]
    buffer_store_dwordx2 v[92:93], v14, s[68:71], s20 offen offset:1024
XB_14:
    v_dot2c_f32_bf16 v8, v92, v11
    v_dot2c_f32_bf16 v9, v92, v92
    v_dot2c_f32_bf16 v8, v93, v11
    v_dot2c_f32_bf16 v9, v93, v93
    s_mov_b64 exec, -1
    v_dot2c_f32_bf16 v8, v88, v11
    v_dot2c_f32_bf16 v9, v88, v88
    v_dot2c_f32_bf16 v8, v89, v11
    v_dot2c_f32_bf16 v9, v89, v89
    v_dot2c_f32_bf16 v8, v90, v11
    v_dot2c_f32_bf16 v9, v90, v90
    v_dot2c_f32_bf16 v8, v91, v11
    v_dot2c_f32_bf16 v9, v91, v91
    s_nop 2
    v_permlane32_swap_b32 v8, v9
    v_add_f32 v8, v8, v9
    v_mov_b32 v9, v8
    s_nop 1
    v_permlane16_swap_b32 v8, v9
    v_add_f32 v8, v8, v9
    v_mov_b32 v9, v8
    s_nop 1
    v_permlane32_swap_b32 v8, v9
    s_waitcnt vmcnt(0)
    s_mov_b64 exec, 0xffff
    s_cmp_eq_u32 s7, 0
    s_cbranch_scc1 XS_15
    buffer_store_dwordx4 v[8:11], v15, s[68:71], s21 offen
XB_16:
    s_mov_b64 exec, -1
    buffer_load_dwordx4 v[48:51], v15, s[68:71], s22 offen sc1
    buffer_load_dwordx4 v[52:55], v15, s[68:71], s22 offen offset:1024 sc1
    v_mfma_f32_16x16x32_bf16 v[64:67], v[176:179], v[76:79], v[64:67]
    s_mul_i32 s10, s17, 7
    s_add_u32 s10, s10, s5
    s_cmp_eq_u32 s5, 7
    s_cselect_b32 s10, 14, s10
    s_lshl3_add_u32 s10, s10, s3
    v_mfma_f32_16x16x32_bf16 v[68:71], v[180:183], v[76:79], v[68:71]
    s_lshl2_add_u32 s25, s10, s79
    s_mul_i32 s11, s17, 110592
    s_lshl_b32 s24, s10, 9
    s_add_u32 s24, s24, s11
    s_add_u32 s11, s79, 36864
    s_add_u32 s24, s24, s11
    v_mfma_f32_16x16x32_bf16 v[64:67], v[184:187], v[76:79], v[64:67]
    s_cmp_ge_u32 s10, 108
    s_cselect_b32 s24, 0x40000000, s24
    s_cselect_b32 s80, 196608, 0
    s_lshr_b32 s10, s3, 2
    s_lshl1_add_u32 s10, s10, s17
    v_mfma_f32_16x16x32_bf16 v[68:71], v[188:191], v[76:79], v[68:71]
    s_mul_i32 s27, s10, 55296
    s_add_u32 s27, s27, s11
    s_mul_i32 s10, s3, 7168
    s_add_u32 s27, s27, s10
    s_mul_i32 s28, s3, 56
    s_add_u32 s10, s28, s5
    v_mfma_f32_16x16x32_bf16 v[64:67], v[192:195], v[76:79], v[64:67]
    s_add_u32 s28, s28, s79
    s_mul_i32 s26, s10, 5120
    s_add_u32 s26, s26, 18874368
    s_cmp_eq_u32 s3, 7
    s_cselect_b32 s31, 0x40000000, 0
    v_mfma_f32_16x16x32_bf16 v[68:71], v[196:199], v[76:79], v[68:71]
    s_cselect_b32 s10, 9, 13
    s_or_b32 s34, s26, s31
    v_min_u32 v14, s10, v1
    v_lshlrev_b32 v14, 2, v14
    s_lshl_b32 s10, s17, 5
    s_add_u32 s10, s10, s3
    v_mfma_f32_16x16x32_bf16 v[64:67], v[200:203], v[76:79], v[64:67]
    s_xor_b32 s11, s10, 32
    s_add_u32 s12, s79, 258048
    s_mul_i32 s23, s10, 2560
    s_add_u32 s23, s23, s12
    s_mul_i32 s20, s11, 2560
    v_mfma_f32_16x16x32_bf16 v[68:71], v[204:207], v[76:79], v[68:71]
    s_add_u32 s20, s20, s12
    s_mul_i32 s30, s3, 5120
    s_lshl_b32 s33, s3, 10
    v_lshrrev_b32 v6, 5, v1
    v_and_b32 v7, 0x1f0, v15
    v_lshl_add_u32 v2, v6, 10, v7
    v_mfma_f32_16x16x32_bf16 v[64:67], v[208:211], v[76:79], v[64:67]
    v_add_u32 v2, s80, v2
    v_add_u32 v3, 0x10000, v2
    v_add_u32 v12, 0x20000, v2
    v_mul_u32_u24 v56, 20480, v6
    v_add_u32 v56, v56, v7
    v_mfma_f32_16x16x32_bf16 v[68:71], v[212:215], v[76:79], v[68:71]
    s_lshl_b32 s10, s3, 3
    v_xor_b32 v7, s10, v1
    s_lshl_b32 s10, s3, 9
    s_add_u32 s10, s10, 155648
    v_lshl_add_u32 v57, v7, 3, s10
    v_and_b32 v5, 56, v1
    v_mfma_f32_16x16x32_bf16 v[64:67], v[216:219], v[76:79], v[64:67]
    v_lshl_add_u32 v7, v5, 3, v7
    s_mov_b32 s10, 155648
    v_lshl_add_u32 v0, v7, 3, s10
    v_and_b32 v5, 15, v1
    v_lshl_add_u32 v5, v5, 3, s10
    v_mfma_f32_16x16x32_bf16 v[68:71], v[220:223], v[76:79], v[68:71]
    v_bfe_u32 v7, v1, 4, 1
    v_mul_u32_u24 v7, 55296, v7
    v_lshl_add_u32 v4, v6, 8, v7
    v_and_b32 v7, 0xf0, v15
    v_add_u32 v4, v4, v7
    v_mov_b32 v13, s4
    s_cmp_eq_u32 s5, 7
    s_cbranch_scc1 J7
    s_add_u32 m0, s30, 81920
    s_waitcnt vmcnt(0)
    v_min3_u32 v51, v50, v54, s4
    v_max3_u32 v55, v50, v54, s4
    v_cmp_ne_u32 vcc, v51, v55
    s_cbranch_vccz H_OK
POLL_17:
    buffer_load_dwordx4 v[48:51], v15, s[68:71], s22 offen sc1
    buffer_load_dwordx4 v[52:55], v15, s[68:71], s22 offen offset:1024 sc1
    s_waitcnt vmcnt(0)
    v_min3_u32 v51, v50, v54, s4
    v_max3_u32 v55, v50, v54, s4
    v_cmp_ne_u32 vcc, v51, v55
    s_cbranch_vccz POLLD_18
    s_sleep 1
    s_sub_i32 s9, s9, 1
    s_cmp_gt_i32 s9, 0
    s_cbranch_scc1 POLL_17
POLLD_18:
H_OK:
    buffer_load_dwordx4 v56, s[68:71], s23 offen offset:0 sc1 lds
    s_add_u32 m0, s30, 82432
    s_nop 0
    buffer_load_dwordx4 v56, s[68:71], s23 offen offset:512 sc1 lds
    s_add_u32 m0, s30, 82944
    s_nop 0
    buffer_load_dwordx4 v56, s[68:71], s23 offen offset:1024 sc1 lds
    s_add_u32 m0, s30, 83456
    s_nop 0
    buffer_load_dwordx4 v56, s[68:71], s23 offen offset:1536 sc1 lds
    s_add_u32 m0, s30, 83968
    s_nop 0
    buffer_load_dwordx4 v56, s[68:71], s23 offen offset:2048 sc1 lds
    s_add_u32 s23, s23, 40960
    v_add_f32 v48, v48, v52
    v_add_f32 v49, v49, v53
    ds_write_b64 v57, v[48:49]
    s_xor_b32 s22, s22, 2048
    v_mfma_f32_16x16x32_bf16 v[64:67], v[224:227], v[76:79], v[64:67]
    v_mfma_f32_16x16x32_bf16 v[68:71], v[228:231], v[76:79], v[68:71]
    v_mfma_f32_16x16x32_bf16 v[64:67], v[232:235], v[76:79], v[64:67]
    v_mfma_f32_16x16x32_bf16 v[68:71], v[236:239], v[76:79], v[68:71]
    v_mfma_f32_16x16x32_bf16 v[64:67], v[240:243], v[76:79], v[64:67]
    v_mfma_f32_16x16x32_bf16 v[68:71], v[244:247], v[76:79], v[68:71]
    v_mfma_f32_16x16x32_bf16 v[64:67], v[248:251], v[76:79], v[64:67]
    v_mfma_f32_16x16x32_bf16 v[68:71], v[252:255], v[76:79], v[68:71]
    s_waitcnt vmcnt(0) lgkmcnt(0)
    s_barrier
    ds_read_b128 v[72:75], v3 offset:49152
    ds_read_b128 v[76:79], v3 offset:49664
    ds_read_b128 v[80:83], v3 offset:51200
    ds_read_b128 v[84:87], v3 offset:51712
    ds_read_b128 v[88:91], v3 offset:53248
    ds_read_b128 v[92:95], v3 offset:53760
    s_waitcnt lgkmcnt(5)
    s_setprio 3
    v_mfma_f32_16x16x32_bf16 v[16:19], v[224:227], v[72:75], 0
    s_add_u32 m0, s30, 40960
    s_nop 0
    buffer_load_dwordx4 v56, s[68:71], s23 offen offset:0 sc1 lds
    v_mfma_f32_16x16x32_bf16 v[20:23], v[228:231], v[72:75], 0
    ds_read_b64 v[32:33], v0 offset:0
    ds_read_b128 v[72:75], v3 offset:55296
    s_waitcnt lgkmcnt(6)
    v_mfma_f32_16x16x32_bf16 v[28:31], v[228:231], v[76:79], 0
    v_mfma_f32_16x16x32_bf16 v[24:27], v[224:227], v[76:79], 0
    ds_read_b128 v[76:79], v3 offset:55808
    s_add_u32 m0, s30, 41472
    s_nop 0
    buffer_load_dwordx4 v56, s[68:71], s23 offen offset:512 sc1 lds
    s_waitcnt lgkmcnt(6)
    v_mfma_f32_16x16x32_bf16 v[16:19], v[232:235], v[80:83], v[16:19]
    v_mfma_f32_16x16x32_bf16 v[20:23], v[236:239], v[80:83], v[20:23]
    ds_read_b128 v[80:83], v3 offset:16384
    s_waitcnt lgkmcnt(6)
    v_mfma_f32_16x16x32_bf16 v[28:31], v[236:239], v[84:87], v[28:31]
    s_add_u32 m0, s30, 41984
    s_nop 0
    buffer_load_dwordx4 v56, s[68:71], s23 offen offset:1024 sc1 lds
    v_mfma_f32_16x16x32_bf16 v[24:27], v[232:235], v[84:87], v[24:27]
    ds_read_b128 v[84:87], v3 offset:16896
    s_waitcnt lgkmcnt(6)
    v_mfma_f32_16x16x32_bf16 v[16:19], v[240:243], v[88:91], v[16:19]
    v_mfma_f32_16x16x32_bf16 v[20:23], v[244:247], v[88:91], v[20:23]
    s_waitcnt lgkmcnt(4)
    v_permlane32_swap_b32 v32, v33
    v_add_f32 v32, v32, v33
    ds_read_b128 v[88:91], v3 offset:18432
    s_add_u32 m0, s30, 42496
    s_nop 0
    buffer_load_dwordx4 v56, s[68:71], s23 offen offset:1536 sc1 lds
    s_setprio 2
    v_mfma_f32_16x16x32_bf16 v[28:31], v[244:247], v[92:95], v[28:31]
    v_add_f32_dpp v32, v32, v32 row_ror:8 row_mask:0xf bank_mask:0xf
    v_mov_b32 v33, v32
    v_mfma_f32_16x16x32_bf16 v[24:27], v[240:243], v[92:95], v[24:27]
    s_nop 0
    v_permlane16_swap_b32 v32, v33
    v_add_f32 v32, v32, v33
    ds_read_b128 v[92:95], v3 offset:18944
    s_waitcnt lgkmcnt(5)
    v_mfma_f32_16x16x32_bf16 v[16:19], v[248:251], v[72:75], v[16:19]
    v_mul_f32 v34, 0x3acccccd, v32
    v_mul_f32 v33, 0x3acccccd, v32
    s_add_u32 m0, s30, 43008
    s_nop 0
    buffer_load_dwordx4 v56, s[68:71], s23 offen offset:2048 sc1 lds
    s_add_u32 s23, s23, 40960
    v_mfma_f32_16x16x32_bf16 v[20:23], v[252:255], v[72:75], v[20:23]
    v_permlane32_swap_b32 v34, v33
    v_fma_f32 v33, -v34, v34, v33
    ds_read_b128 v[72:75], v3 offset:20480
    s_waitcnt lgkmcnt(5)
    v_mfma_f32_16x16x32_bf16 v[28:31], v[252:255], v[76:79], v[28:31]
    v_max_f32 v33, 0, v33
    v_add_f32 v33, 0x3727c5ac, v33
    buffer_load_dwordx4 v[48:51], v15, s[68:71], s22 offen sc1
    buffer_load_dwordx4 v[52:55], v15, s[68:71], s22 offen offset:1024 sc1
    v_mfma_f32_16x16x32_bf16 v[24:27], v[248:251], v[76:79], v[24:27]
    v_rsq_f32 v32, v33
    ds_read_b128 v[76:79], v3 offset:20992
    s_waitcnt lgkmcnt(5)
    v_mfma_f32_16x16x32_bf16 v[16:19], v[96:99], v[80:83], v[16:19]
    v_mul_f32 v32, 0xbfb8aa3b, v32
    v_mfma_f32_16x16x32_bf16 v[20:23], v[100:103], v[80:83], v[20:23]
    s_nop 0
    v_permlane32_swap_b32 v32, v34
    ds_write_b64 v0, v[32:33] offset:0
    ds_read_b128 v[80:83], v3 offset:22528
    s_waitcnt lgkmcnt(6)
    v_mfma_f32_16x16x32_bf16 v[28:31], v[100:103], v[84:87], v[28:31]
    v_mfma_f32_16x16x32_bf16 v[24:27], v[96:99], v[84:87], v[24:27]
    ds_read_b128 v[84:87], v3 offset:23040
    s_waitcnt lgkmcnt(6)
    s_setprio 1
    v_mfma_f32_16x16x32_bf16 v[16:19], v[104:107], v[88:91], v[16:19]
    v_mfma_f32_16x16x32_bf16 v[20:23], v[108:111], v[88:91], v[20:23]
    ds_read_b128 v[88:91], v3 offset:24576
    s_waitcnt lgkmcnt(6)
    v_mfma_f32_16x16x32_bf16 v[28:31], v[108:111], v[92:95], v[28:31]
    v_mfma_f32_16x16x32_bf16 v[24:27], v[104:107], v[92:95], v[24:27]
    ds_read_b128 v[92:95], v3 offset:25088
    s_waitcnt lgkmcnt(6)
    v_mfma_f32_16x16x32_bf16 v[16:19], v[112:115], v[72:75], v[16:19]
    v_mfma_f32_16x16x32_bf16 v[20:23], v[116:119], v[72:75], v[20:23]
    ds_read_b128 v[72:75], v3 offset:26624
    s_waitcnt lgkmcnt(6)
    v_mfma_f32_16x16x32_bf16 v[28:31], v[116:119], v[76:79], v[28:31]
    v_mfma_f32_16x16x32_bf16 v[24:27], v[112:115], v[76:79], v[24:27]
    ds_read_b128 v[76:79], v3 offset:27136
    s_waitcnt lgkmcnt(5)
    v_mfma_f32_16x16x32_bf16 v[16:19], v[120:123], v[80:83], v[16:19]
    v_mfma_f32_16x16x32_bf16 v[20:23], v[124:127], v[80:83], v[20:23]
    ds_read_b128 v[80:83], v3 offset:28672
    s_waitcnt lgkmcnt(5)
    v_mfma_f32_16x16x32_bf16 v[28:31], v[124:127], v[84:87], v[28:31]
    s_setprio 0
    v_mfma_f32_16x16x32_bf16 v[24:27], v[120:123], v[84:87], v[24:27]
    ds_read_b128 v[84:87], v3 offset:29184
    s_waitcnt lgkmcnt(5)
    v_mfma_f32_16x16x32_bf16 v[16:19], v[128:131], v[88:91], v[16:19]
    v_mfma_f32_16x16x32_bf16 v[20:23], v[132:135], v[88:91], v[20:23]
    ds_read_b128 v[88:91], v3 offset:30720
    s_waitcnt lgkmcnt(5)
    v_mfma_f32_16x16x32_bf16 v[28:31], v[132:135], v[92:95], v[28:31]
    s_waitcnt vmcnt(0)
    s_barrier
    v_min3_u32 v51, v50, v54, s4
    v_max3_u32 v55, v50, v54, s4
    v_cmp_ne_u32 vcc, v51, v55
    s_cbranch_vccnz HP2
HB2:
    v_add_f32 v48, v48, v52
    v_add_f32 v49, v49, v53
    ds_write_b64 v57, v[48:49] offset:4096
    s_add_u32 m0, s30, 0
    s_nop 0
    buffer_load_dwordx4 v56, s[68:71], s20 offen offset:0 sc1 lds
    s_setprio 3
    v_mfma_f32_16x16x32_bf16 v[24:27], v[128:131], v[92:95], v[24:27]
    ds_read_b32 v10, v5 offset:2048
    ds_read_b32 v11, v5 offset:2176
    ds_read_b128 v[92:95], v3 offset:31232
    s_waitcnt lgkmcnt(8)
    v_mfma_f32_16x16x32_bf16 v[16:19], v[136:139], v[72:75], v[16:19]
    v_mfma_f32_16x16x32_bf16 v[20:23], v[140:143], v[72:75], v[20:23]
    ds_read_b128 v[72:75], v3 offset:32768
    s_waitcnt lgkmcnt(8)
    v_mfma_f32_16x16x32_bf16 v[28:31], v[140:143], v[76:79], v[28:31]
    s_add_u32 m0, s30, 512
    s_nop 0
    buffer_load_dwordx4 v56, s[68:71], s20 offen offset:512 sc1 lds
    v_mfma_f32_16x16x32_bf16 v[24:27], v[136:139], v[76:79], v[24:27]
    ds_read_b128 v[76:79], v3 offset:33280
    s_waitcnt lgkmcnt(8)
    v_mfma_f32_16x16x32_bf16 v[16:19], v[144:147], v[80:83], v[16:19]
    v_mfma_f32_16x16x32_bf16 v[20:23], v[148:151], v[80:83], v[20:23]
    ds_read_b128 v[80:83], v3 offset:34816
    s_waitcnt lgkmcnt(8)
    v_mfma_f32_16x16x32_bf16 v[28:31], v[148:151], v[84:87], v[28:31]
    v_mfma_f32_16x16x32_bf16 v[24:27], v[144:147], v[84:87], v[24:27]
    s_waitcnt lgkmcnt(4)
    v_fma_f32 v32, -v10, v64, 0
    v_fma_f32 v33, -v10, v65, 0
    ds_read_b128 v[84:87], v3 offset:35328
    s_add_u32 m0, s30, 1024
    s_nop 0
    buffer_load_dwordx4 v56, s[68:71], s20 offen offset:1024 sc1 lds
    v_mfma_f32_16x16x32_bf16 v[16:19], v[152:155], v[88:91], v[16:19]
    v_fma_f32 v34, -v10, v66, 0
    v_fma_f32 v35, -v10, v67, 0
    v_mfma_f32_16x16x32_bf16 v[20:23], v[156:159], v[88:91], v[20:23]
    v_fma_f32 v36, -v10, v68, 0
    v_fma_f32 v37, -v10, v69, 0
    ds_read_b128 v[88:91], v3 offset:36864
    s_waitcnt lgkmcnt(5)
    v_mfma_f32_16x16x32_bf16 v[28:31], v[156:159], v[92:95], v[28:31]
    v_fma_f32 v38, -v10, v70, 0
    v_fma_f32 v39, -v10, v71, 0
    v_mfma_f32_16x16x32_bf16 v[24:27], v[152:155], v[92:95], v[24:27]
    v_fma_f32 v40, -v11, v64, 0
    v_fma_f32 v41, -v11, v65, 0
    ds_read_b128 v[92:95], v3 offset:37376
    s_waitcnt lgkmcnt(5)
    v_mfma_f32_16x16x32_bf16 v[16:19], v[160:163], v[72:75], v[16:19]
    v_fma_f32 v42, -v11, v66, 0
    v_fma_f32 v43, -v11, v67, 0
    s_add_u32 m0, s30, 1536
    s_nop 0
    buffer_load_dwordx4 v56, s[68:71], s20 offen offset:1536 sc1 lds
    s_setprio 2
    v_mfma_f32_16x16x32_bf16 v[20:23], v[164:167], v[72:75], v[20:23]
    v_fma_f32 v44, -v11, v68, 0
    v_fma_f32 v45, -v11, v69, 0
    ds_read_b128 v[72:75], v3 offset:38912
    s_waitcnt lgkmcnt(5)
    v_mfma_f32_16x16x32_bf16 v[28:31], v[164:167], v[76:79], v[28:31]
    v_fma_f32 v46, -v11, v70, 0
    v_fma_f32 v47, -v11, v71, 0
    v_mfma_f32_16x16x32_bf16 v[24:27], v[160:163], v[76:79], v[24:27]
    ds_read_b32 v10, v5 offset:2304
    ds_read_b32 v11, v5 offset:2432
    ds_read_b64 v[6:7], v5 offset:0
    ds_read_b64 v[8:9], v5 offset:128
    ds_read_b128 v[76:79], v3 offset:39424
    s_waitcnt lgkmcnt(9)
    v_mfma_f32_16x16x32_bf16 v[16:19], v[168:171], v[80:83], v[16:19]
    v_mfma_f32_16x16x32_bf16 v[20:23], v[172:175], v[80:83], v[20:23]
    ds_read_b128 v[80:83], v3 offset:40960
WST24576:
    s_cbranch_execz WST8192
    s_add_u32 m0, s30, 2048
    s_nop 0
    buffer_load_dwordx4 v56, s[68:71], s20 offen offset:2048 sc1 lds
    s_add_u32 s20, s20, 40960
    s_waitcnt lgkmcnt(9)
    v_mfma_f32_16x16x32_bf16 v[28:31], v[172:175], v[84:87], v[28:31]
    v_mfma_f32_16x16x32_bf16 v[24:27], v[168:171], v[84:87], v[24:27]
    ds_read_b128 v[84:87], v3 offset:41472
    s_waitcnt lgkmcnt(9)
    v_mfma_f32_16x16x32_bf16 v[16:19], v[176:179], v[88:91], v[16:19]
    v_mfma_f32_16x16x32_bf16 v[20:23], v[180:183], v[88:91], v[20:23]
    ds_read_b128 v[88:91], v3 offset:43008
    s_waitcnt lgkmcnt(9)
    v_mfma_f32_16x16x32_bf16 v[28:31], v[180:183], v[92:95], v[28:31]
    s_add_u32 m0, s30, 114688
    s_nop 0
    buffer_load_dwordx4 v56, s[68:71], s20 offen offset:0 sc1 lds
    v_mfma_f32_16x16x32_bf16 v[24:27], v[176:179], v[92:95], v[24:27]
    ds_read_b128 v[92:95], v3 offset:43520
    s_waitcnt lgkmcnt(9)
    v_mfma_f32_16x16x32_bf16 v[16:19], v[184:187], v[72:75], v[16:19]
    v_mfma_f32_16x16x32_bf16 v[20:23], v[188:191], v[72:75], v[20:23]
    ds_read_b128 v[72:75], v3 offset:45056
    s_waitcnt lgkmcnt(5)
    v_mfma_f32_16x16x32_bf16 v[28:31], v[188:191], v[76:79], v[28:31]
    s_setprio 1
    v_mfma_f32_16x16x32_bf16 v[24:27], v[184:187], v[76:79], v[24:27]
    ds_read_b128 v[76:79], v3 offset:45568
    s_add_u32 m0, s30, 115200
    s_nop 0
    buffer_load_dwordx4 v56, s[68:71], s20 offen offset:512 sc1 lds
    s_waitcnt lgkmcnt(5)
    v_mfma_f32_16x16x32_bf16 v[16:19], v[192:195], v[80:83], v[16:19]
    v_mfma_f32_16x16x32_bf16 v[20:23], v[196:199], v[80:83], v[20:23]
    ds_read_b128 v[80:83], v3 offset:47104
    s_waitcnt lgkmcnt(5)
    v_mfma_f32_16x16x32_bf16 v[28:31], v[196:199], v[84:87], v[28:31]
    v_mfma_f32_16x16x32_bf16 v[24:27], v[192:195], v[84:87], v[24:27]
    ds_read_b128 v[84:87], v3 offset:47616
    s_waitcnt lgkmcnt(5)
    v_mfma_f32_16x16x32_bf16 v[16:19], v[200:203], v[88:91], v[16:19]
    s_add_u32 m0, s30, 115712
    s_nop 0
    buffer_load_dwordx4 v56, s[68:71], s20 offen offset:1024 sc1 lds
    v_mfma_f32_16x16x32_bf16 v[20:23], v[204:207], v[88:91], v[20:23]
    ds_read_b128 v[88:91], v2 offset:40960
    s_waitcnt lgkmcnt(5)
    v_mfma_f32_16x16x32_bf16 v[28:31], v[204:207], v[92:95], v[28:31]
    v_mfma_f32_16x16x32_bf16 v[24:27], v[200:203], v[92:95], v[24:27]
    ds_read_b128 v[92:95], v2 offset:41472
    s_waitcnt lgkmcnt(5)
    v_mfma_f32_16x16x32_bf16 v[16:19], v[208:211], v[72:75], v[16:19]
    v_mfma_f32_16x16x32_bf16 v[20:23], v[212:215], v[72:75], v[20:23]
    ds_read_b128 v[72:75], v2 offset:43008
    s_add_u32 m0, s30, 116224
    s_nop 0
    buffer_load_dwordx4 v56, s[68:71], s20 offen offset:1536 sc1 lds
    s_waitcnt lgkmcnt(5)
    v_mfma_f32_16x16x32_bf16 v[28:31], v[212:215], v[76:79], v[28:31]
    v_mfma_f32_16x16x32_bf16 v[24:27], v[208:211], v[76:79], v[24:27]
    ds_read_b128 v[76:79], v2 offset:43520
    s_waitcnt lgkmcnt(5)
    v_mfma_f32_16x16x32_bf16 v[16:19], v[216:219], v[80:83], v[16:19]
    s_setprio 0
    v_mfma_f32_16x16x32_bf16 v[20:23], v[220:223], v[80:83], v[20:23]
    ds_read_b128 v[80:83], v2 offset:45056
    s_waitcnt lgkmcnt(5)
    v_mfma_f32_16x16x32_bf16 v[28:31], v[220:223], v[84:87], v[28:31]
    s_add_u32 m0, s30, 116736
    s_nop 0
    buffer_load_dwordx4 v56, s[68:71], s20 offen offset:2048 sc1 lds
    s_add_u32 s20, s20, 40960
    v_mfma_f32_16x16x32_bf16 v[24:27], v[216:219], v[84:87], v[24:27]
    ds_read_b128 v[84:87], v2 offset:45568
    s_waitcnt lgkmcnt(5)
    v_mfma_f32_16x16x32_bf16 v[32:35], v[96:99], v[88:91], v[32:35]
    s_barrier
    s_setprio 3
    v_mfma_f32_16x16x32_bf16 v[36:39], v[100:103], v[88:91], v[36:39]
    ds_read_b128 v[88:91], v2 offset:47104
    s_waitcnt lgkmcnt(5)
    v_mfma_f32_16x16x32_bf16 v[44:47], v[100:103], v[92:95], v[44:47]
    v_fma_f32 v16, -v10, v64, v16
    v_fma_f32 v17, -v10, v65, v17
    v_mfma_f32_16x16x32_bf16 v[40:43], v[96:99], v[92:95], v[40:43]
    v_fma_f32 v18, -v10, v66, v18
    v_fma_f32 v19, -v10, v67, v19
    ds_read_b128 v[92:95], v2 offset:47616
    s_add_u32 s32, s26, 165888
    s_add_u32 m0, s33, 81920
    s_nop 0
    buffer_load_dwordx4 v15, s[68:71], s32 offen offset:0 lds
    s_waitcnt lgkmcnt(5)
    v_mfma_f32_16x16x32_bf16 v[32:35], v[104:107], v[72:75], v[32:35]
    v_fma_f32 v20, -v10, v68, v20
    v_fma_f32 v21, -v10, v69, v21
    v_mfma_f32_16x16x32_bf16 v[36:39], v[108:111], v[72:75], v[36:39]
    v_fma_f32 v22, -v10, v70, v22
    v_fma_f32 v23, -v10, v71, v23
    ds_read_b128 v[72:75], v2 offset:49152
    s_waitcnt lgkmcnt(5)
    v_mfma_f32_16x16x32_bf16 v[44:47], v[108:111], v[76:79], v[44:47]
    v_fma_f32 v24, -v11, v64, v24
    v_fma_f32 v25, -v11, v65, v25
    v_mfma_f32_16x16x32_bf16 v[40:43], v[104:107], v[76:79], v[40:43]
    v_fma_f32 v26, -v11, v66, v26
    v_fma_f32 v27, -v11, v67, v27
    ds_read_b128 v[76:79], v2 offset:49664
    s_waitcnt lgkmcnt(5)
    v_mfma_f32_16x16x32_bf16 v[32:35], v[112:115], v[80:83], v[32:35]
    v_fma_f32 v28, -v11, v68, v28
    v_fma_f32 v29, -v11, v69, v29
    s_add_u32 m0, s33, 89088
    s_nop 0
    buffer_load_dwordx4 v15, s[68:71], s32 offen offset:1024 lds
    v_mfma_f32_16x16x32_bf16 v[36:39], v[116:119], v[80:83], v[36:39]
    v_fma_f32 v30, -v11, v70, v30
    v_fma_f32 v31, -v11, v71, v31
    ds_read_b128 v[80:83], v2 offset:51200
    s_waitcnt lgkmcnt(5)
    v_mfma_f32_16x16x32_bf16 v[44:47], v[116:119], v[84:87], v[44:47]
    v_mul_f32 v20, v20, v16
    v_mul_f32 v16, v6, v16
    s_setprio 2
    v_mfma_f32_16x16x32_bf16 v[40:43], v[112:115], v[84:87], v[40:43]
    v_mul_f32 v21, v21, v17
    v_mul_f32 v17, v6, v17
    ds_read_b128 v[84:87], v2 offset:51712
    s_waitcnt lgkmcnt(5)
    v_mfma_f32_16x16x32_bf16 v[32:35], v[120:123], v[88:91], v[32:35]
    v_mul_f32 v22, v22, v18
    v_mul_f32 v18, v6, v18
    v_mfma_f32_16x16x32_bf16 v[36:39], v[124:127], v[88:91], v[36:39]
    v_mul_f32 v23, v23, v19
    v_mul_f32 v19, v6, v19
    ds_read_b128 v[88:91], v2 offset:53248
    s_add_u32 m0, s33, 96256
    s_nop 0
    buffer_load_dwordx4 v15, s[68:71], s32 offen offset:2048 lds
    s_waitcnt lgkmcnt(5)
    v_mfma_f32_16x16x32_bf16 v[44:47], v[124:127], v[92:95], v[44:47]
    v_exp_f32 v16, v16
    v_mfma_f32_16x16x32_bf16 v[40:43], v[120:123], v[92:95], v[40:43]
    v_exp_f32 v17, v17
    ds_read_b128 v[92:95], v2 offset:53760
    s_waitcnt lgkmcnt(5)
    v_mfma_f32_16x16x32_bf16 v[32:35], v[128:131], v[72:75], v[32:35]
    v_exp_f32 v18, v18
    v_mfma_f32_16x16x32_bf16 v[36:39], v[132:135], v[72:75], v[36:39]
    v_exp_f32 v19, v19
    ds_read_b128 v[72:75], v2 offset:55296
    s_waitcnt lgkmcnt(5)
    v_mfma_f32_16x16x32_bf16 v[44:47], v[132:135], v[76:79], v[44:47]
    v_fma_f32 v16, v16, v7, v7
    v_fma_f32 v17, v17, v7, v7
    s_add_u32 s32, s34, 204800
    s_add_u32 m0, s33, 106496
    s_nop 0
    buffer_load_dwordx4 v15, s[68:71], s32 offen offset:0 lds
    v_mfma_f32_16x16x32_bf16 v[40:43], v[128:131], v[76:79], v[40:43]
    v_fma_f32 v18, v18, v7, v7
    v_fma_f32 v19, v19, v7, v7
    ds_read_b128 v[76:79], v2 offset:55808
    s_waitcnt lgkmcnt(5)
    v_mfma_f32_16x16x32_bf16 v[32:35], v[136:139], v[80:83], v[32:35]
    v_rcp_f32 v16, v16
    s_setprio 1
    v_mfma_f32_16x16x32_bf16 v[36:39], v[140:143], v[80:83], v[36:39]
    v_rcp_f32 v17, v17
    ds_read_b128 v[80:83], v2 offset:57344
    s_waitcnt lgkmcnt(5)
    v_mfma_f32_16x16x32_bf16 v[44:47], v[140:143], v[84:87], v[44:47]
    v_rcp_f32 v18, v18
    v_mfma_f32_16x16x32_bf16 v[40:43], v[136:139], v[84:87], v[40:43]
    v_rcp_f32 v19, v19
    ds_read_b128 v[84:87], v2 offset:57856
    s_waitcnt lgkmcnt(5)
    v_mfma_f32_16x16x32_bf16 v[32:35], v[144:147], v[88:91], v[32:35]
    v_mul_f32 v20, v20, v16
    v_mul_f32 v21, v21, v17
    v_mfma_f32_16x16x32_bf16 v[36:39], v[148:151], v[88:91], v[36:39]
    v_mul_f32 v22, v22, v18
    v_mul_f32 v23, v23, v19
    ds_read_b128 v[88:91], v2 offset:59392
    s_waitcnt lgkmcnt(5)
    v_mfma_f32_16x16x32_bf16 v[44:47], v[148:151], v[92:95], v[44:47]
    v_cvt_pk_bf16_f32 v16, v20, v21
    v_cvt_pk_bf16_f32 v17, v22, v23
    v_mfma_f32_16x16x32_bf16 v[40:43], v[144:147], v[92:95], v[40:43]
    v_mul_f32 v28, v28, v24
    v_mul_f32 v24, v8, v24
    ds_read_b128 v[92:95], v2 offset:59904
    s_waitcnt lgkmcnt(5)
    v_mfma_f32_16x16x32_bf16 v[32:35], v[152:155], v[72:75], v[32:35]
    v_mul_f32 v29, v29, v25
    v_mul_f32 v25, v8, v25
    v_mfma_f32_16x16x32_bf16 v[36:39], v[156:159], v[72:75], v[36:39]
    v_mul_f32 v30, v30, v26
    v_mul_f32 v26, v8, v26
    ds_read_b128 v[72:75], v2 offset:61440
    s_waitcnt lgkmcnt(5)
    v_mfma_f32_16x16x32_bf16 v[44:47], v[156:159], v[76:79], v[44:47]
    v_mul_f32 v31, v31, v27
    v_mul_f32 v27, v8, v27
    s_setprio 0
    v_mfma_f32_16x16x32_bf16 v[40:43], v[152:155], v[76:79], v[40:43]
    v_exp_f32 v24, v24
    ds_read_b128 v[76:79], v2 offset:61952
    s_waitcnt lgkmcnt(5)
    v_mfma_f32_16x16x32_bf16 v[32:35], v[160:163], v[80:83], v[32:35]
    v_exp_f32 v25, v25
    v_mfma_f32_16x16x32_bf16 v[36:39], v[164:167], v[80:83], v[36:39]
    v_exp_f32 v26, v26
    ds_read_b128 v[80:83], v2 offset:63488
    s_waitcnt lgkmcnt(5)
    v_mfma_f32_16x16x32_bf16 v[44:47], v[164:167], v[84:87], v[44:47]
    v_exp_f32 v27, v27
    s_waitcnt vmcnt(4)
    s_barrier
    s_setprio 3
    v_mfma_f32_16x16x32_bf16 v[40:43], v[160:163], v[84:87], v[40:43]
    v_fma_f32 v24, v24, v9, v9
    v_fma_f32 v25, v25, v9, v9
    ds_read_b128 v[84:87], v2 offset:64000
    s_add_u32 m0, s33, 39936
    s_nop 0
    buffer_load_dwordx4 v15, s[68:71], s32 offen offset:1024 lds
    s_waitcnt lgkmcnt(5)
    v_mfma_f32_16x16x32_bf16 v[32:35], v[168:171], v[88:91], v[32:35]
    v_fma_f32 v26, v26, v9, v9
    v_fma_f32 v27, v27, v9, v9
    v_mfma_f32_16x16x32_bf16 v[36:39], v[172:175], v[88:91], v[36:39]
    v_rcp_f32 v24, v24
    ds_read_b128 v[88:91], v2 offset:0
    s_waitcnt lgkmcnt(5)
    v_mfma_f32_16x16x32_bf16 v[44:47], v[172:175], v[92:95], v[44:47]
    v_rcp_f32 v25, v25
    v_mfma_f32_16x16x32_bf16 v[40:43], v[168:171], v[92:95], v[40:43]
    v_rcp_f32 v26, v26
    ds_read_b128 v[92:95], v2 offset:512
    s_add_u32 m0, s33, 47104
    s_nop 0
    buffer_load_dwordx4 v15, s[68:71], s32 offen offset:2048 lds
    s_waitcnt lgkmcnt(5)
    v_mfma_f32_16x16x32_bf16 v[32:35], v[176:179], v[72:75], v[32:35]
    v_rcp_f32 v27, v27
    v_mfma_f32_16x16x32_bf16 v[36:39], v[180:183], v[72:75], v[36:39]
    v_mul_f32 v28, v28, v24
    v_mul_f32 v29, v29, v25
    ds_read_b128 v[72:75], v3 offset:49152
    s_waitcnt lgkmcnt(5)
    v_mfma_f32_16x16x32_bf16 v[44:47], v[180:183], v[76:79], v[44:47]
    v_mul_f32 v30, v30, v26
    v_mul_f32 v31, v31, v27
    v_mfma_f32_16x16x32_bf16 v[40:43], v[176:179], v[76:79], v[40:43]
    v_cvt_pk_bf16_f32 v18, v28, v29
    v_cvt_pk_bf16_f32 v19, v30, v31
    ds_read_b128 v[76:79], v3 offset:49664
    s_waitcnt lgkmcnt(5)
    v_mfma_f32_16x16x32_bf16 v[32:35], v[184:187], v[80:83], v[32:35]
    v_permlane16_swap_b32 v16, v18
    v_permlane16_swap_b32 v17, v19
    s_cmp_eq_u32 s7, 0
    s_cbranch_scc1 XS_19
    buffer_store_dwordx4 v[16:19], v4, s[68:71], s24 offen
XB_20:
    s_add_u32 s24, s24, 385024
    v_mfma_f32_16x16x32_bf16 v[36:39], v[188:191], v[80:83], v[36:39]
    ds_read_b64 v[6:7], v0 offset:4096
    ds_read_b128 v[80:83], v2 offset:2048
    s_waitcnt lgkmcnt(6)
    v_mfma_f32_16x16x32_bf16 v[44:47], v[188:191], v[84:87], v[44:47]
    v_mfma_f32_16x16x32_bf16 v[40:43], v[184:187], v[84:87], v[40:43]
    ds_read_b128 v[84:87], v2 offset:2560
    s_waitcnt lgkmcnt(6)
    v_mfma_f32_16x16x32_bf16 v[48:51], v[96:99], v[88:91], 0
    v_mfma_f32_16x16x32_bf16 v[52:55], v[100:103], v[88:91], 0
    ds_read_b128 v[88:91], v3 offset:51200
    s_waitcnt lgkmcnt(6)
    v_mfma_f32_16x16x32_bf16 v[60:63], v[100:103], v[92:95], 0
    v_mfma_f32_16x16x32_bf16 v[56:59], v[96:99], v[92:95], 0
    ds_read_b128 v[92:95], v3 offset:51712
    s_waitcnt lgkmcnt(6)
    v_mfma_f32_16x16x32_bf16 v[16:19], v[96:99], v[72:75], 0
    v_mfma_f32_16x16x32_bf16 v[20:23], v[100:103], v[72:75], 0
    s_waitcnt lgkmcnt(4)
    v_permlane32_swap_b32 v6, v7
    v_add_f32 v6, v6, v7
    ds_read_b128 v[72:75], v2 offset:4096
    v_mfma_f32_16x16x32_bf16 v[28:31], v[100:103], v[76:79], 0
    v_add_f32_dpp v6, v6, v6 row_ror:8 row_mask:0xf bank_mask:0xf
    v_mov_b32 v7, v6
    v_mfma_f32_16x16x32_bf16 v[24:27], v[96:99], v[76:79], 0
    s_nop 0
    v_permlane16_swap_b32 v6, v7
    v_add_f32 v6, v6, v7
    ds_read_b128 v[76:79], v2 offset:4608
    s_waitcnt lgkmcnt(5)
    v_mfma_f32_16x16x32_bf16 v[48:51], v[104:107], v[80:83], v[48:51]
    v_mul_f32 v8, 0x3acccccd, v6
    v_mul_f32 v7, 0x3acccccd, v6
    s_add_u32 s35, s26, 0
    buffer_load_dwordx4 v[96:99], v15, s[68:71], s35 offen offset:0
    v_mfma_f32_16x16x32_bf16 v[52:55], v[108:111], v[80:83], v[52:55]
    v_permlane32_swap_b32 v8, v7
    v_fma_f32 v7, -v8, v8, v7
    ds_read_b128 v[80:83], v3 offset:53248
    s_waitcnt lgkmcnt(5)
    v_mfma_f32_16x16x32_bf16 v[60:63], v[108:111], v[84:87], v[60:63]
    v_max_f32 v7, 0, v7
    v_add_f32 v7, 0x3727c5ac, v7
    v_mfma_f32_16x16x32_bf16 v[56:59], v[104:107], v[84:87], v[56:59]
    v_rsq_f32 v6, v7
    ds_read_b128 v[84:87], v3 offset:53760
    s_waitcnt lgkmcnt(5)
    v_mfma_f32_16x16x32_bf16 v[16:19], v[104:107], v[88:91], v[16:19]
    v_mul_f32 v6, 0xbfb8aa3b, v6
    buffer_load_dwordx4 v[100:103], v15, s[68:71], s35 offen offset:1024
    v_mfma_f32_16x16x32_bf16 v[20:23], v[108:111], v[88:91], v[20:23]
    v_permlane32_swap_b32 v6, v8
    ds_write_b64 v0, v[6:7] offset:4096
    ds_read_b64 v[6:7], v5 offset:256
    ds_read_b128 v[88:91], v2 offset:6144
    s_waitcnt lgkmcnt(7)
    v_mfma_f32_16x16x32_bf16 v[28:31], v[108:111], v[92:95], v[28:31]
    ds_read_b64 v[8:9], v5 offset:384
    v_mfma_f32_16x16x32_bf16 v[24:27], v[104:107], v[92:95], v[24:27]
    ds_read_b128 v[92:95], v2 offset:6656
    s_waitcnt lgkmcnt(8)
    v_mfma_f32_16x16x32_bf16 v[48:51], v[112:115], v[72:75], v[48:51]
    s_setprio 2
    v_mfma_f32_16x16x32_bf16 v[52:55], v[116:119], v[72:75], v[52:55]
    ds_read_b128 v[72:75], v3 offset:55296
    s_waitcnt vmcnt(2)
    s_mov_b64 exec, 1
    s_cmp_eq_u32 s7, 0
    s_cbranch_scc1 XS_21
    buffer_store_dword v13, v15, s[68:71], s25 offen offset:1024
XB_22:
    s_mov_b64 exec, -1
    buffer_load_dwordx4 v[104:107], v15, s[68:71], s35 offen offset:2048
    s_waitcnt lgkmcnt(8)
    v_mfma_f32_16x16x32_bf16 v[60:63], v[116:119], v[76:79], v[60:63]
    v_mfma_f32_16x16x32_bf16 v[56:59], v[112:115], v[76:79], v[56:59]
    ds_read_b128 v[76:79], v3 offset:55808
    s_waitcnt lgkmcnt(8)
    v_mfma_f32_16x16x32_bf16 v[16:19], v[112:115], v[80:83], v[16:19]
    v_mfma_f32_16x16x32_bf16 v[20:23], v[116:119], v[80:83], v[20:23]
    ds_read_b128 v[80:83], v2 offset:8192
    s_waitcnt lgkmcnt(8)
    v_mfma_f32_16x16x32_bf16 v[28:31], v[116:119], v[84:87], v[28:31]
    buffer_load_dwordx4 v[108:111], v15, s[68:71], s35 offen offset:3072
    v_mfma_f32_16x16x32_bf16 v[24:27], v[112:115], v[84:87], v[24:27]
    ds_read_b128 v[84:87], v2 offset:8704
    s_waitcnt lgkmcnt(6)
    v_mfma_f32_16x16x32_bf16 v[48:51], v[120:123], v[88:91], v[48:51]
    v_mfma_f32_16x16x32_bf16 v[52:55], v[124:127], v[88:91], v[52:55]
    ds_read_b128 v[88:91], v3 offset:57344
    s_waitcnt lgkmcnt(5)
    v_mfma_f32_16x16x32_bf16 v[60:63], v[124:127], v[92:95], v[60:63]
    v_mfma_f32_16x16x32_bf16 v[56:59], v[120:123], v[92:95], v[56:59]
    ds_read_b128 v[92:95], v3 offset:57856
    s_add_u32 s35, s26, 4096
    buffer_load_dwordx4 v[112:115], v15, s[68:71], s35 offen offset:0
    s_waitcnt lgkmcnt(5)
    v_mfma_f32_16x16x32_bf16 v[16:19], v[120:123], v[72:75], v[16:19]
    v_mfma_f32_16x16x32_bf16 v[20:23], v[124:127], v[72:75], v[20:23]
    ds_read_b128 v[72:75], v2 offset:10240
    s_waitcnt lgkmcnt(5)
    v_mfma_f32_16x16x32_bf16 v[28:31], v[124:127], v[76:79], v[28:31]
    v_mfma_f32_16x16x32_bf16 v[24:27], v[120:123], v[76:79], v[24:27]
    ds_read_b128 v[76:79], v2 offset:10752
    s_waitcnt lgkmcnt(5)
    v_mfma_f32_16x16x32_bf16 v[48:51], v[128:131], v[80:83], v[48:51]
    s_add_u32 s35, s26, 40960
    buffer_load_dwordx4 v[116:119], v15, s[68:71], s35 offen offset:0
    v_mfma_f32_16x16x32_bf16 v[52:55], v[132:135], v[80:83], v[52:55]
    ds_read_b128 v[80:83], v3 offset:59392
    s_waitcnt lgkmcnt(5)
    v_mfma_f32_16x16x32_bf16 v[60:63], v[132:135], v[84:87], v[60:63]
    v_mfma_f32_16x16x32_bf16 v[56:59], v[128:131], v[84:87], v[56:59]
    ds_read_b128 v[84:87], v3 offset:59904
    s_waitcnt lgkmcnt(5)
    v_mfma_f32_16x16x32_bf16 v[16:19], v[128:131], v[88:91], v[16:19]
    v_mfma_f32_16x16x32_bf16 v[20:23], v[132:135], v[88:91], v[20:23]
    ds_read_b128 v[88:91], v2 offset:12288
    buffer_load_dwordx4 v[120:123], v15, s[68:71], s35 offen offset:1024
    s_waitcnt lgkmcnt(5)
    v_mfma_f32_16x16x32_bf16 v[28:31], v[132:135], v[92:95], v[28:31]
    v_mfma_f32_16x16x32_bf16 v[24:27], v[128:131], v[92:95], v[24:27]
    ds_read_b128 v[92:95], v2 offset:12800
    s_waitcnt lgkmcnt(5)
    v_mfma_f32_16x16x32_bf16 v[48:51], v[136:139], v[72:75], v[48:51]
    v_mfma_f32_16x16x32_bf16 v[52:55], v[140:143], v[72:75], v[52:55]
    ds_read_b128 v[72:75], v3 offset:61440
    s_waitcnt lgkmcnt(5)
    v_mfma_f32_16x16x32_bf16 v[60:63], v[140:143], v[76:79], v[60:63]
    buffer_load_dwordx4 v[124:127], v15, s[68:71], s35 offen offset:2048
    v_mfma_f32_16x16x32_bf16 v[56:59], v[136:139], v[76:79], v[56:59]
    ds_read_b128 v[76:79], v3 offset:61952
    s_waitcnt lgkmcnt(5)
    v_mfma_f32_16x16x32_bf16 v[16:19], v[136:139], v[80:83], v[16:19]
    v_mfma_f32_16x16x32_bf16 v[20:23], v[140:143], v[80:83], v[20:23]
    ds_read_b128 v[80:83], v2 offset:14336
    s_waitcnt lgkmcnt(5)
    v_mfma_f32_16x16x32_bf16 v[28:31], v[140:143], v[84:87], v[28:31]
    s_setprio 1
    v_mfma_f32_16x16x32_bf16 v[24:27], v[136:139], v[84:87], v[24:27]
    ds_read_b128 v[84:87], v2 offset:14848
    buffer_load_dwordx4 v[128:131], v15, s[68:71], s35 offen offset:3072
    s_waitcnt lgkmcnt(5)
    v_mfma_f32_16x16x32_bf16 v[48:51], v[144:147], v[88:91], v[48:51]
    v_mfma_f32_16x16x32_bf16 v[52:55], v[148:151], v[88:91], v[52:55]
    ds_read_b128 v[88:91], v3 offset:63488
    s_waitcnt lgkmcnt(5)
    v_mfma_f32_16x16x32_bf16 v[60:63], v[148:151], v[92:95], v[60:63]
    v_mfma_f32_16x16x32_bf16 v[56:59], v[144:147], v[92:95], v[56:59]
    ds_read_b128 v[92:95], v3 offset:64000
    s_waitcnt lgkmcnt(5)
    v_mfma_f32_16x16x32_bf16 v[16:19], v[144:147], v[72:75], v[16:19]
    s_add_u32 s35, s26, 45056
    buffer_load_dwordx4 v[132:135], v15, s[68:71], s35 offen offset:0
    v_mfma_f32_16x16x32_bf16 v[20:23], v[148:151], v[72:75], v[20:23]
    ds_read_b128 v[72:75], v2 offset:16384
    s_waitcnt lgkmcnt(5)
    v_mfma_f32_16x16x32_bf16 v[28:31], v[148:151], v[76:79], v[28:31]
    v_mfma_f32_16x16x32_bf16 v[24:27], v[144:147], v[76:79], v[24:27]
    ds_read_b128 v[76:79], v2 offset:16896
    s_waitcnt lgkmcnt(5)
    v_mfma_f32_16x16x32_bf16 v[48:51], v[152:155], v[80:83], v[48:51]
    v_mfma_f32_16x16x32_bf16 v[52:55], v[156:159], v[80:83], v[52:55]
    ds_read_b128 v[80:83], v12 offset:0
    s_add_u32 s35, s26, 81920
    buffer_load_dwordx4 v[136:139], v15, s[68:71], s35 offen offset:0
    s_waitcnt lgkmcnt(5)
    v_mfma_f32_16x16x32_bf16 v[60:63], v[156:159], v[84:87], v[60:63]
    v_mfma_f32_16x16x32_bf16 v[56:59], v[152:155], v[84:87], v[56:59]
    ds_read_b128 v[84:87], v12 offset:512
    s_waitcnt lgkmcnt(5)
    v_mfma_f32_16x16x32_bf16 v[16:19], v[152:155], v[88:91], v[16:19]
    v_mfma_f32_16x16x32_bf16 v[20:23], v[156:159], v[88:91], v[20:23]
    ds_read_b128 v[88:91], v2 offset:18432
    s_waitcnt lgkmcnt(5)
    v_mfma_f32_16x16x32_bf16 v[28:31], v[156:159], v[92:95], v[28:31]
    buffer_load_dwordx4 v[140:143], v15, s[68:71], s35 offen offset:1024
    v_mfma_f32_16x16x32_bf16 v[24:27], v[152:155], v[92:95], v[24:27]
    ds_read_b128 v[92:95], v2 offset:18944
    s_waitcnt lgkmcnt(5)
    v_mfma_f32_16x16x32_bf16 v[48:51], v[160:163], v[72:75], v[48:51]
    v_mfma_f32_16x16x32_bf16 v[52:55], v[164:167], v[72:75], v[52:55]
    ds_read_b128 v[72:75], v12 offset:2048
    s_waitcnt lgkmcnt(5)
    v_mfma_f32_16x16x32_bf16 v[60:63], v[164:167], v[76:79], v[60:63]
    v_mfma_f32_16x16x32_bf16 v[56:59], v[160:163], v[76:79], v[56:59]
    ds_read_b128 v[76:79], v12 offset:2560
    buffer_load_dwordx4 v[144:147], v15, s[68:71], s35 offen offset:2048
    s_waitcnt lgkmcnt(5)
    v_mfma_f32_16x16x32_bf16 v[16:19], v[160:163], v[80:83], v[16:19]
    v_mfma_f32_16x16x32_bf16 v[20:23], v[164:167], v[80:83], v[20:23]
    ds_read_b128 v[80:83], v3 offset:0
    s_waitcnt lgkmcnt(5)
    v_mfma_f32_16x16x32_bf16 v[28:31], v[164:167], v[84:87], v[28:31]
    v_mfma_f32_16x16x32_bf16 v[24:27], v[160:163], v[84:87], v[24:27]
    ds_read_b128 v[84:87], v3 offset:512
    s_waitcnt lgkmcnt(5)
    v_mfma_f32_16x16x32_bf16 v[48:51], v[168:171], v[88:91], v[48:51]
    buffer_load_dword v1, v14, s[68:71], s28 offen offset:1024 sc1
    buffer_load_dwordx4 v[148:151], v15, s[68:71], s35 offen offset:3072
    v_mfma_f32_16x16x32_bf16 v[52:55], v[172:175], v[88:91], v[52:55]
    ds_read_b128 v[88:91], v3 offset:2048
    s_waitcnt lgkmcnt(5)
    v_mfma_f32_16x16x32_bf16 v[60:63], v[172:175], v[92:95], v[60:63]
    v_mfma_f32_16x16x32_bf16 v[56:59], v[168:171], v[92:95], v[56:59]
    ds_read_b128 v[92:95], v3 offset:2560
    s_waitcnt lgkmcnt(5)
    v_mfma_f32_16x16x32_bf16 v[16:19], v[168:171], v[72:75], v[16:19]
    s_setprio 0
    v_mfma_f32_16x16x32_bf16 v[20:23], v[172:175], v[72:75], v[20:23]
    ds_read_b128 v[72:75], v3 offset:4096
    s_add_u32 s35, s26, 86016
    buffer_load_dwordx4 v[152:155], v15, s[68:71], s35 offen offset:0
    s_waitcnt lgkmcnt(5)
    v_mfma_f32_16x16x32_bf16 v[28:31], v[172:175], v[76:79], v[28:31]
    v_mfma_f32_16x16x32_bf16 v[24:27], v[168:171], v[76:79], v[24:27]
    ds_read_b128 v[76:79], v3 offset:4608
    s_waitcnt lgkmcnt(5)
    v_mfma_f32_16x16x32_bf16 v[32:35], v[192:195], v[80:83], v[32:35]
    s_barrier
    s_setprio 3
    v_mfma_f32_16x16x32_bf16 v[36:39], v[196:199], v[80:83], v[36:39]
    ds_read_b128 v[80:83], v3 offset:6144
    s_waitcnt lgkmcnt(5)
    v_mfma_f32_16x16x32_bf16 v[44:47], v[196:199], v[84:87], v[44:47]
    ds_read_b32 v10, v5 offset:6400
    ds_read_b32 v11, v5 offset:6528
    s_add_u32 s32, s34, 207872
    s_add_u32 m0, s33, 0
    s_nop 0
    buffer_load_dwordx4 v15, s[68:71], s32 offen offset:0 lds
    v_mfma_f32_16x16x32_bf16 v[40:43], v[192:195], v[84:87], v[40:43]
    ds_read_b128 v[84:87], v3 offset:6656
    s_waitcnt lgkmcnt(7)
    v_mfma_f32_16x16x32_bf16 v[32:35], v[200:203], v[88:91], v[32:35]
    v_mfma_f32_16x16x32_bf16 v[36:39], v[204:207], v[88:91], v[36:39]
    ds_read_b128 v[88:91], v3 offset:8192
    s_waitcnt lgkmcnt(7)
    v_mfma_f32_16x16x32_bf16 v[44:47], v[204:207], v[92:95], v[44:47]
    v_mfma_f32_16x16x32_bf16 v[40:43], v[200:203], v[92:95], v[40:43]
    ds_read_b128 v[92:95], v3 offset:8704
    s_add_u32 m0, s33, 7168
    s_nop 0
    buffer_load_dwordx4 v15, s[68:71], s32 offen offset:1024 lds
    s_waitcnt lgkmcnt(7)
    v_mfma_f32_16x16x32_bf16 v[32:35], v[208:211], v[72:75], v[32:35]
    v_mfma_f32_16x16x32_bf16 v[36:39], v[212:215], v[72:75], v[36:39]
    ds_read_b128 v[72:75], v3 offset:10240
    s_waitcnt lgkmcnt(7)
    s_setprio 2
    v_mfma_f32_16x16x32_bf16 v[44:47], v[212:215], v[76:79], v[44:47]
    s_waitcnt lgkmcnt(4)
    v_fma_f32 v48, -v10, v64, v48
    v_fma_f32 v49, -v10, v65, v49
    v_mfma_f32_16x16x32_bf16 v[40:43], v[208:211], v[76:79], v[40:43]
    v_fma_f32 v50, -v10, v66, v50
    v_fma_f32 v51, -v10, v67, v51
    ds_read_b128 v[76:79], v3 offset:10752
    v_mfma_f32_16x16x32_bf16 v[32:35], v[216:219], v[80:83], v[32:35]
    v_fma_f32 v52, -v10, v68, v52
    v_fma_f32 v53, -v10, v69, v53
    s_add_u32 s32, s34, 245760
    s_add_u32 m0, s33, 57344
    s_nop 0
    buffer_load_dwordx4 v15, s[68:71], s32 offen offset:0 lds
    v_mfma_f32_16x16x32_bf16 v[36:39], v[220:223], v[80:83], v[36:39]
    v_fma_f32 v54, -v10, v70, v54
    v_fma_f32 v55, -v10, v71, v55
    ds_read_b128 v[80:83], v3 offset:12288
    s_waitcnt lgkmcnt(5)
    v_mfma_f32_16x16x32_bf16 v[44:47], v[220:223], v[84:87], v[44:47]
    v_fma_f32 v56, -v11, v64, v56
    v_fma_f32 v57, -v11, v65, v57
    v_mfma_f32_16x16x32_bf16 v[40:43], v[216:219], v[84:87], v[40:43]
    v_fma_f32 v58, -v11, v66, v58
    v_fma_f32 v59, -v11, v67, v59
    ds_read_b128 v[84:87], v3 offset:12800
    s_waitcnt lgkmcnt(5)
    v_mfma_f32_16x16x32_bf16 v[32:35], v[224:227], v[88:91], v[32:35]
    v_fma_f32 v60, -v11, v68, v60
    v_fma_f32 v61, -v11, v69, v61
    v_mfma_f32_16x16x32_bf16 v[36:39], v[228:231], v[88:91], v[36:39]
    v_fma_f32 v62, -v11, v70, v62
    v_fma_f32 v63, -v11, v71, v63
    ds_read_b128 v[88:91], v3 offset:14336
    s_waitcnt vmcnt(5)
    v_cmp_ne_u32 vcc, s4, v1
    s_cbranch_vccnz GFP0
GFB0:
    s_add_u32 m0, s33, 113664
    s_nop 0
    buffer_load_dwordx4 v15, s[68:71], s32 offen offset:1024 lds
    s_waitcnt lgkmcnt(5)
    v_mfma_f32_16x16x32_bf16 v[44:47], v[228:231], v[92:95], v[44:47]
    ds_read_b32 v10, v5 offset:6144
    ds_read_b32 v11, v5 offset:6272
    s_setprio 1
    v_mfma_f32_16x16x32_bf16 v[40:43], v[224:227], v[92:95], v[40:43]
    ds_read_b128 v[92:95], v3 offset:14848
    s_waitcnt lgkmcnt(7)
    v_mfma_f32_16x16x32_bf16 v[32:35], v[232:235], v[72:75], v[32:35]
    v_mfma_f32_16x16x32_bf16 v[36:39], v[236:239], v[72:75], v[36:39]
    ds_read_b128 v[72:75], v2 offset:20480
    s_waitcnt lgkmcnt(7)
    v_mfma_f32_16x16x32_bf16 v[44:47], v[236:239], v[76:79], v[44:47]
    s_add_u32 m0, s33, 120832
    s_nop 0
    buffer_load_dwordx4 v15, s[68:71], s32 offen offset:2048 lds
    v_mfma_f32_16x16x32_bf16 v[40:43], v[232:235], v[76:79], v[40:43]
    ds_read_b128 v[76:79], v2 offset:20992
    s_waitcnt lgkmcnt(7)
    v_mfma_f32_16x16x32_bf16 v[32:35], v[240:243], v[80:83], v[32:35]
    v_mfma_f32_16x16x32_bf16 v[36:39], v[244:247], v[80:83], v[36:39]
    ds_read_b128 v[80:83], v2 offset:22528
    s_waitcnt lgkmcnt(7)
    v_mfma_f32_16x16x32_bf16 v[44:47], v[244:247], v[84:87], v[44:47]
    s_waitcnt lgkmcnt(4)
    v_fma_f32 v16, -v10, v64, v16
    v_fma_f32 v17, -v10, v65, v17
    v_mfma_f32_16x16x32_bf16 v[40:43], v[240:243], v[84:87], v[40:43]
    v_fma_f32 v18, -v10, v66, v18
    v_fma_f32 v19, -v10, v67, v19
    ds_read_b128 v[84:87], v2 offset:23040
    s_add_u32 s35, s26, 122880
    buffer_load_dwordx4 v[156:159], v15, s[68:71], s35 offen offset:0
    v_mfma_f32_16x16x32_bf16 v[32:35], v[248:251], v[88:91], v[32:35]
    v_fma_f32 v20, -v10, v68, v20
    v_fma_f32 v21, -v10, v69, v21
    s_setprio 0
    v_mfma_f32_16x16x32_bf16 v[36:39], v[252:255], v[88:91], v[36:39]
    v_fma_f32 v22, -v10, v70, v22
    v_fma_f32 v23, -v10, v71, v23
    ds_read_b128 v[88:91], v2 offset:24576
    s_waitcnt lgkmcnt(5)
    v_mfma_f32_16x16x32_bf16 v[44:47], v[252:255], v[92:95], v[44:47]
    v_fma_f32 v24, -v11, v64, v24
    v_fma_f32 v25, -v11, v65, v25
    v_mfma_f32_16x16x32_bf16 v[40:43], v[248:251], v[92:95], v[40:43]
    v_fma_f32 v26, -v11, v66, v26
    v_fma_f32 v27, -v11, v67, v27
    ds_read_b128 v[92:95], v2 offset:25088
    s_waitcnt lgkmcnt(5)
    v_mfma_f32_16x16x32_bf16 v[48:51], v[176:179], v[72:75], v[48:51]
WST28672:
    s_cbranch_execz WST32768
    v_fma_f32 v28, -v11, v68, v28
    v_fma_f32 v29, -v11, v69, v29
    s_barrier
    buffer_load_dwordx4 v[160:163], v15, s[68:71], s35 offen offset:1024
    s_setprio 3
    v_mfma_f32_16x16x32_bf16 v[52:55], v[180:183], v[72:75], v[52:55]
    v_fma_f32 v30, -v11, v70, v30
    v_fma_f32 v31, -v11, v71, v31
    ds_read_b128 v[72:75], v2 offset:26624
    s_waitcnt lgkmcnt(5)
    v_mfma_f32_16x16x32_bf16 v[60:63], v[180:183], v[76:79], v[60:63]
    v_add_u32 v10, s33, v15
    v_add_u32 v11, 0x10000, v10
    v_mfma_f32_16x16x32_bf16 v[56:59], v[176:179], v[76:79], v[56:59]
    v_mul_f32 v36, v36, v32
    v_mul_f32 v32, v6, v32
    ds_read_b128 v[76:79], v2 offset:27136
    s_waitcnt lgkmcnt(5)
    v_mfma_f32_16x16x32_bf16 v[48:51], v[184:187], v[80:83], v[48:51]
    v_mul_f32 v37, v37, v33
    v_mul_f32 v33, v6, v33
    v_mfma_f32_16x16x32_bf16 v[52:55], v[188:191], v[80:83], v[52:55]
    v_mul_f32 v38, v38, v34
    v_mul_f32 v34, v6, v34
    ds_read_b128 v[80:83], v2 offset:28672
    s_add_u32 m0, s33, 62464
    s_nop 0
    buffer_load_dwordx4 v15, s[68:71], s32 offen offset:3072 lds
    s_waitcnt lgkmcnt(5)
    v_mfma_f32_16x16x32_bf16 v[60:63], v[188:191], v[84:87], v[60:63]
    v_mul_f32 v39, v39, v35
    v_mul_f32 v35, v6, v35
    v_mfma_f32_16x16x32_bf16 v[56:59], v[184:187], v[84:87], v[56:59]
    v_exp_f32 v32, v32
    ds_read_b128 v[84:87], v2 offset:29184
    s_waitcnt lgkmcnt(5)
    v_mfma_f32_16x16x32_bf16 v[48:51], v[192:195], v[88:91], v[48:51]
    v_exp_f32 v33, v33
    v_mfma_f32_16x16x32_bf16 v[52:55], v[196:199], v[88:91], v[52:55]
    v_exp_f32 v34, v34
    ds_read_b128 v[88:91], v2 offset:30720
    s_waitcnt lgkmcnt(5)
    v_mfma_f32_16x16x32_bf16 v[60:63], v[196:199], v[92:95], v[60:63]
    v_exp_f32 v35, v35
    s_add_u32 s32, s34, 249856
    s_add_u32 m0, s33, 73728
    s_nop 0
    buffer_load_dwordx4 v15, s[68:71], s32 offen offset:0 lds
    v_mfma_f32_16x16x32_bf16 v[56:59], v[192:195], v[92:95], v[56:59]
    v_fma_f32 v32, v32, v7, v7
    v_fma_f32 v33, v33, v7, v7
    ds_read_b128 v[92:95], v2 offset:31232
    s_waitcnt lgkmcnt(5)
    v_mfma_f32_16x16x32_bf16 v[48:51], v[200:203], v[72:75], v[48:51]
    v_fma_f32 v34, v34, v7, v7
    v_fma_f32 v35, v35, v7, v7
    ds_read_b64 v[6:7], v5 offset:4096
    v_mfma_f32_16x16x32_bf16 v[52:55], v[204:207], v[72:75], v[52:55]
    v_rcp_f32 v32, v32
    ds_read_b128 v[72:75], v2 offset:32768
    s_waitcnt lgkmcnt(6)
    v_mfma_f32_16x16x32_bf16 v[60:63], v[204:207], v[76:79], v[60:63]
    v_rcp_f32 v33, v33
    v_mfma_f32_16x16x32_bf16 v[56:59], v[200:203], v[76:79], v[56:59]
    v_rcp_f32 v34, v34
    ds_read_b128 v[76:79], v2 offset:33280
    buffer_load_dwordx4 v[64:67], v15, s[68:71], s27 offen offset:0 sc1
    s_waitcnt lgkmcnt(6)
    v_mfma_f32_16x16x32_bf16 v[48:51], v[208:211], v[80:83], v[48:51]
    v_rcp_f32 v35, v35
    v_mfma_f32_16x16x32_bf16 v[52:55], v[212:215], v[80:83], v[52:55]
    v_mul_f32 v36, v36, v32
    v_mul_f32 v37, v37, v33
    ds_read_b128 v[80:83], v2 offset:34816
    s_waitcnt lgkmcnt(6)
    v_mfma_f32_16x16x32_bf16 v[60:63], v[212:215], v[84:87], v[60:63]
    v_mul_f32 v38, v38, v34
    v_mul_f32 v39, v39, v35
    v_mfma_f32_16x16x32_bf16 v[56:59], v[208:211], v[84:87], v[56:59]
    v_cvt_pk_bf16_f32 v32, v36, v37
    v_cvt_pk_bf16_f32 v33, v38, v39
    ds_read_b128 v[84:87], v2 offset:35328
    s_waitcnt lgkmcnt(6)
    v_mfma_f32_16x16x32_bf16 v[48:51], v[216:219], v[88:91], v[48:51]
    v_mul_f32 v44, v44, v40
    v_mul_f32 v40, v8, v40
    buffer_load_dwordx4 v[68:71], v15, s[68:71], s27 offen offset:1024 sc1
    v_mfma_f32_16x16x32_bf16 v[52:55], v[220:223], v[88:91], v[52:55]
    v_mul_f32 v45, v45, v41
    v_mul_f32 v41, v8, v41
    ds_read_b128 v[88:91], v2 offset:36864
    s_waitcnt lgkmcnt(6)
    v_mfma_f32_16x16x32_bf16 v[60:63], v[220:223], v[92:95], v[60:63]
    v_mul_f32 v46, v46, v42
    v_mul_f32 v42, v8, v42
    v_mfma_f32_16x16x32_bf16 v[56:59], v[216:219], v[92:95], v[56:59]
    v_mul_f32 v47, v47, v43
    v_mul_f32 v43, v8, v43
    ds_read_b128 v[92:95], v2 offset:37376
    s_waitcnt lgkmcnt(5)
    v_mfma_f32_16x16x32_bf16 v[48:51], v[224:227], v[72:75], v[48:51]
    v_exp_f32 v40, v40
    v_mfma_f32_16x16x32_bf16 v[52:55], v[228:231], v[72:75], v[52:55]
    v_exp_f32 v41, v41
    ds_read_b128 v[72:75], v2 offset:38912
    buffer_load_dwordx4 v[164:167], v15, s[68:71], s35 offen offset:2048
    s_waitcnt lgkmcnt(5)
    v_mfma_f32_16x16x32_bf16 v[60:63], v[228:231], v[76:79], v[60:63]
    v_exp_f32 v42, v42
    v_mfma_f32_16x16x32_bf16 v[56:59], v[224:227], v[76:79], v[56:59]
    v_exp_f32 v43, v43
    ds_read_b128 v[76:79], v2 offset:39424
    s_waitcnt lgkmcnt(5)
    v_mfma_f32_16x16x32_bf16 v[48:51], v[232:235], v[80:83], v[48:51]
    v_fma_f32 v40, v40, v9, v9
    v_fma_f32 v41, v41, v9, v9
    v_mfma_f32_16x16x32_bf16 v[52:55], v[236:239], v[80:83], v[52:55]
    v_fma_f32 v42, v42, v9, v9
    v_fma_f32 v43, v43, v9, v9
    ds_read_b64 v[8:9], v5 offset:4224
    ds_read_b128 v[80:83], v12 offset:4096
    s_waitcnt lgkmcnt(6)
    v_mfma_f32_16x16x32_bf16 v[60:63], v[236:239], v[84:87], v[60:63]
    v_rcp_f32 v40, v40
    buffer_load_dwordx4 v[168:171], v15, s[68:71], s35 offen offset:3072
    v_mfma_f32_16x16x32_bf16 v[56:59], v[232:235], v[84:87], v[56:59]
    v_rcp_f32 v41, v41
    ds_read_b128 v[84:87], v12 offset:4608
    s_waitcnt lgkmcnt(6)
    v_mfma_f32_16x16x32_bf16 v[48:51], v[240:243], v[88:91], v[48:51]
    v_rcp_f32 v42, v42
    v_mfma_f32_16x16x32_bf16 v[52:55], v[244:247], v[88:91], v[52:55]
    v_rcp_f32 v43, v43
    ds_read_b128 v[88:91], v12 offset:6144
    s_waitcnt lgkmcnt(6)
    v_mfma_f32_16x16x32_bf16 v[60:63], v[244:247], v[92:95], v[60:63]
    v_mul_f32 v44, v44, v40
    v_mul_f32 v45, v45, v41
    v_mfma_f32_16x16x32_bf16 v[56:59], v[240:243], v[92:95], v[56:59]
    v_mul_f32 v46, v46, v42
    v_mul_f32 v47, v47, v43
    ds_read_b128 v[92:95], v12 offset:6656
    s_add_u32 s35, s26, 126976
    buffer_load_dwordx4 v[172:175], v15, s[68:71], s35 offen offset:0
    s_waitcnt lgkmcnt(6)
    v_mfma_f32_16x16x32_bf16 v[48:51], v[248:251], v[72:75], v[48:51]
    v_cvt_pk_bf16_f32 v34, v44, v45
    v_cvt_pk_bf16_f32 v35, v46, v47
    s_setprio 2
    v_mfma_f32_16x16x32_bf16 v[52:55], v[252:255], v[72:75], v[52:55]
    v_permlane16_swap_b32 v32, v34
    v_permlane16_swap_b32 v33, v35
    s_cmp_eq_u32 s7, 0
    s_cbranch_scc1 XS_23
    buffer_store_dwordx4 v[32:35], v4, s[68:71], s24 offen
XB_24:
    s_mul_i32 s10, s17, 221184
    s_sub_u32 s24, s24, s10
    s_sub_u32 s24, s24, 274432
    ds_read_b128 v[72:75], v12 offset:8192
    s_waitcnt lgkmcnt(6)
    v_mfma_f32_16x16x32_bf16 v[60:63], v[252:255], v[76:79], v[60:63]
    v_mfma_f32_16x16x32_bf16 v[56:59], v[248:251], v[76:79], v[56:59]
    ds_read_b128 v[76:79], v12 offset:8704
    s_waitcnt lgkmcnt(5)
    v_mfma_f32_16x16x32_bf16 v[16:19], v[176:179], v[80:83], v[16:19]
    buffer_load_dwordx4 v[36:39], v15, s[68:71], s27 offen offset:2048 sc1
    v_mfma_f32_16x16x32_bf16 v[20:23], v[180:183], v[80:83], v[20:23]
    ds_read_b128 v[80:83], v12 offset:10240
    s_waitcnt lgkmcnt(5)
    v_mfma_f32_16x16x32_bf16 v[28:31], v[180:183], v[84:87], v[28:31]
    v_mul_f32 v52, v52, v48
    v_mul_f32 v48, v6, v48
    v_mfma_f32_16x16x32_bf16 v[24:27], v[176:179], v[84:87], v[24:27]
    v_mul_f32 v53, v53, v49
    v_mul_f32 v49, v6, v49
    ds_read_b128 v[84:87], v12 offset:10752
    s_waitcnt lgkmcnt(5)
    v_mfma_f32_16x16x32_bf16 v[16:19], v[184:187], v[88:91], v[16:19]
    v_mul_f32 v54, v54, v50
    v_mul_f32 v50, v6, v50
    v_mfma_f32_16x16x32_bf16 v[20:23], v[188:191], v[88:91], v[20:23]
    v_mul_f32 v55, v55, v51
    v_mul_f32 v51, v6, v51
    ds_read_b128 v[88:91], v12 offset:12288
    buffer_load_dwordx4 v[40:43], v15, s[68:71], s27 offen offset:3072 sc1
    s_waitcnt lgkmcnt(5)
    v_mfma_f32_16x16x32_bf16 v[28:31], v[188:191], v[92:95], v[28:31]
    v_exp_f32 v48, v48
    v_mfma_f32_16x16x32_bf16 v[24:27], v[184:187], v[92:95], v[24:27]
    v_exp_f32 v49, v49
    ds_read_b128 v[92:95], v12 offset:12800
    s_waitcnt lgkmcnt(5)
    v_mfma_f32_16x16x32_bf16 v[16:19], v[192:195], v[72:75], v[16:19]
    v_exp_f32 v50, v50
    ds_read_b128 v[184:187], v11 offset:16384
    v_mfma_f32_16x16x32_bf16 v[20:23], v[196:199], v[72:75], v[20:23]
    v_exp_f32 v51, v51
    ds_read_b128 v[72:75], v12 offset:14336
    s_waitcnt lgkmcnt(6)
    v_mfma_f32_16x16x32_bf16 v[28:31], v[196:199], v[76:79], v[28:31]
    v_fma_f32 v48, v48, v7, v7
    v_fma_f32 v49, v49, v7, v7
    ds_read_b128 v[188:191], v11 offset:24576
    s_add_u32 s35, s26, 163840
    buffer_load_dwordx4 v[176:179], v15, s[68:71], s35 offen offset:0
    v_mfma_f32_16x16x32_bf16 v[24:27], v[192:195], v[76:79], v[24:27]
    v_fma_f32 v50, v50, v7, v7
    v_fma_f32 v51, v51, v7, v7
    ds_read_b64 v[6:7], v5 offset:4352
    ds_read_b128 v[76:79], v12 offset:14848
    s_waitcnt lgkmcnt(8)
    v_mfma_f32_16x16x32_bf16 v[16:19], v[200:203], v[80:83], v[16:19]
    v_rcp_f32 v48, v48
    ds_read_b128 v[192:195], v11 offset:32768
    v_mfma_f32_16x16x32_bf16 v[20:23], v[204:207], v[80:83], v[20:23]
    v_rcp_f32 v49, v49
    ds_read_b128 v[80:83], v12 offset:16384
    s_waitcnt lgkmcnt(9)
    v_mfma_f32_16x16x32_bf16 v[28:31], v[204:207], v[84:87], v[28:31]
    v_rcp_f32 v50, v50
    ds_read_b128 v[196:199], v11 offset:40960
    s_waitcnt vmcnt(3)
    s_mov_b64 exec, 1
    s_cmp_eq_u32 s7, 0
    s_cbranch_scc1 XS_25
    buffer_store_dword v13, v15, s[68:71], s25 offen offset:1536
XB_26:
    s_mov_b64 exec, -1
    v_mfma_f32_16x16x32_bf16 v[24:27], v[200:203], v[84:87], v[24:27]
    v_rcp_f32 v51, v51
    ds_read_b128 v[84:87], v12 offset:16896
    s_add_u32 s29, s27, 4096
    s_add_u32 s27, s27, 385024
    buffer_load_dwordx4 v[44:47], v15, s[68:71], s29 offen offset:0 sc1
    s_or_b32 s29, s29, s31
    s_waitcnt lgkmcnt(10)
    v_mfma_f32_16x16x32_bf16 v[16:19], v[208:211], v[88:91], v[16:19]
    v_mul_f32 v52, v52, v48
    v_mul_f32 v53, v53, v49
    ds_read_b128 v[200:203], v10 offset:40960
    v_mfma_f32_16x16x32_bf16 v[20:23], v[212:215], v[88:91], v[20:23]
    v_mul_f32 v54, v54, v50
    v_mul_f32 v55, v55, v51
    ds_read_b128 v[88:91], v12 offset:18432
    s_waitcnt lgkmcnt(11)
    v_mfma_f32_16x16x32_bf16 v[28:31], v[212:215], v[92:95], v[28:31]
    v_cvt_pk_bf16_f32 v48, v52, v53
    v_cvt_pk_bf16_f32 v49, v54, v55
    ds_read_b128 v[204:207], v10 offset:49152
    v_mfma_f32_16x16x32_bf16 v[24:27], v[208:211], v[92:95], v[24:27]
    v_mul_f32 v60, v60, v56
    v_mul_f32 v56, v8, v56
    ds_read_b128 v[92:95], v12 offset:18944
    s_waitcnt lgkmcnt(11)
    v_mfma_f32_16x16x32_bf16 v[16:19], v[216:219], v[72:75], v[16:19]
    v_mul_f32 v61, v61, v57
    v_mul_f32 v57, v8, v57
    ds_read_b128 v[208:211], v10 offset:0
    buffer_load_dwordx4 v[180:183], v15, s[68:71], s35 offen offset:1024
    v_mfma_f32_16x16x32_bf16 v[20:23], v[220:223], v[72:75], v[20:23]
    v_mul_f32 v62, v62, v58
    v_mul_f32 v58, v8, v58
    ds_read_b128 v[72:75], v12 offset:20480
    s_waitcnt lgkmcnt(10)
    v_mfma_f32_16x16x32_bf16 v[28:31], v[220:223], v[76:79], v[28:31]
    v_mul_f32 v63, v63, v59
    v_mul_f32 v59, v8, v59
    ds_read_b128 v[212:215], v10 offset:8192
    v_mfma_f32_16x16x32_bf16 v[24:27], v[216:219], v[76:79], v[24:27]
    v_exp_f32 v56, v56
    ds_read_b128 v[76:79], v12 offset:20992
    s_waitcnt lgkmcnt(10)
    v_mfma_f32_16x16x32_bf16 v[16:19], v[224:227], v[80:83], v[16:19]
    v_exp_f32 v57, v57
    ds_read_b128 v[216:219], v10 offset:57344
    v_mfma_f32_16x16x32_bf16 v[20:23], v[228:231], v[80:83], v[20:23]
    v_exp_f32 v58, v58
    ds_read_b128 v[80:83], v12 offset:22528
    buffer_load_dwordx4 v[32:35], v15, s[68:71], s29 offen offset:1024 sc1
    s_waitcnt lgkmcnt(10)
J7E:
    v_mfma_f32_16x16x32_bf16 v[28:31], v[228:231], v[84:87], v[28:31]
    v_exp_f32 v59, v59
    ds_read_b128 v[220:223], v11 offset:49152
    v_mfma_f32_16x16x32_bf16 v[24:27], v[224:227], v[84:87], v[24:27]
    v_fma_f32 v56, v56, v9, v9
    v_fma_f32 v57, v57, v9, v9
    ds_read_b128 v[84:87], v12 offset:23040
    s_waitcnt lgkmcnt(10)
    v_mfma_f32_16x16x32_bf16 v[16:19], v[232:235], v[88:91], v[16:19]
    v_fma_f32 v58, v58, v9, v9
    v_fma_f32 v59, v59, v9, v9
    ds_read_b64 v[8:9], v5 offset:4480
    ds_read_b128 v[224:227], v11 offset:57344
    v_mfma_f32_16x16x32_bf16 v[20:23], v[236:239], v[88:91], v[20:23]
    v_rcp_f32 v56, v56
    s_waitcnt lgkmcnt(10)
    v_mfma_f32_16x16x32_bf16 v[28:31], v[236:239], v[92:95], v[28:31]
    v_rcp_f32 v57, v57
    ds_read_b128 v[228:231], v11 offset:0
    v_mfma_f32_16x16x32_bf16 v[24:27], v[232:235], v[92:95], v[24:27]
    v_rcp_f32 v58, v58
    buffer_load_dwordx4 v[92:95], v15, s[68:71], s29 offen offset:2048 sc1
    s_waitcnt lgkmcnt(9)
    v_mfma_f32_16x16x32_bf16 v[16:19], v[240:243], v[72:75], v[16:19]
    v_rcp_f32 v59, v59
    ds_read_b128 v[232:235], v11 offset:8192
    v_mfma_f32_16x16x32_bf16 v[20:23], v[244:247], v[72:75], v[20:23]
    v_mul_f32 v60, v60, v56
    v_mul_f32 v61, v61, v57
    s_waitcnt lgkmcnt(8)
    s_setprio 1
    v_mfma_f32_16x16x32_bf16 v[28:31], v[244:247], v[76:79], v[28:31]
    v_mul_f32 v62, v62, v58
    v_mul_f32 v63, v63, v59
    v_mfma_f32_16x16x32_bf16 v[24:27], v[240:243], v[76:79], v[24:27]
    v_cvt_pk_bf16_f32 v50, v60, v61
    v_cvt_pk_bf16_f32 v51, v62, v63
    s_waitcnt lgkmcnt(6)
    v_mfma_f32_16x16x32_bf16 v[16:19], v[248:251], v[80:83], v[16:19]
    v_permlane16_swap_b32 v48, v50
    v_permlane16_swap_b32 v49, v51
    s_cmp_eq_u32 s7, 0
    s_cbranch_scc1 XS_27
    buffer_store_dwordx4 v[48:51], v4, s[68:71], s24 offen
XB_28:
    s_add_u32 s24, s24, 385024
    buffer_load_dword v1, v14, s[68:71], s28 offen offset:1536 sc1
    v_mfma_f32_16x16x32_bf16 v[20:23], v[252:255], v[80:83], v[20:23]
    s_waitcnt lgkmcnt(4)
    v_mfma_f32_16x16x32_bf16 v[28:31], v[252:255], v[84:87], v[28:31]
    v_mfma_f32_16x16x32_bf16 v[24:27], v[248:251], v[84:87], v[24:27]
    v_mfma_f32_16x16x32_bf16 v[236:239], v[96:99], v[64:67], 0
    v_mfma_f32_16x16x32_bf16 v[240:243], v[100:103], v[64:67], 0
    v_mfma_f32_16x16x32_bf16 v[244:247], v[104:107], v[64:67], 0
    s_nop 1
    v_mul_f32 v20, v20, v16
    v_mul_f32 v16, v6, v16
    v_mfma_f32_16x16x32_bf16 v[248:251], v[108:111], v[64:67], 0
    v_mul_f32 v21, v21, v17
    v_mul_f32 v17, v6, v17
    v_mfma_f32_16x16x32_bf16 v[252:255], v[112:115], v[64:67], 0
    v_mul_f32 v22, v22, v18
    v_mul_f32 v18, v6, v18
    v_mfma_f32_16x16x32_bf16 v[236:239], v[116:119], v[68:71], v[236:239]
    v_mul_f32 v23, v23, v19
    v_mul_f32 v19, v6, v19
    v_mfma_f32_16x16x32_bf16 v[240:243], v[120:123], v[68:71], v[240:243]
    v_exp_f32 v16, v16
    s_waitcnt vmcnt(0)
    v_cmp_ne_u32 vcc, s4, v1
    s_cbranch_vccnz GFP1
GFB1:
    buffer_load_dwordx4 v[72:75], v15, s[68:71], s27 offen offset:0 sc1
    v_mfma_f32_16x16x32_bf16 v[244:247], v[124:127], v[68:71], v[244:247]
    v_exp_f32 v17, v17
    buffer_load_dwordx4 v[76:79], v15, s[68:71], s27 offen offset:1024 sc1
    v_mfma_f32_16x16x32_bf16 v[248:251], v[128:131], v[68:71], v[248:251]
    v_exp_f32 v18, v18
    v_mfma_f32_16x16x32_bf16 v[252:255], v[132:135], v[68:71], v[252:255]
    v_exp_f32 v19, v19
    s_mov_b64 exec, 1
    s_cmp_eq_u32 s7, 0
    s_cbranch_scc1 XS_29
    buffer_store_dword v13, v15, s[68:71], s25 offen offset:2048
XB_30:
    s_mov_b64 exec, -1
    buffer_load_dwordx4 v[80:83], v15, s[68:71], s27 offen offset:2048 sc1
    v_mfma_f32_16x16x32_bf16 v[236:239], v[136:139], v[36:39], v[236:239]
    v_fma_f32 v16, v16, v7, v7
    v_fma_f32 v17, v17, v7, v7
    v_mfma_f32_16x16x32_bf16 v[240:243], v[140:143], v[36:39], v[240:243]
    v_fma_f32 v18, v18, v7, v7
    v_fma_f32 v19, v19, v7, v7
    buffer_load_dwordx4 v[84:87], v15, s[68:71], s27 offen offset:3072 sc1
    v_mfma_f32_16x16x32_bf16 v[244:247], v[144:147], v[36:39], v[244:247]
    v_rcp_f32 v16, v16
    v_mfma_f32_16x16x32_bf16 v[248:251], v[148:151], v[36:39], v[248:251]
    v_rcp_f32 v17, v17
    v_mfma_f32_16x16x32_bf16 v[252:255], v[152:155], v[36:39], v[252:255]
    v_rcp_f32 v18, v18
    v_mfma_f32_16x16x32_bf16 v[236:239], v[156:159], v[40:43], v[236:239]
    v_rcp_f32 v19, v19
    v_mfma_f32_16x16x32_bf16 v[240:243], v[160:163], v[40:43], v[240:243]
    v_mul_f32 v20, v20, v16
    v_mul_f32 v21, v21, v17
    s_add_u32 s29, s27, 4096
    s_and_b32 s10, s3, 4
    s_mul_i32 s10, s10, 55296
    s_sub_u32 s27, s27, s10
    s_sub_u32 s27, s27, 274432
    buffer_load_dwordx4 v[64:67], v15, s[68:71], s29 offen offset:0 sc1
    s_or_b32 s29, s29, s31
    v_mfma_f32_16x16x32_bf16 v[244:247], v[164:167], v[40:43], v[244:247]
    v_mul_f32 v22, v22, v18
    v_mul_f32 v23, v23, v19
    v_mfma_f32_16x16x32_bf16 v[248:251], v[168:171], v[40:43], v[248:251]
    v_cvt_pk_bf16_f32 v16, v20, v21
    v_cvt_pk_bf16_f32 v17, v22, v23
    s_waitcnt lgkmcnt(3)
    v_mfma_f32_16x16x32_bf16 v[252:255], v[172:175], v[40:43], v[252:255]
    v_mul_f32 v28, v28, v24
    v_mul_f32 v24, v8, v24
    v_mfma_f32_16x16x32_bf16 v[236:239], v[176:179], v[44:47], v[236:239]
    v_mul_f32 v29, v29, v25
    v_mul_f32 v25, v8, v25
    v_mfma_f32_16x16x32_bf16 v[240:243], v[180:183], v[44:47], v[240:243]
    v_mul_f32 v30, v30, v26
    v_mul_f32 v26, v8, v26
    buffer_load_dwordx4 v[68:71], v15, s[68:71], s29 offen offset:1024 sc1
    v_mfma_f32_16x16x32_bf16 v[244:247], v[184:187], v[44:47], v[244:247]
    v_mul_f32 v31, v31, v27
    v_mul_f32 v27, v8, v27
    v_mfma_f32_16x16x32_bf16 v[248:251], v[188:191], v[44:47], v[248:251]
    v_exp_f32 v24, v24
    v_mfma_f32_16x16x32_bf16 v[252:255], v[192:195], v[44:47], v[252:255]
    v_exp_f32 v25, v25
    v_mfma_f32_16x16x32_bf16 v[236:239], v[196:199], v[32:35], v[236:239]
    v_exp_f32 v26, v26
    v_mfma_f32_16x16x32_bf16 v[240:243], v[200:203], v[32:35], v[240:243]
    v_exp_f32 v27, v27
    buffer_load_dwordx4 v[36:39], v15, s[68:71], s29 offen offset:2048 sc1
    v_mfma_f32_16x16x32_bf16 v[244:247], v[204:207], v[32:35], v[244:247]
    v_fma_f32 v24, v24, v9, v9
    v_fma_f32 v25, v25, v9, v9
    v_mfma_f32_16x16x32_bf16 v[248:251], v[208:211], v[32:35], v[248:251]
    v_fma_f32 v26, v26, v9, v9
    v_fma_f32 v27, v27, v9, v9
    v_mfma_f32_16x16x32_bf16 v[252:255], v[212:215], v[32:35], v[252:255]
    v_rcp_f32 v24, v24
    v_mfma_f32_16x16x32_bf16 v[236:239], v[216:219], v[92:95], v[236:239]
    v_rcp_f32 v25, v25
    s_setprio 0
    v_mfma_f32_16x16x32_bf16 v[240:243], v[220:223], v[92:95], v[240:243]
    v_rcp_f32 v26, v26
    s_waitcnt lgkmcnt(2)
    v_mfma_f32_16x16x32_bf16 v[244:247], v[224:227], v[92:95], v[244:247]
    v_rcp_f32 v27, v27
    s_waitcnt lgkmcnt(1)
    v_mfma_f32_16x16x32_bf16 v[248:251], v[228:231], v[92:95], v[248:251]
    v_mul_f32 v28, v28, v24
    v_mul_f32 v29, v29, v25
    s_waitcnt lgkmcnt(0)
    v_mfma_f32_16x16x32_bf16 v[252:255], v[232:235], v[92:95], v[252:255]
    v_mul_f32 v30, v30, v26
    v_mul_f32 v31, v31, v27
    s_barrier
    s_waitcnt vmcnt(7)
    s_setprio 3
    v_mfma_f32_16x16x32_bf16 v[48:51], v[96:99], v[72:75], 0
    v_cvt_pk_bf16_f32 v18, v28, v29
    v_cvt_pk_bf16_f32 v19, v30, v31
    buffer_load_dword v1, v14, s[68:71], s28 offen offset:2048 sc1
    v_mfma_f32_16x16x32_bf16 v[52:55], v[100:103], v[72:75], 0
    v_permlane16_swap_b32 v16, v18
    v_permlane16_swap_b32 v17, v19
    s_cmp_eq_u32 s7, 0
    s_cbranch_scc1 XS_31
    buffer_store_dwordx4 v[16:19], v4, s[68:71], s24 offen
XB_32:
    v_mfma_f32_16x16x32_bf16 v[56:59], v[104:107], v[72:75], 0
    v_lshrrev_b32 v12, 4, v15
    v_and_b32 v2, 15, v12
    v_mfma_f32_16x16x32_bf16 v[60:63], v[108:111], v[72:75], 0
    v_mul_u32_u24 v2, 320, v2
    v_lshlrev_b32 v5, 3, v12
    v_mfma_f32_16x16x32_bf16 v[88:91], v[112:115], v[72:75], 0
    v_xor_b32 v5, v5, v12
    v_and_b32 v5, 48, v5
    s_waitcnt vmcnt(8)
    v_mfma_f32_16x16x32_bf16 v[48:51], v[116:119], v[76:79], v[48:51]
    v_add3_u32 v2, v2, v5, s30
    v_add_u32 v3, 81920, v2
    s_cmp_lt_u32 s3, 4
    s_movk_i32 s11, 20480
    s_cselect_b32 s11, s11, 0xffffb000
    v_mfma_f32_16x16x32_bf16 v[52:55], v[120:123], v[76:79], v[52:55]
    v_add_u32 v5, s11, v2
    s_setprio 2
    v_mfma_f32_16x16x32_bf16 v[56:59], v[124:127], v[76:79], v[56:59]
    ds_write_b128 v2, v[236:239] offset:0
    v_mfma_f32_16x16x32_bf16 v[60:63], v[128:131], v[76:79], v[60:63]
    v_mfma_f32_16x16x32_bf16 v[88:91], v[132:135], v[76:79], v[88:91]
    s_waitcnt vmcnt(6)
    v_mfma_f32_16x16x32_bf16 v[48:51], v[136:139], v[80:83], v[48:51]
    s_waitcnt vmcnt(1)
    v_cmp_ne_u32 vcc, s4, v1
    s_cbranch_vccnz GFP2
GFB2:
    buffer_load_dwordx4 v[40:43], v15, s[68:71], s27 offen offset:0 sc1
    v_mfma_f32_16x16x32_bf16 v[52:55], v[140:143], v[80:83], v[52:55]
    ds_write_b128 v2, v[240:243] offset:64
    buffer_load_dwordx4 v[44:47], v15, s[68:71], s27 offen offset:1024 sc1
    v_mfma_f32_16x16x32_bf16 v[56:59], v[144:147], v[80:83], v[56:59]
    v_mfma_f32_16x16x32_bf16 v[60:63], v[148:151], v[80:83], v[60:63]
    buffer_load_dwordx4 v[32:35], v15, s[68:71], s27 offen offset:2048 sc1
    s_setprio 1
    v_mfma_f32_16x16x32_bf16 v[88:91], v[152:155], v[80:83], v[88:91]
    s_waitcnt vmcnt(3)
    s_mov_b64 exec, 1
    s_cmp_eq_u32 s7, 0
    s_cbranch_scc1 XS_33
    buffer_store_dword v13, v15, s[68:71], s25 offen offset:2560
XB_34:
    s_mov_b64 exec, -1
    v_mfma_f32_16x16x32_bf16 v[48:51], v[156:159], v[84:87], v[48:51]
    ds_write_b128 v2, v[244:247] offset:128
    buffer_load_dwordx4 v[92:95], v15, s[68:71], s27 offen offset:3072 sc1
    v_mfma_f32_16x16x32_bf16 v[52:55], v[160:163], v[84:87], v[52:55]
    v_mfma_f32_16x16x32_bf16 v[56:59], v[164:167], v[84:87], v[56:59]
    s_add_u32 s29, s27, 4096
    s_add_u32 s27, s27, 385024
    buffer_load_dwordx4 v[20:23], v15, s[68:71], s29 offen offset:0 sc1
    s_or_b32 s29, s29, s31
    v_mfma_f32_16x16x32_bf16 v[60:63], v[168:171], v[84:87], v[60:63]
    v_mfma_f32_16x16x32_bf16 v[88:91], v[172:175], v[84:87], v[88:91]
    ds_write_b128 v2, v[248:251] offset:192
    v_mfma_f32_16x16x32_bf16 v[48:51], v[176:179], v[64:67], v[48:51]
    v_mfma_f32_16x16x32_bf16 v[48:51], v[196:199], v[68:71], v[48:51]
    s_setprio 0
    v_mfma_f32_16x16x32_bf16 v[48:51], v[216:219], v[36:39], v[48:51]
    buffer_load_dwordx4 v[24:27], v15, s[68:71], s29 offen offset:1024 sc1
    v_mfma_f32_16x16x32_bf16 v[52:55], v[180:183], v[64:67], v[52:55]
    ds_write_b128 v2, v[252:255] offset:256
    v_mfma_f32_16x16x32_bf16 v[52:55], v[200:203], v[68:71], v[52:55]
    v_mfma_f32_16x16x32_bf16 v[52:55], v[220:223], v[36:39], v[52:55]
    s_nop 2
    ds_write_b128 v2, v[48:51] offset:40960
    s_waitcnt lgkmcnt(1)
    s_barrier
    s_setprio 3
    v_mfma_f32_16x16x32_bf16 v[56:59], v[184:187], v[64:67], v[56:59]
    ds_read_b128 v[236:239], v5 offset:0
    ds_read_b128 v[240:243], v5 offset:64
    ds_read_b128 v[244:247], v5 offset:128
    ds_read_b128 v[248:251], v5 offset:192
    v_mfma_f32_16x16x32_bf16 v[56:59], v[204:207], v[68:71], v[56:59]
    ds_read_b128 v[252:255], v5 offset:256
    buffer_load_dwordx4 v[28:31], v15, s[68:71], s29 offen offset:2048 sc1
    v_mfma_f32_16x16x32_bf16 v[56:59], v[224:227], v[36:39], v[56:59]
    ds_write_b128 v2, v[52:55] offset:41024
    v_mfma_f32_16x16x32_bf16 v[60:63], v[188:191], v[64:67], v[60:63]
    v_mfma_f32_16x16x32_bf16 v[60:63], v[208:211], v[68:71], v[60:63]
    v_mfma_f32_16x16x32_bf16 v[60:63], v[228:231], v[36:39], v[60:63]
    s_nop 3
    ds_write_b128 v2, v[56:59] offset:41088
    v_mfma_f32_16x16x32_bf16 v[88:91], v[192:195], v[64:67], v[88:91]
    v_mfma_f32_16x16x32_bf16 v[88:91], v[212:215], v[68:71], v[88:91]
    v_mfma_f32_16x16x32_bf16 v[88:91], v[232:235], v[36:39], v[88:91]
    ds_write_b128 v2, v[60:63] offset:41152
    s_waitcnt vmcnt(7) lgkmcnt(7)
    s_setprio 2
    v_mfma_f32_16x16x32_bf16 v[236:239], v[96:99], v[40:43], v[236:239]
    v_mul_u32_u24 v7, 13, v12
    v_lshrrev_b32 v7, 8, v7
    s_waitcnt lgkmcnt(6)
    v_mfma_f32_16x16x32_bf16 v[240:243], v[100:103], v[40:43], v[240:243]
    v_mul_u32_u24 v6, 20, v7
    v_sub_u32 v12, v12, v6
    s_waitcnt lgkmcnt(5)
    v_mfma_f32_16x16x32_bf16 v[244:247], v[104:107], v[40:43], v[244:247]
    v_lshrrev_b32 v11, 1, v12
    v_lshlrev_b32 v11, 8, v11
    ds_write_b128 v2, v[88:91] offset:41216
    s_waitcnt lgkmcnt(5)
    v_mfma_f32_16x16x32_bf16 v[248:251], v[108:111], v[40:43], v[248:251]
    v_and_b32 v6, 1, v12
    v_lshl_add_u32 v11, v6, 3, v11
    s_waitcnt lgkmcnt(4)
    v_mfma_f32_16x16x32_bf16 v[252:255], v[112:115], v[40:43], v[252:255]
    v_lshl_add_u32 v11, v7, 4, v11
    v_mul_u32_u24 v10, 1280, v7
    s_waitcnt vmcnt(6)
    v_mfma_f32_16x16x32_bf16 v[236:239], v[116:119], v[44:47], v[236:239]
    v_lshl_add_u32 v10, v12, 3, v10
    v_lshrrev_b32 v6, 1, v7
    buffer_load_dword v1, v14, s[68:71], s28 offen offset:2560 sc1
    v_mfma_f32_16x16x32_bf16 v[240:243], v[120:123], v[44:47], v[240:243]
    v_lshl_add_u32 v10, v6, 30, v10
    v_lshl_add_u32 v11, v6, 30, v11
    s_and_b32 s11, s3, 3
    v_mfma_f32_16x16x32_bf16 v[244:247], v[124:127], v[44:47], v[244:247]
    v_xor_b32 v6, s11, v12
    v_lshlrev_b32 v6, 4, v6
    v_mfma_f32_16x16x32_bf16 v[248:251], v[128:131], v[44:47], v[248:251]
    v_mul_u32_u24 v7, 320, v7
    s_mul_i32 s11, s3, 640
    s_add_u32 s11, s11, 81920
    v_add3_u32 v8, v6, v7, s11
    s_setprio 1
    v_mfma_f32_16x16x32_bf16 v[252:255], v[132:135], v[44:47], v[252:255]
    v_add_u32 v9, 40960, v8
    s_lshr_b32 s32, s6, 1
    s_lshl3_add_u32 s32, s32, s17
    s_lshl3_add_u32 s32, s32, s3
    s_mul_i32 s32, s32, 2560
    s_mul_i32 s11, s5, 160
    s_add_u32 s32, s32, s11
    s_mov_b32 s35, 0xffff0000
    s_waitcnt vmcnt(6)
    v_mfma_f32_16x16x32_bf16 v[236:239], v[136:139], v[32:35], v[236:239]
    v_mfma_f32_16x16x32_bf16 v[240:243], v[140:143], v[32:35], v[240:243]
    v_mfma_f32_16x16x32_bf16 v[244:247], v[144:147], v[32:35], v[244:247]
    v_mfma_f32_16x16x32_bf16 v[248:251], v[148:151], v[32:35], v[248:251]
    v_mfma_f32_16x16x32_bf16 v[252:255], v[152:155], v[32:35], v[252:255]
    s_waitcnt vmcnt(4)
    v_mfma_f32_16x16x32_bf16 v[236:239], v[156:159], v[92:95], v[236:239]
    s_waitcnt vmcnt(0)
    v_cmp_ne_u32 vcc, s4, v1
    s_cbranch_vccnz GFP3
GFB3:
    buffer_load_dwordx4 v[16:19], v15, s[68:71], s27 offen offset:0 sc1
    v_mfma_f32_16x16x32_bf16 v[240:243], v[160:163], v[92:95], v[240:243]
    buffer_load_dwordx4 v[72:75], v15, s[68:71], s27 offen offset:1024 sc1
    v_mfma_f32_16x16x32_bf16 v[244:247], v[164:167], v[92:95], v[244:247]
    v_mfma_f32_16x16x32_bf16 v[248:251], v[168:171], v[92:95], v[248:251]
    buffer_load_dwordx4 v[76:79], v15, s[68:71], s27 offen offset:2048 sc1
    s_setprio 0
    v_mfma_f32_16x16x32_bf16 v[252:255], v[172:175], v[92:95], v[252:255]
    v_mfma_f32_16x16x32_bf16 v[236:239], v[176:179], v[20:23], v[236:239]
    buffer_load_dwordx4 v[80:83], v15, s[68:71], s27 offen offset:3072 sc1
    v_mfma_f32_16x16x32_bf16 v[236:239], v[196:199], v[24:27], v[236:239]
    v_mfma_f32_16x16x32_bf16 v[236:239], v[216:219], v[28:31], v[236:239]
    s_waitcnt lgkmcnt(0)
    s_barrier
    s_add_u32 s29, s27, 4096
    s_add_u32 s27, s27, 385024
    buffer_load_dwordx4 v[84:87], v15, s[68:71], s29 offen offset:0 sc1
    s_or_b32 s29, s29, s31
    s_setprio 3
    v_mfma_f32_16x16x32_bf16 v[240:243], v[180:183], v[20:23], v[240:243]
    ds_read_b128 v[48:51], v5 offset:40960
    ds_read_b128 v[52:55], v5 offset:41024
    ds_read_b128 v[56:59], v5 offset:41088
    ds_read_b128 v[60:63], v5 offset:41152
    v_mfma_f32_16x16x32_bf16 v[240:243], v[200:203], v[24:27], v[240:243]
    ds_read_b128 v[88:91], v5 offset:41216
    buffer_load_dwordx4 v[64:67], v15, s[68:71], s29 offen offset:1024 sc1
    v_mfma_f32_16x16x32_bf16 v[240:243], v[220:223], v[28:31], v[240:243]
    ds_write_b128 v3, v[236:239] offset:0
    v_mfma_f32_16x16x32_bf16 v[244:247], v[184:187], v[20:23], v[244:247]
    buffer_load_dwordx4 v[68:71], v15, s[68:71], s29 offen offset:2048 sc1
    v_mfma_f32_16x16x32_bf16 v[244:247], v[204:207], v[24:27], v[244:247]
    v_mfma_f32_16x16x32_bf16 v[244:247], v[224:227], v[28:31], v[244:247]
    s_nop 2
    ds_write_b128 v3, v[240:243] offset:64
    s_setprio 2
    v_mfma_f32_16x16x32_bf16 v[248:251], v[188:191], v[20:23], v[248:251]
    s_lshl3_add_u32 s10, s17, s5
    s_mul_i32 s10, s10, 2560
    s_lshl_b32 s11, s3, 5
    s_add_u32 s10, s10, s11
    s_add_u32 s10, s10, s79
    s_add_u32 s10, s10, 258048
    buffer_load_dwordx2 v[36:37], v11, s[68:71], s10 offen sc1
    s_add_u32 s10, s10, 40960
WST32768:
    s_cbranch_execz WRETB
    buffer_load_dwordx2 v[40:41], v11, s[68:71], s10 offen sc1
    s_add_u32 s10, s10, 40960
    buffer_load_dwordx2 v[38:39], v11, s[68:71], s10 offen sc1
    s_add_u32 s10, s10, 40960
    buffer_load_dwordx2 v[42:43], v11, s[68:71], s10 offen sc1
    s_add_u32 s10, s10, 40960
    v_mfma_f32_16x16x32_bf16 v[248:251], v[208:211], v[24:27], v[248:251]
    v_mfma_f32_16x16x32_bf16 v[248:251], v[228:231], v[28:31], v[248:251]
    ds_write_b128 v3, v[244:247] offset:128
    v_mfma_f32_16x16x32_bf16 v[252:255], v[192:195], v[20:23], v[252:255]
    v_mfma_f32_16x16x32_bf16 v[252:255], v[212:215], v[24:27], v[252:255]
    v_mfma_f32_16x16x32_bf16 v[252:255], v[232:235], v[28:31], v[252:255]
    s_nop 3
    ds_write_b128 v3, v[248:251] offset:192
    s_waitcnt vmcnt(10) lgkmcnt(8)
    s_setprio 1
    v_mfma_f32_16x16x32_bf16 v[48:51], v[96:99], v[16:19], v[48:51]
    s_waitcnt lgkmcnt(7)
    v_mfma_f32_16x16x32_bf16 v[52:55], v[100:103], v[16:19], v[52:55]
    s_waitcnt lgkmcnt(6)
    v_mfma_f32_16x16x32_bf16 v[56:59], v[104:107], v[16:19], v[56:59]
    ds_write_b128 v3, v[252:255] offset:256
    s_waitcnt lgkmcnt(6)
    v_mfma_f32_16x16x32_bf16 v[60:63], v[108:111], v[16:19], v[60:63]
    s_waitcnt lgkmcnt(5)
    v_mfma_f32_16x16x32_bf16 v[88:91], v[112:115], v[16:19], v[88:91]
    s_waitcnt vmcnt(9)
    v_mfma_f32_16x16x32_bf16 v[48:51], v[116:119], v[72:75], v[48:51]
    s_setprio 0
    v_mfma_f32_16x16x32_bf16 v[52:55], v[120:123], v[72:75], v[52:55]
    v_mfma_f32_16x16x32_bf16 v[56:59], v[124:127], v[72:75], v[56:59]
    v_mfma_f32_16x16x32_bf16 v[60:63], v[128:131], v[72:75], v[60:63]
    v_mfma_f32_16x16x32_bf16 v[88:91], v[132:135], v[72:75], v[88:91]
    s_waitcnt lgkmcnt(0)
    s_barrier
    s_waitcnt vmcnt(8)
    s_setprio 3
    v_mfma_f32_16x16x32_bf16 v[48:51], v[136:139], v[76:79], v[48:51]
    ds_read_b128 v[236:239], v8 offset:0
    ds_read_b128 v[240:243], v8 offset:5120
    ds_read_b128 v[244:247], v8 offset:10240
    ds_read_b128 v[248:251], v8 offset:15360
    v_mfma_f32_16x16x32_bf16 v[52:55], v[140:143], v[76:79], v[52:55]
    ds_read_b128 v[252:255], v8 offset:20480
    ds_read_b128 v[44:47], v8 offset:25600
    ds_read_b128 v[32:35], v8 offset:30720
    ds_read_b128 v[92:95], v8 offset:35840
    s_waitcnt vmcnt(0)
    v_mfma_f32_16x16x32_bf16 v[56:59], v[144:147], v[76:79], v[56:59]
    v_lshlrev_b32 v20, 16, v38
    v_and_b32 v21, s35, v38
    v_mfma_f32_16x16x32_bf16 v[60:63], v[148:151], v[76:79], v[60:63]
    v_lshlrev_b32 v22, 16, v39
    v_and_b32 v23, s35, v39
    s_waitcnt lgkmcnt(7)
    v_mfma_f32_16x16x32_bf16 v[88:91], v[152:155], v[76:79], v[88:91]
    v_add_f32 v20, v20, v236
    v_add_f32 v21, v21, v237
    v_mfma_f32_16x16x32_bf16 v[48:51], v[156:159], v[80:83], v[48:51]
    v_add_f32 v22, v22, v238
    v_add_f32 v23, v23, v239
    s_waitcnt lgkmcnt(6)
    v_mfma_f32_16x16x32_bf16 v[52:55], v[160:163], v[80:83], v[52:55]
    v_add_f32 v20, v20, v240
    v_add_f32 v21, v21, v241
    s_setprio 2
    v_mfma_f32_16x16x32_bf16 v[56:59], v[164:167], v[80:83], v[56:59]
    v_add_f32 v22, v22, v242
    v_add_f32 v23, v23, v243
    s_waitcnt lgkmcnt(5)
    v_mfma_f32_16x16x32_bf16 v[60:63], v[168:171], v[80:83], v[60:63]
    v_add_f32 v20, v20, v244
    v_add_f32 v21, v21, v245
    v_mfma_f32_16x16x32_bf16 v[88:91], v[172:175], v[80:83], v[88:91]
    v_add_f32 v22, v22, v246
    v_add_f32 v23, v23, v247
    s_waitcnt lgkmcnt(4)
    v_mfma_f32_16x16x32_bf16 v[48:51], v[176:179], v[84:87], v[48:51]
    v_add_f32 v20, v20, v248
    v_add_f32 v21, v21, v249
    v_mfma_f32_16x16x32_bf16 v[48:51], v[196:199], v[64:67], v[48:51]
    v_add_f32 v22, v22, v250
    v_add_f32 v23, v23, v251
    v_mfma_f32_16x16x32_bf16 v[48:51], v[216:219], v[68:71], v[48:51]
    v_cvt_pk_bf16_f32 v20, v20, v21
    v_cvt_pk_bf16_f32 v21, v22, v23
    s_add_u32 s10, s32, 81920
    v_mfma_f32_16x16x32_bf16 v[52:55], v[180:183], v[84:87], v[52:55]
    buffer_store_dwordx2 v[20:21], v10, s[60:63], s10 offen
    v_lshlrev_b32 v24, 16, v36
    s_setprio 1
    v_mfma_f32_16x16x32_bf16 v[52:55], v[200:203], v[64:67], v[52:55]
    v_and_b32 v25, s35, v36
    v_lshlrev_b32 v26, 16, v37
    v_mfma_f32_16x16x32_bf16 v[52:55], v[220:223], v[68:71], v[52:55]
    v_and_b32 v27, s35, v37
    s_waitcnt lgkmcnt(3)
    v_add_f32 v24, v24, v252
    ds_write_b128 v3, v[48:51] offset:40960
    v_mfma_f32_16x16x32_bf16 v[56:59], v[184:187], v[84:87], v[56:59]
    v_add_f32 v25, v25, v253
    v_add_f32 v26, v26, v254
    v_mfma_f32_16x16x32_bf16 v[56:59], v[204:207], v[64:67], v[56:59]
    v_add_f32 v27, v27, v255
    s_waitcnt lgkmcnt(3)
    v_add_f32 v24, v24, v44
    v_mfma_f32_16x16x32_bf16 v[56:59], v[224:227], v[68:71], v[56:59]
    v_add_f32 v25, v25, v45
    v_add_f32 v26, v26, v46
    ds_write_b128 v3, v[52:55] offset:41024
    v_mfma_f32_16x16x32_bf16 v[60:63], v[188:191], v[84:87], v[60:63]
    v_add_f32 v27, v27, v47
    s_waitcnt lgkmcnt(3)
    v_add_f32 v24, v24, v32
    v_mfma_f32_16x16x32_bf16 v[60:63], v[208:211], v[64:67], v[60:63]
    v_add_f32 v25, v25, v33
    v_add_f32 v26, v26, v34
    s_setprio 0
    v_mfma_f32_16x16x32_bf16 v[60:63], v[228:231], v[68:71], v[60:63]
    v_add_f32 v27, v27, v35
    s_waitcnt lgkmcnt(2)
    v_add_f32 v24, v24, v92
    ds_write_b128 v3, v[56:59] offset:41088
    v_mfma_f32_16x16x32_bf16 v[88:91], v[192:195], v[84:87], v[88:91]
    v_add_f32 v25, v25, v93
    v_add_f32 v26, v26, v94
    v_mfma_f32_16x16x32_bf16 v[88:91], v[212:215], v[64:67], v[88:91]
    v_add_f32 v27, v27, v95
    v_cvt_pk_bf16_f32 v24, v24, v25
    v_mfma_f32_16x16x32_bf16 v[88:91], v[232:235], v[68:71], v[88:91]
    v_cvt_pk_bf16_f32 v25, v26, v27
    s_add_u32 s10, s32, 0
    buffer_store_dwordx2 v[24:25], v10, s[60:63], s10 offen
    ds_write_b128 v3, v[60:63] offset:41152
    v_lshlrev_b32 v120, 16, v42
    v_and_b32 v121, s35, v42
    v_lshlrev_b32 v122, 16, v43
    v_and_b32 v123, s35, v43
    ds_write_b128 v3, v[88:91] offset:41216
    v_lshlrev_b32 v124, 16, v40
    v_and_b32 v125, s35, v40
    v_lshlrev_b32 v126, 16, v41
    v_and_b32 v127, s35, v41
    s_waitcnt lgkmcnt(0)
    s_barrier
    ds_read_b128 v[28:31], v9 offset:0
    ds_read_b128 v[96:99], v9 offset:5120
    ds_read_b128 v[100:103], v9 offset:10240
    ds_read_b128 v[104:107], v9 offset:15360
    ds_read_b128 v[108:111], v9 offset:20480
    ds_read_b128 v[16:19], v9 offset:25600
    ds_read_b128 v[112:115], v9 offset:30720
    ds_read_b128 v[116:119], v9 offset:35840
    s_waitcnt lgkmcnt(7)
    v_pk_add_f32 v[120:121], v[120:121], v[28:29]
    v_pk_add_f32 v[122:123], v[122:123], v[30:31]
    s_waitcnt lgkmcnt(6)
    v_pk_add_f32 v[120:121], v[120:121], v[96:97]
    v_pk_add_f32 v[122:123], v[122:123], v[98:99]
    s_waitcnt lgkmcnt(5)
    v_pk_add_f32 v[120:121], v[120:121], v[100:101]
    v_pk_add_f32 v[122:123], v[122:123], v[102:103]
    s_waitcnt lgkmcnt(4)
    v_pk_add_f32 v[120:121], v[120:121], v[104:105]
    v_pk_add_f32 v[122:123], v[122:123], v[106:107]
    v_cvt_pk_bf16_f32 v120, v120, v121
    v_cvt_pk_bf16_f32 v121, v122, v123
    s_add_u32 s10, s32, 122880
    buffer_store_dwordx2 v[120:121], v10, s[60:63], s10 offen
    s_waitcnt lgkmcnt(3)
    v_pk_add_f32 v[124:125], v[124:125], v[108:109]
    v_pk_add_f32 v[126:127], v[126:127], v[110:111]
    s_waitcnt lgkmcnt(2)
    v_pk_add_f32 v[124:125], v[124:125], v[16:17]
    v_pk_add_f32 v[126:127], v[126:127], v[18:19]
    s_waitcnt lgkmcnt(1)
    v_pk_add_f32 v[124:125], v[124:125], v[112:113]
    v_pk_add_f32 v[126:127], v[126:127], v[114:115]
    s_waitcnt lgkmcnt(0)
    v_pk_add_f32 v[124:125], v[124:125], v[116:117]
    v_pk_add_f32 v[126:127], v[126:127], v[118:119]
    v_cvt_pk_bf16_f32 v124, v124, v125
    v_cvt_pk_bf16_f32 v125, v126, v127
    s_add_u32 s10, s32, 40960
    buffer_store_dwordx2 v[124:125], v10, s[60:63], s10 offen
L_FIN:
L_END:
    s_endpgm
KVC:
POLL_35:
    buffer_load_dword v28, v15, s[68:71], 0 offen sc1
    buffer_load_dword v29, v15, s[68:71], 0 offen offset:1024 sc1
    buffer_load_dword v30, v15, s[68:71], 0 offen offset:2048 sc1
    buffer_load_dword v31, v15, s[68:71], 0 offen offset:3072 sc1
    s_waitcnt vmcnt(0)
    v_xor_b32 v28, s4, v28
    v_xor_b32 v29, s4, v29
    v_xor_b32 v30, s4, v30
    v_xor_b32 v31, s4, v31
    v_or3_b32 v28, v28, v29, v30
    v_or_b32 v28, v28, v31
    v_cmp_ne_u32 vcc, 0, v28
    s_cbranch_vccz P1_END
    s_sleep 1
    s_sub_i32 s9, s9, 1
    s_cmp_gt_i32 s9, 0
    s_cbranch_scc1 POLL_35
    s_branch P1_END
W2C_5:
POLL_36:
    buffer_load_dword v4, v3, s[68:71], s13 offen sc1
    s_waitcnt vmcnt(0)
    v_cmp_ne_u32 vcc, s4, v4
    s_cbranch_vccz W2CB_6
    s_sleep 1
    s_sub_i32 s9, s9, 1
    s_cmp_gt_i32 s9, 0
    s_cbranch_scc1 POLL_36
    s_branch W2CB_6
XS_7:
    buffer_store_dwordx4 v[32:35], v15, s[68:71], s15 offen sc1
    s_mov_b32 exec_hi, 0
    buffer_store_dwordx2 v[36:37], v8, s[68:71], s15 offen offset:1024 sc1
    s_mov_b32 exec_hi, -1
    s_branch XB_8
FALLBACK:
    s_cmp_lg_u32 s74, 0
    s_cbranch_scc1 O_ST
    s_mov_b32 s74, 1
    s_waitcnt vmcnt(0)
    v_mov_b32 v69, 0
    v_subrev_u32 v8, 114688, v86
    v_subrev_u32 v10, 114688, v87
    v_mov_b32 v6, 0xff800000
    s_mov_b32 s13, 0
FB_L0:
    s_add_u32 s10, s13, 0
    s_bfe_u32 s14, s10, 0x30003
    s_and_b32 s10, s10, 7
    s_lshl_b32 s14, s14, 15
    s_mul_i32 s10, s10, 3072
    s_add_u32 s10, s10, s14
    s_add_u32 s10, s10, 524288
    buffer_load_dwordx4 v[72:75], v15, s[68:71], s10 offen sc1
    buffer_load_dword v70, v8, s[68:71], s10 offen sc1
    s_waitcnt vmcnt(0)
    v_mfma_f32_32x32x16_bf16 v[16:31], v[72:75], v[64:67], 0
    v_mfma_f32_32x32x8_bf16 v[16:31], v[70:71], v[68:69], v[16:31]
    s_nop 11
    v_max3_f32 v6, v6, v16, v17
    v_max3_f32 v6, v6, v18, v19
    v_max3_f32 v6, v6, v20, v21
    v_max3_f32 v6, v6, v22, v23
    v_max3_f32 v6, v6, v24, v25
    v_max3_f32 v6, v6, v26, v27
    v_max3_f32 v6, v6, v28, v29
    v_max3_f32 v6, v6, v30, v31
    s_add_u32 s13, s13, 1
    s_cmp_lt_u32 s13, 64
    s_cbranch_scc1 FB_L0
    v_mov_b32 v7, v6
    s_nop 1
    v_permlane32_swap_b32 v6, v7
    v_max_f32 v6, v6, v7
    v_cvt_pk_bf16_f32 v7, -v6, -v6
    v_lshlrev_b32 v7, 16, v7
    v_sub_f32 v4, -v6, v7
    v_cvt_pk_bf16_f32 v69, -v6, v4
    v_and_b32 v4, 0xffff0000, v69
    v_add_f32 v4, v4, v7
    v_mov_b32 v48, 0
    v_mov_b32 v49, 0
    v_mov_b32 v50, 0
    v_mov_b32 v51, 0
    v_mov_b32 v52, 0
    v_mov_b32 v53, 0
    v_mov_b32 v54, 0
    v_mov_b32 v55, 0
    v_mov_b32 v56, 0
    v_mov_b32 v57, 0
    v_mov_b32 v58, 0
    v_mov_b32 v59, 0
    v_mov_b32 v60, 0
    v_mov_b32 v61, 0
    v_mov_b32 v62, 0
    v_mov_b32 v63, 0
    s_mov_b32 s13, 0
FB_L1:
    s_add_u32 s10, s13, 0
    s_bfe_u32 s14, s10, 0x30003
    s_and_b32 s10, s10, 7
    s_lshl_b32 s14, s14, 15
    s_mul_i32 s10, s10, 3072
    s_add_u32 s10, s10, s14
    s_add_u32 s10, s10, 524288
    buffer_load_dwordx4 v[72:75], v15, s[68:71], s10 offen sc1
    buffer_load_dword v70, v8, s[68:71], s10 offen sc1
    s_add_u32 s11, s13, 1
    s_bfe_u32 s14, s11, 0x30003
    s_and_b32 s11, s11, 7
    s_lshl_b32 s14, s14, 15
    s_mul_i32 s11, s11, 3072
    s_add_u32 s11, s11, s14
    s_add_u32 s11, s11, 524288
    s_add_u32 s12, s13, 2
    s_bfe_u32 s14, s12, 0x30003
    s_and_b32 s12, s12, 7
    s_lshl_b32 s14, s14, 15
    s_mul_i32 s12, s12, 3072
    s_add_u32 s12, s12, s14
    s_add_u32 s12, s12, 524288
    buffer_load_dwordx4 v[76:79], v10, s[68:71], s11 offen sc1
    buffer_load_dwordx4 v[80:83], v10, s[68:71], s12 offen offset:768 sc1
    s_waitcnt vmcnt(0)
    v_mfma_f32_32x32x16_bf16 v[16:31], v[72:75], v[64:67], 0
    v_mfma_f32_32x32x8_bf16 v[16:31], v[70:71], v[68:69], v[16:31]
    s_nop 11
    v_exp_f32 v16, v16
    v_exp_f32 v17, v17
    v_exp_f32 v18, v18
    v_exp_f32 v19, v19
    v_exp_f32 v20, v20
    v_exp_f32 v21, v21
    v_exp_f32 v22, v22
    v_exp_f32 v23, v23
    v_exp_f32 v24, v24
    v_exp_f32 v25, v25
    v_exp_f32 v26, v26
    v_exp_f32 v27, v27
    v_exp_f32 v28, v28
    v_exp_f32 v29, v29
    v_exp_f32 v30, v30
    v_exp_f32 v31, v31
    v_smfmac_f32_32x32x32_bf16 v[48:63], v[76:79], v[16:23], v84
    s_nop 0
    v_smfmac_f32_32x32x32_bf16 v[48:63], v[80:83], v[24:31], v84
    s_nop 7
    s_add_u32 s13, s13, 1
    s_cmp_lt_u32 s13, 64
    s_cbranch_scc1 FB_L1
    v_lshlrev_b32 v8, 3, v1
    s_branch O_EPI
XS_9:
    buffer_store_dword v38, v15, s[68:71], s16 offen offset:0 sc1
    s_branch XB_10
XS_13:
    buffer_store_dwordx4 v[88:91], v0, s[68:71], s23 offen sc1
    s_mov_b64 exec, s[14:15]
    buffer_store_dwordx2 v[92:93], v14, s[68:71], s20 offen offset:1024 sc1
    s_branch XB_14
XS_15:
    buffer_store_dwordx4 v[8:11], v15, s[68:71], s21 offen sc1
    s_branch XB_16
HP2:
POLL_37:
    buffer_load_dwordx4 v[48:51], v15, s[68:71], s22 offen sc1
    buffer_load_dwordx4 v[52:55], v15, s[68:71], s22 offen offset:1024 sc1
    s_waitcnt vmcnt(0)
    v_min3_u32 v51, v50, v54, s4
    v_max3_u32 v55, v50, v54, s4
    v_cmp_ne_u32 vcc, v51, v55
    s_cbranch_vccz HB2
    s_sleep 1
    s_sub_i32 s9, s9, 1
    s_cmp_gt_i32 s9, 0
    s_cbranch_scc1 POLL_37
    s_branch HB2
XS_19:
    buffer_store_dwordx4 v[16:19], v4, s[68:71], s24 offen sc1
    s_branch XB_20
XS_21:
    buffer_store_dword v13, v15, s[68:71], s25 offen offset:1024 sc1
    s_branch XB_22
GFP0:
POLL_38:
    buffer_load_dword v1, v14, s[68:71], s28 offen offset:1024 sc1
    s_waitcnt vmcnt(0)
    v_cmp_ne_u32 vcc, s4, v1
    s_cbranch_vccz GFB0
    s_sleep 1
    s_sub_i32 s9, s9, 1
    s_cmp_gt_i32 s9, 0
    s_cbranch_scc1 POLL_38
    s_branch GFB0
XS_23:
    buffer_store_dwordx4 v[32:35], v4, s[68:71], s24 offen sc1
    s_branch XB_24
XS_25:
    buffer_store_dword v13, v15, s[68:71], s25 offen offset:1536 sc1
    s_branch XB_26
J7:
    s_barrier
    s_lshl3_add_u32 s10, s17, s3
    s_mul_i32 s10, s10, 13824
    s_add_u32 s10, s10, s79
    s_add_u32 s10, s10, 421888
    v_lshlrev_b32 v16, 4, v15
    s_mov_b32 exec_hi, 0x3fffff
    buffer_load_dwordx2 v[16:17], v16, s[68:71], s10 offen offset:124 sc1
    s_mov_b32 exec_hi, -1
    s_add_u32 s35, s26, 0
    buffer_load_dwordx4 v[96:99], v15, s[68:71], s35 offen offset:0
    buffer_load_dwordx4 v[100:103], v15, s[68:71], s35 offen offset:1024
    buffer_load_dwordx4 v[104:107], v15, s[68:71], s35 offen offset:2048
    buffer_load_dwordx4 v[108:111], v15, s[68:71], s35 offen offset:3072
    s_add_u32 s35, s26, 4096
    buffer_load_dwordx4 v[112:115], v15, s[68:71], s35 offen offset:0
    s_add_u32 s35, s26, 40960
    buffer_load_dwordx4 v[116:119], v15, s[68:71], s35 offen offset:0
    buffer_load_dwordx4 v[120:123], v15, s[68:71], s35 offen offset:1024
    buffer_load_dwordx4 v[124:127], v15, s[68:71], s35 offen offset:2048
    buffer_load_dwordx4 v[128:131], v15, s[68:71], s35 offen offset:3072
    s_add_u32 s35, s26, 45056
    buffer_load_dwordx4 v[132:135], v15, s[68:71], s35 offen offset:0
    s_add_u32 s35, s26, 81920
    buffer_load_dwordx4 v[136:139], v15, s[68:71], s35 offen offset:0
    buffer_load_dwordx4 v[140:143], v15, s[68:71], s35 offen offset:1024
    buffer_load_dwordx4 v[144:147], v15, s[68:71], s35 offen offset:2048
    buffer_load_dwordx4 v[148:151], v15, s[68:71], s35 offen offset:3072
    s_add_u32 s35, s26, 86016
    buffer_load_dwordx4 v[152:155], v15, s[68:71], s35 offen offset:0
    s_add_u32 s35, s26, 122880
    buffer_load_dwordx4 v[156:159], v15, s[68:71], s35 offen offset:0
    buffer_load_dwordx4 v[160:163], v15, s[68:71], s35 offen offset:1024
    buffer_load_dwordx4 v[164:167], v15, s[68:71], s35 offen offset:2048
    buffer_load_dwordx4 v[168:171], v15, s[68:71], s35 offen offset:3072
    s_add_u32 s35, s26, 126976
    buffer_load_dwordx4 v[172:175], v15, s[68:71], s35 offen offset:0
    s_add_u32 s35, s26, 163840
    buffer_load_dwordx4 v[176:179], v15, s[68:71], s35 offen offset:0
    buffer_load_dwordx4 v[180:183], v15, s[68:71], s35 offen offset:1024
    buffer_load_dwordx4 v[184:187], v15, s[68:71], s35 offen offset:2048
    buffer_load_dwordx4 v[188:191], v15, s[68:71], s35 offen offset:3072
    s_add_u32 s35, s26, 167936
    buffer_load_dwordx4 v[192:195], v15, s[68:71], s35 offen offset:0
    s_add_u32 s35, s34, 204800
    buffer_load_dwordx4 v[196:199], v15, s[68:71], s35 offen offset:0
    buffer_load_dwordx4 v[200:203], v15, s[68:71], s35 offen offset:1024
    buffer_load_dwordx4 v[204:207], v15, s[68:71], s35 offen offset:2048
    buffer_load_dwordx4 v[208:211], v15, s[68:71], s35 offen offset:3072
    s_add_u32 s35, s34, 208896
    buffer_load_dwordx4 v[212:215], v15, s[68:71], s35 offen offset:0
    s_add_u32 s35, s34, 245760
    buffer_load_dwordx4 v[216:219], v15, s[68:71], s35 offen offset:0
    s_add_u32 s32, s34, 246784
    s_add_u32 m0, s33, 114688
    s_nop 0
    buffer_load_dwordx4 v15, s[68:71], s32 offen offset:0 lds
    s_add_u32 m0, s33, 121856
    s_nop 0
    buffer_load_dwordx4 v15, s[68:71], s32 offen offset:1024 lds
    s_add_u32 m0, s33, 63488
    s_nop 0
    buffer_load_dwordx4 v15, s[68:71], s32 offen offset:2048 lds
    s_add_u32 m0, s33, 70656
    s_nop 0
    buffer_load_dwordx4 v15, s[68:71], s32 offen offset:3072 lds
    v_add_u32 v10, s33, v15
    v_add_u32 v11, 0x10000, v10
POLL_39:
    buffer_load_dword v1, v14, s[68:71], s28 offen offset:1024 sc1
    s_waitcnt vmcnt(0)
    v_cmp_ne_u32 vcc, s4, v1
    s_cbranch_vccz POLLD_40
    s_sleep 8
    s_sub_i32 s9, s9, 1
    s_cmp_gt_i32 s9, 0
    s_cbranch_scc1 POLL_39
POLLD_40:
    buffer_load_dwordx4 v[64:67], v15, s[68:71], s27 offen offset:0 sc1
    buffer_load_dwordx4 v[68:71], v15, s[68:71], s27 offen offset:1024 sc1
    buffer_load_dwordx4 v[36:39], v15, s[68:71], s27 offen offset:2048 sc1
    buffer_load_dwordx4 v[40:43], v15, s[68:71], s27 offen offset:3072 sc1
    s_add_u32 s29, s27, 4096
    s_add_u32 s27, s27, 385024
    buffer_load_dwordx4 v[44:47], v15, s[68:71], s29 offen offset:0 sc1
    s_or_b32 s29, s29, s31
    buffer_load_dwordx4 v[32:35], v15, s[68:71], s29 offen offset:1024 sc1
    s_waitcnt vmcnt(0)
    s_branch J7E
XS_27:
    buffer_store_dwordx4 v[48:51], v4, s[68:71], s24 offen sc1
    s_branch XB_28
GFP1:
POLL_41:
    buffer_load_dword v1, v14, s[68:71], s28 offen offset:1536 sc1
    s_waitcnt vmcnt(0)
    v_cmp_ne_u32 vcc, s4, v1
    s_cbranch_vccz GFB1
    s_sleep 1
    s_sub_i32 s9, s9, 1
    s_cmp_gt_i32 s9, 0
    s_cbranch_scc1 POLL_41
    s_branch GFB1
XS_29:
    buffer_store_dword v13, v15, s[68:71], s25 offen offset:2048 sc1
    s_branch XB_30
XS_31:
    buffer_store_dwordx4 v[16:19], v4, s[68:71], s24 offen sc1
    s_branch XB_32
GFP2:
POLL_42:
    buffer_load_dword v1, v14, s[68:71], s28 offen offset:2048 sc1
    s_waitcnt vmcnt(0)
    v_cmp_ne_u32 vcc, s4, v1
    s_cbranch_vccz GFB2
    s_sleep 1
    s_sub_i32 s9, s9, 1
    s_cmp_gt_i32 s9, 0
    s_cbranch_scc1 POLL_42
    s_branch GFB2
XS_33:
    buffer_store_dword v13, v15, s[68:71], s25 offen offset:2560 sc1
    s_branch XB_34
GFP3:
POLL_43:
    buffer_load_dword v1, v14, s[68:71], s28 offen offset:2560 sc1
    s_waitcnt vmcnt(0)
    v_cmp_ne_u32 vcc, s4, v1
    s_cbranch_vccz GFB3
    s_sleep 1
    s_sub_i32 s9, s9, 1
    s_cmp_gt_i32 s9, 0
    s_cbranch_scc1 POLL_43
    s_branch GFB3
P2J:
WST35629:
WARMB1:
    s_cbranch_execz WST36864
    s_barrier
    s_setprio 3
    v_smfmac_f32_32x32x32_bf16 v[48:63], v[80:83], v[40:47], v84
    ds_read_b128 v[80:83], v87 offset:25344
    v_exp_f32 v16, v16
    v_exp_f32 v17, v17
    v_exp_f32 v18, v18
    v_exp_f32 v19, v19
    v_mfma_f32_32x32x16_bf16 v[32:47], v[72:75], v[64:67], 0
    ds_read_b128 v[72:75], v85 offset:24576
    s_add_u32 s72, s72, 32768
    s_bitset0_b32 s72, 18
    s_add_u32 m0, s73, 114688
    s_nop 0
    buffer_load_dwordx4 v15, s[68:71], s72 offen offset:0 sc1 lds
    v_exp_f32 v20, v20
    v_exp_f32 v21, v21
    v_exp_f32 v22, v22
    v_exp_f32 v23, v23
    v_mfma_f32_32x32x8_bf16 v[32:47], v[70:71], v[68:69], v[32:47]
    ds_read_b32 v70, v86 offset:24576
    v_exp_f32 v24, v24
    v_exp_f32 v25, v25
    v_exp_f32 v26, v26
    v_exp_f32 v27, v27
    v_smfmac_f32_32x32x32_bf16 v[48:63], v[76:79], v[16:23], v84
    ds_read_b64_tr_b16 v[112:113], v13 offset:0
    ds_read_b64_tr_b16 v[114:115], v13 offset:1024
    ds_read_b128 v[76:79], v87 offset:24576
    buffer_load_dwordx4 v15, s[68:71], s72 offen offset:1024 sc1 lds
    v_exp_f32 v28, v28
    v_exp_f32 v29, v29
    v_exp_f32 v30, v30
    v_exp_f32 v31, v31
    s_setprio 2
    s_waitcnt lgkmcnt(3)
    v_smfmac_f32_32x32x32_bf16 v[48:63], v[80:83], v[24:31], v84
    ds_read_b128 v[80:83], v87 offset:28416
    v_exp_f32 v32, v32
    v_exp_f32 v33, v33
    v_exp_f32 v34, v34
    v_exp_f32 v35, v35
    s_waitcnt lgkmcnt(3)
    v_mfma_f32_32x32x16_bf16 v[16:31], v[72:75], v[64:67], 0
    ds_read_b128 v[72:75], v85 offset:27648
    buffer_load_dwordx4 v15, s[68:71], s72 offen offset:2048 sc1 lds
    v_exp_f32 v36, v36
    v_exp_f32 v37, v37
    v_exp_f32 v38, v38
    v_exp_f32 v39, v39
    s_waitcnt lgkmcnt(3)
    v_mfma_f32_32x32x8_bf16 v[16:31], v[70:71], v[68:69], v[16:31]
    ds_read_b32 v70, v86 offset:27648
    v_exp_f32 v40, v40
    v_exp_f32 v41, v41
    v_exp_f32 v42, v42
    v_exp_f32 v43, v43
    s_waitcnt lgkmcnt(3)
    v_smfmac_f32_32x32x32_bf16 v[48:63], v[76:79], v[32:39], v84
    ds_read_b64_tr_b16 v[116:117], v13 offset:16384
    ds_read_b64_tr_b16 v[118:119], v13 offset:17408
    ds_read_b128 v[76:79], v87 offset:27648
    s_mul_i32 s15, s6, 81920
    s_lshr_b32 s11, s17, 1
    s_add_u32 s15, s15, s11
    s_add_u32 s15, s15, 18874368
    s_cmp_ge_u32 s6, 27
    s_cselect_b32 s15, 0x40000000, s15
    s_and_b32 s75, s6, 1
    s_lshl3_add_u32 s75, s75, s3
    s_mul_i32 s75, s75, 2560
    s_add_u32 s75, s75, s79
    v_exp_f32 v44, v44
    v_exp_f32 v45, v45
    v_exp_f32 v46, v46
    v_exp_f32 v47, v47
    s_setprio 1
    s_waitcnt lgkmcnt(3)
    v_smfmac_f32_32x32x32_bf16 v[48:63], v[80:83], v[40:47], v84
    ds_read_b128 v[80:83], v87 offset:31488
    v_exp_f32 v16, v16
    v_exp_f32 v17, v17
    v_exp_f32 v18, v18
    v_exp_f32 v19, v19
    s_waitcnt lgkmcnt(3)
    v_mfma_f32_32x32x16_bf16 v[32:47], v[72:75], v[64:67], 0
    ds_read_b128 v[72:75], v85 offset:30720
    buffer_store_dwordx4 v[96:99], v15, s[68:71], s15 offen sc1
    s_add_u32 s15, s15, 40960
    v_exp_f32 v20, v20
    v_exp_f32 v21, v21
    v_exp_f32 v22, v22
    v_exp_f32 v23, v23
    s_waitcnt lgkmcnt(3)
    v_mfma_f32_32x32x8_bf16 v[32:47], v[70:71], v[68:69], v[32:47]
    ds_read_b32 v70, v86 offset:30720
    v_exp_f32 v24, v24
    v_exp_f32 v25, v25
    v_exp_f32 v26, v26
    v_exp_f32 v27, v27
    s_waitcnt lgkmcnt(3)
    v_smfmac_f32_32x32x32_bf16 v[48:63], v[76:79], v[16:23], v84
    ds_read_b64_tr_b16 v[120:121], v13 offset:8192
    ds_read_b64_tr_b16 v[122:123], v13 offset:9216
    ds_read_b128 v[76:79], v87 offset:30720
    buffer_store_dwordx4 v[104:107], v15, s[68:71], s15 offen sc1
    s_sub_u32 s15, s15, 32768
    v_exp_f32 v28, v28
    v_exp_f32 v29, v29
    v_exp_f32 v30, v30
    v_exp_f32 v31, v31
    s_setprio 0
    s_waitcnt lgkmcnt(3)
    v_smfmac_f32_32x32x32_bf16 v[48:63], v[80:83], v[24:31], v84
    ds_read_b128 v[80:83], v87 offset:34560
    v_exp_f32 v32, v32
    v_exp_f32 v33, v33
    v_exp_f32 v34, v34
    v_exp_f32 v35, v35
    s_waitcnt lgkmcnt(3)
    v_mfma_f32_32x32x16_bf16 v[16:31], v[72:75], v[64:67], 0
    ds_read_b128 v[72:75], v85 offset:33792
    buffer_store_dwordx4 v[100:103], v15, s[68:71], s15 offen sc1
    s_add_u32 s15, s15, 40960
    v_exp_f32 v36, v36
    v_exp_f32 v37, v37
    v_exp_f32 v38, v38
    v_exp_f32 v39, v39
    s_waitcnt lgkmcnt(3)
    v_mfma_f32_32x32x8_bf16 v[16:31], v[70:71], v[68:69], v[16:31]
    ds_read_b32 v70, v86 offset:33792
    v_exp_f32 v40, v40
    v_exp_f32 v41, v41
    v_exp_f32 v42, v42
    v_exp_f32 v43, v43
    s_waitcnt lgkmcnt(3)
    v_smfmac_f32_32x32x32_bf16 v[48:63], v[76:79], v[32:39], v84
    ds_read_b64_tr_b16 v[124:125], v13 offset:24576
    ds_read_b64_tr_b16 v[126:127], v13 offset:25600
    ds_read_b128 v[76:79], v87 offset:33792
    buffer_store_dwordx4 v[108:111], v15, s[68:71], s15 offen sc1
    s_sub_u32 s15, s15, 32768
    v_exp_f32 v44, v44
    v_exp_f32 v45, v45
    v_exp_f32 v46, v46
    v_exp_f32 v47, v47
    s_waitcnt vmcnt(7) lgkmcnt(0)
    s_barrier
    s_setprio 3
    v_smfmac_f32_32x32x32_bf16 v[48:63], v[80:83], v[40:47], v84
    ds_read_b128 v[80:83], v87 offset:37632
    v_exp_f32 v16, v16
    v_exp_f32 v17, v17
    v_exp_f32 v18, v18
    v_exp_f32 v19, v19
    v_mfma_f32_32x32x16_bf16 v[32:47], v[72:75], v[64:67], 0
    ds_read_b128 v[72:75], v85 offset:36864
    buffer_store_dwordx4 v[112:115], v15, s[68:71], s15 offen sc1
    s_add_u32 s15, s15, 40960
    v_exp_f32 v20, v20
    v_exp_f32 v21, v21
    v_exp_f32 v22, v22
    v_exp_f32 v23, v23
    v_mfma_f32_32x32x8_bf16 v[32:47], v[70:71], v[68:69], v[32:47]
    ds_read_b32 v70, v86 offset:36864
    v_exp_f32 v24, v24
    v_exp_f32 v25, v25
    v_exp_f32 v26, v26
    v_exp_f32 v27, v27
    v_smfmac_f32_32x32x32_bf16 v[48:63], v[76:79], v[16:23], v84
    ds_read_b64_tr_b16 v[128:129], v13 offset:32768
    ds_read_b64_tr_b16 v[130:131], v13 offset:33792
    ds_read_b128 v[76:79], v87 offset:36864
    buffer_store_dwordx4 v[120:123], v15, s[68:71], s15 offen sc1
    s_sub_u32 s15, s15, 32768
    v_exp_f32 v28, v28
    v_exp_f32 v29, v29
    v_exp_f32 v30, v30
    v_exp_f32 v31, v31
    s_setprio 2
    s_waitcnt lgkmcnt(3)
    v_smfmac_f32_32x32x32_bf16 v[48:63], v[80:83], v[24:31], v84
    ds_read_b128 v[80:83], v87 offset:40704
    v_exp_f32 v32, v32
    v_exp_f32 v33, v33
    v_exp_f32 v34, v34
    v_exp_f32 v35, v35
    s_waitcnt lgkmcnt(3)
    v_mfma_f32_32x32x16_bf16 v[16:31], v[72:75], v[64:67], 0
    ds_read_b128 v[72:75], v85 offset:39936
    buffer_store_dwordx4 v[116:119], v15, s[68:71], s15 offen sc1
    s_add_u32 s15, s15, 40960
    v_exp_f32 v36, v36
    v_exp_f32 v37, v37
    v_exp_f32 v38, v38
    v_exp_f32 v39, v39
    s_waitcnt lgkmcnt(3)
    v_mfma_f32_32x32x8_bf16 v[16:31], v[70:71], v[68:69], v[16:31]
    ds_read_b32 v70, v86 offset:39936
    v_exp_f32 v40, v40
    v_exp_f32 v41, v41
    v_exp_f32 v42, v42
    v_exp_f32 v43, v43
    s_waitcnt lgkmcnt(3)
    v_smfmac_f32_32x32x32_bf16 v[48:63], v[76:79], v[32:39], v84
    ds_read_b64_tr_b16 v[132:133], v13 offset:49152
    ds_read_b64_tr_b16 v[134:135], v13 offset:50176
    ds_read_b128 v[76:79], v87 offset:39936
    v_exp_f32 v44, v44
    v_exp_f32 v45, v45
    v_exp_f32 v46, v46
    v_exp_f32 v47, v47
    s_setprio 1
    s_waitcnt lgkmcnt(3)
WST36864:
    s_cbranch_execz WST40960
    v_smfmac_f32_32x32x32_bf16 v[48:63], v[80:83], v[40:47], v84
    ds_read_b128 v[80:83], v87 offset:43776
    v_exp_f32 v16, v16
    v_exp_f32 v17, v17
    v_exp_f32 v18, v18
    v_exp_f32 v19, v19
    s_waitcnt lgkmcnt(3)
    v_mfma_f32_32x32x16_bf16 v[32:47], v[72:75], v[64:67], 0
    ds_read_b128 v[72:75], v85 offset:43008
    buffer_store_dwordx4 v[124:127], v15, s[68:71], s15 offen sc1
    s_sub_u32 s15, s15, 32768
    v_exp_f32 v20, v20
    v_exp_f32 v21, v21
    v_exp_f32 v22, v22
    v_exp_f32 v23, v23
    s_waitcnt lgkmcnt(3)
    v_mfma_f32_32x32x8_bf16 v[32:47], v[70:71], v[68:69], v[32:47]
    ds_read_b32 v70, v86 offset:43008
    v_exp_f32 v24, v24
    v_exp_f32 v25, v25
    v_exp_f32 v26, v26
    v_exp_f32 v27, v27
    s_waitcnt lgkmcnt(3)
    v_smfmac_f32_32x32x32_bf16 v[48:63], v[76:79], v[16:23], v84
    ds_read_b64_tr_b16 v[136:137], v13 offset:40960
    ds_read_b64_tr_b16 v[138:139], v13 offset:41984
    ds_read_b128 v[76:79], v87 offset:43008
    v_exp_f32 v28, v28
    v_exp_f32 v29, v29
    v_exp_f32 v30, v30
    v_exp_f32 v31, v31
    s_setprio 0
    s_waitcnt lgkmcnt(3)
    v_smfmac_f32_32x32x32_bf16 v[48:63], v[80:83], v[24:31], v84
    ds_read_b128 v[80:83], v87 offset:46848
    v_exp_f32 v32, v32
    v_exp_f32 v33, v33
    v_exp_f32 v34, v34
    v_exp_f32 v35, v35
    s_waitcnt lgkmcnt(3)
    v_mfma_f32_32x32x16_bf16 v[16:31], v[72:75], v[64:67], 0
    ds_read_b128 v[72:75], v85 offset:46080
    s_mov_b64 exec, 0x3ff
    buffer_load_dwordx2 v[6:7], v10, s[24:27], s14 offen offset:124 sc1
    s_mov_b64 exec, -1
    v_exp_f32 v36, v36
    v_exp_f32 v37, v37
    v_exp_f32 v38, v38
    v_exp_f32 v39, v39
    s_waitcnt lgkmcnt(3)
    v_mfma_f32_32x32x8_bf16 v[16:31], v[70:71], v[68:69], v[16:31]
    ds_read_b32 v70, v86 offset:46080
    v_exp_f32 v40, v40
    v_exp_f32 v41, v41
    v_exp_f32 v42, v42
    v_exp_f32 v43, v43
    s_waitcnt lgkmcnt(3)
    v_smfmac_f32_32x32x32_bf16 v[48:63], v[76:79], v[32:39], v84
    ds_read_b64_tr_b16 v[140:141], v13 offset:57344
    ds_read_b64_tr_b16 v[142:143], v13 offset:58368
    ds_read_b128 v[76:79], v87 offset:46080
    v_exp_f32 v44, v44
    v_exp_f32 v45, v45
    v_exp_f32 v46, v46
    v_exp_f32 v47, v47
    s_waitcnt vmcnt(9) lgkmcnt(0)
    s_barrier
    s_setprio 3
    v_smfmac_f32_32x32x32_bf16 v[48:63], v[80:83], v[40:47], v84
    ds_read_b128 v[80:83], v87 offset:768
    s_and_b32 s14, s6, 1
    s_lshl3_add_u32 s14, s14, s5
    s_lshl3_add_u32 s14, s14, s3
    s_mul_i32 s14, s14, 3328
    s_add_u32 s14, s14, s79
    v_exp_f32 v16, v16
    v_exp_f32 v17, v17
    v_exp_f32 v18, v18
    v_exp_f32 v19, v19
    v_mfma_f32_32x32x16_bf16 v[32:47], v[72:75], v[64:67], 0
    ds_read_b128 v[72:75], v85 offset:0
    s_add_u32 s72, s72, 32768
    s_bitset0_b32 s72, 18
    s_add_u32 m0, s73, 139264
    s_nop 0
    buffer_load_dwordx4 v15, s[68:71], s72 offen offset:0 sc1 lds
    v_exp_f32 v20, v20
    v_exp_f32 v21, v21
    v_exp_f32 v22, v22
    v_exp_f32 v23, v23
    v_mfma_f32_32x32x8_bf16 v[32:47], v[70:71], v[68:69], v[32:47]
    ds_read_b32 v70, v86 offset:0
    v_exp_f32 v24, v24
    v_exp_f32 v25, v25
    v_exp_f32 v26, v26
    v_exp_f32 v27, v27
    v_smfmac_f32_32x32x32_bf16 v[48:63], v[76:79], v[16:23], v84
    ds_read_b128 v[76:79], v87 offset:0
    buffer_load_dwordx4 v15, s[68:71], s72 offen offset:1024 sc1 lds
    v_exp_f32 v28, v28
    v_exp_f32 v29, v29
    v_exp_f32 v30, v30
    v_exp_f32 v31, v31
    s_setprio 2
    s_waitcnt lgkmcnt(3)
    v_smfmac_f32_32x32x32_bf16 v[48:63], v[80:83], v[24:31], v84
    ds_read_b128 v[80:83], v87 offset:3840
    v_exp_f32 v32, v32
    v_exp_f32 v33, v33
    v_exp_f32 v34, v34
    v_exp_f32 v35, v35
    s_waitcnt lgkmcnt(3)
    v_mfma_f32_32x32x16_bf16 v[16:31], v[72:75], v[64:67], 0
    ds_read_b128 v[72:75], v85 offset:3072
    buffer_load_dwordx4 v15, s[68:71], s72 offen offset:2048 sc1 lds
    v_exp_f32 v36, v36
    v_exp_f32 v37, v37
    v_exp_f32 v38, v38
    v_exp_f32 v39, v39
    s_waitcnt lgkmcnt(3)
    v_mfma_f32_32x32x8_bf16 v[16:31], v[70:71], v[68:69], v[16:31]
    ds_read_b32 v70, v86 offset:3072
    v_exp_f32 v40, v40
    v_exp_f32 v41, v41
    v_exp_f32 v42, v42
    v_exp_f32 v43, v43
    s_waitcnt lgkmcnt(3)
    v_smfmac_f32_32x32x32_bf16 v[48:63], v[76:79], v[32:39], v84
    ds_read_b128 v[76:79], v87 offset:3072
    v_exp_f32 v44, v44
    v_exp_f32 v45, v45
    v_exp_f32 v46, v46
    v_exp_f32 v47, v47
    s_setprio 1
    s_waitcnt lgkmcnt(3)
    v_smfmac_f32_32x32x32_bf16 v[48:63], v[80:83], v[40:47], v84
    ds_read_b128 v[80:83], v87 offset:6912
    v_exp_f32 v16, v16
    v_exp_f32 v17, v17
    v_exp_f32 v18, v18
    v_exp_f32 v19, v19
    s_waitcnt lgkmcnt(3)
    v_mfma_f32_32x32x16_bf16 v[32:47], v[72:75], v[64:67], 0
    ds_read_b128 v[72:75], v85 offset:6144
    buffer_store_dwordx4 v[128:131], v15, s[68:71], s15 offen sc1
    s_add_u32 s15, s15, 40960
    v_exp_f32 v20, v20
    v_exp_f32 v21, v21
    v_exp_f32 v22, v22
    v_exp_f32 v23, v23
    s_waitcnt lgkmcnt(3)
    v_mfma_f32_32x32x8_bf16 v[32:47], v[70:71], v[68:69], v[32:47]
    ds_read_b32 v70, v86 offset:6144
    v_exp_f32 v24, v24
    v_exp_f32 v25, v25
    v_exp_f32 v26, v26
    v_exp_f32 v27, v27
    s_waitcnt lgkmcnt(3)
    v_smfmac_f32_32x32x32_bf16 v[48:63], v[76:79], v[16:23], v84
    ds_read_b128 v[76:79], v87 offset:6144
    v_exp_f32 v28, v28
    v_exp_f32 v29, v29
    v_exp_f32 v30, v30
    v_exp_f32 v31, v31
    s_setprio 0
    s_waitcnt lgkmcnt(3)
    v_smfmac_f32_32x32x32_bf16 v[48:63], v[80:83], v[24:31], v84
    ds_read_b128 v[80:83], v87 offset:9984
    v_exp_f32 v32, v32
    v_exp_f32 v33, v33
    v_exp_f32 v34, v34
    v_exp_f32 v35, v35
    s_waitcnt lgkmcnt(3)
    v_mfma_f32_32x32x16_bf16 v[16:31], v[72:75], v[64:67], 0
    ds_read_b128 v[72:75], v85 offset:9216
    buffer_store_dwordx4 v[136:139], v15, s[68:71], s15 offen sc1
    s_sub_u32 s15, s15, 32768
    v_exp_f32 v36, v36
    v_exp_f32 v37, v37
    v_exp_f32 v38, v38
    v_exp_f32 v39, v39
    s_waitcnt lgkmcnt(3)
    v_mfma_f32_32x32x8_bf16 v[16:31], v[70:71], v[68:69], v[16:31]
    ds_read_b32 v70, v86 offset:9216
    v_exp_f32 v40, v40
    v_exp_f32 v41, v41
    v_exp_f32 v42, v42
    v_exp_f32 v43, v43
    s_waitcnt lgkmcnt(3)
    v_smfmac_f32_32x32x32_bf16 v[48:63], v[76:79], v[32:39], v84
    ds_read_b128 v[76:79], v87 offset:9216
    v_exp_f32 v44, v44
    v_exp_f32 v45, v45
    v_exp_f32 v46, v46
    v_exp_f32 v47, v47
    s_waitcnt lgkmcnt(0)
    s_barrier
    s_setprio 3
    v_smfmac_f32_32x32x32_bf16 v[48:63], v[80:83], v[40:47], v84
    ds_read_b128 v[80:83], v87 offset:13056
    v_exp_f32 v16, v16
    v_exp_f32 v17, v17
    v_exp_f32 v18, v18
    v_exp_f32 v19, v19
    v_mfma_f32_32x32x16_bf16 v[32:47], v[72:75], v[64:67], 0
    ds_read_b128 v[72:75], v85 offset:12288
    s_add_u32 m0, s19, 0
    s_nop 0
    buffer_load_dwordx4 v11, s[24:27], s18 offen lds
    s_add_u32 s18, s18, 61440
    v_exp_f32 v20, v20
    v_exp_f32 v21, v21
    v_exp_f32 v22, v22
    v_exp_f32 v23, v23
    v_mfma_f32_32x32x8_bf16 v[32:47], v[70:71], v[68:69], v[32:47]
    ds_read_b32 v70, v86 offset:12288
    v_exp_f32 v24, v24
    v_exp_f32 v25, v25
    v_exp_f32 v26, v26
    v_exp_f32 v27, v27
    v_smfmac_f32_32x32x32_bf16 v[48:63], v[76:79], v[16:23], v84
    ds_read_b128 v[76:79], v87 offset:12288
    v_exp_f32 v28, v28
    v_exp_f32 v29, v29
    v_exp_f32 v30, v30
    v_exp_f32 v31, v31
    s_setprio 2
    s_waitcnt lgkmcnt(3)
    v_smfmac_f32_32x32x32_bf16 v[48:63], v[80:83], v[24:31], v84
    ds_read_b128 v[80:83], v87 offset:16128
    v_exp_f32 v32, v32
    v_exp_f32 v33, v33
    v_exp_f32 v34, v34
    v_exp_f32 v35, v35
    s_waitcnt lgkmcnt(3)
    v_mfma_f32_32x32x16_bf16 v[16:31], v[72:75], v[64:67], 0
    ds_read_b128 v[72:75], v85 offset:15360
    s_add_u32 m0, s19, 7680
    s_nop 0
    buffer_load_dwordx4 v11, s[24:27], s18 offen lds
    s_add_u32 s18, s18, 61440
    v_exp_f32 v36, v36
    v_exp_f32 v37, v37
    v_exp_f32 v38, v38
    v_exp_f32 v39, v39
    s_waitcnt lgkmcnt(3)
    v_mfma_f32_32x32x8_bf16 v[16:31], v[70:71], v[68:69], v[16:31]
    ds_read_b32 v70, v86 offset:15360
    v_exp_f32 v40, v40
    v_exp_f32 v41, v41
    v_exp_f32 v42, v42
    v_exp_f32 v43, v43
    s_waitcnt lgkmcnt(3)
    v_smfmac_f32_32x32x32_bf16 v[48:63], v[76:79], v[32:39], v84
    ds_read_b128 v[76:79], v87 offset:15360
    v_exp_f32 v44, v44
    v_exp_f32 v45, v45
    v_exp_f32 v46, v46
    v_exp_f32 v47, v47
    s_setprio 1
    s_waitcnt lgkmcnt(3)
    v_smfmac_f32_32x32x32_bf16 v[48:63], v[80:83], v[40:47], v84
    ds_read_b128 v[80:83], v87 offset:19200
    v_exp_f32 v16, v16
    v_exp_f32 v17, v17
    v_exp_f32 v18, v18
    v_exp_f32 v19, v19
    s_waitcnt lgkmcnt(3)
    v_mfma_f32_32x32x16_bf16 v[32:47], v[72:75], v[64:67], 0
    ds_read_b128 v[72:75], v85 offset:18432
    s_add_u32 m0, s19, 15360
    s_nop 0
    buffer_load_dwordx4 v11, s[24:27], s18 offen lds
    s_add_u32 s18, s18, 61440
    v_exp_f32 v20, v20
    v_exp_f32 v21, v21
    v_exp_f32 v22, v22
    v_exp_f32 v23, v23
    s_waitcnt lgkmcnt(3)
    v_mfma_f32_32x32x8_bf16 v[32:47], v[70:71], v[68:69], v[32:47]
    ds_read_b32 v70, v86 offset:18432
    v_exp_f32 v24, v24
    v_exp_f32 v25, v25
    v_exp_f32 v26, v26
    v_exp_f32 v27, v27
    s_waitcnt lgkmcnt(3)
    v_smfmac_f32_32x32x32_bf16 v[48:63], v[76:79], v[16:23], v84
    ds_read_b128 v[76:79], v87 offset:18432
    v_exp_f32 v28, v28
    v_exp_f32 v29, v29
    v_exp_f32 v30, v30
    v_exp_f32 v31, v31
    s_setprio 0
    s_waitcnt lgkmcnt(3)
    v_smfmac_f32_32x32x32_bf16 v[48:63], v[80:83], v[24:31], v84
    ds_read_b128 v[80:83], v87 offset:22272
    v_exp_f32 v32, v32
    v_exp_f32 v33, v33
    v_exp_f32 v34, v34
    v_exp_f32 v35, v35
    s_waitcnt lgkmcnt(3)
    v_mfma_f32_32x32x16_bf16 v[16:31], v[72:75], v[64:67], 0
    ds_read_b128 v[72:75], v85 offset:21504
    v_exp_f32 v36, v36
    v_exp_f32 v37, v37
    v_exp_f32 v38, v38
    v_exp_f32 v39, v39
    s_waitcnt lgkmcnt(3)
    v_mfma_f32_32x32x8_bf16 v[16:31], v[70:71], v[68:69], v[16:31]
    ds_read_b32 v70, v86 offset:21504
    v_exp_f32 v40, v40
    v_exp_f32 v41, v41
    v_exp_f32 v42, v42
    v_exp_f32 v43, v43
    s_waitcnt lgkmcnt(3)
    v_smfmac_f32_32x32x32_bf16 v[48:63], v[76:79], v[32:39], v84
    ds_read_b128 v[76:79], v87 offset:21504
    v_exp_f32 v44, v44
    v_exp_f32 v45, v45
    v_exp_f32 v46, v46
    v_exp_f32 v47, v47
    s_waitcnt vmcnt(3) lgkmcnt(0)
    s_barrier
    s_setprio 3
    v_smfmac_f32_32x32x32_bf16 v[48:63], v[80:83], v[40:47], v84
    ds_read_b128 v[80:83], v87 offset:25344
    s_lshl_b32 s39, s3, 2
    s_lshr_b32 s39, 0x76325410, s39
    s_and_b32 s39, s39, 7
    s_and_b32 s15, s39, 3
    s_lshl2_add_u32 s15, s6, s15
    s_mul_i32 s15, s15, 20480
    s_mul_i32 s10, s5, 160
    s_add_u32 s15, s15, s10
    s_lshr_b32 s13, s6, 1
    s_lshl_b32 s13, s13, 8
    v_and_b32 v3, 0xf0, v15
    v_lshrrev_b32 v5, 4, v1
    v_mul_u32_u24 v4, 80, v3
    v_lshl_add_u32 v2, v5, 3, v4
    v_exp_f32 v16, v16
    v_exp_f32 v17, v17
    v_exp_f32 v18, v18
    v_exp_f32 v19, v19
    v_mfma_f32_32x32x16_bf16 v[32:47], v[72:75], v[64:67], 0
    ds_read_b128 v[72:75], v85 offset:24576
    s_add_u32 s72, s72, 32768
    s_bitset0_b32 s72, 18
    s_add_u32 m0, s73, 114688
    s_nop 0
    buffer_load_dwordx4 v15, s[68:71], s72 offen offset:0 sc1 lds
    v_exp_f32 v20, v20
    v_exp_f32 v21, v21
    v_exp_f32 v22, v22
    v_exp_f32 v23, v23
    v_mfma_f32_32x32x8_bf16 v[32:47], v[70:71], v[68:69], v[32:47]
    ds_read_b32 v70, v86 offset:24576
    v_exp_f32 v24, v24
    v_exp_f32 v25, v25
    v_exp_f32 v26, v26
    v_exp_f32 v27, v27
    v_smfmac_f32_32x32x32_bf16 v[48:63], v[76:79], v[16:23], v84
    ds_read_b128 v[76:79], v87 offset:24576
    buffer_load_dwordx4 v15, s[68:71], s72 offen offset:1024 sc1 lds
    v_exp_f32 v28, v28
    v_exp_f32 v29, v29
    v_exp_f32 v30, v30
    v_exp_f32 v31, v31
    s_setprio 2
    s_waitcnt lgkmcnt(3)
    v_smfmac_f32_32x32x32_bf16 v[48:63], v[80:83], v[24:31], v84
    ds_read_b128 v[80:83], v87 offset:28416
    v_exp_f32 v32, v32
    v_exp_f32 v33, v33
    v_exp_f32 v34, v34
    v_exp_f32 v35, v35
    s_waitcnt lgkmcnt(3)
    v_mfma_f32_32x32x16_bf16 v[16:31], v[72:75], v[64:67], 0
    ds_read_b128 v[72:75], v85 offset:27648
    buffer_load_dwordx4 v15, s[68:71], s72 offen offset:2048 sc1 lds
    v_exp_f32 v36, v36
    v_exp_f32 v37, v37
    v_exp_f32 v38, v38
    v_exp_f32 v39, v39
    s_waitcnt lgkmcnt(3)
    v_mfma_f32_32x32x8_bf16 v[16:31], v[70:71], v[68:69], v[16:31]
    ds_read_b32 v70, v86 offset:27648
    v_exp_f32 v40, v40
    v_exp_f32 v41, v41
    v_exp_f32 v42, v42
    v_exp_f32 v43, v43
    s_waitcnt lgkmcnt(3)
    v_smfmac_f32_32x32x32_bf16 v[48:63], v[76:79], v[32:39], v84
    ds_read_b128 v[76:79], v87 offset:27648
    s_lshl_b32 s10, s6, 4
    s_cmp_eq_u32 s3, 0
    s_cselect_b32 s10, s10, 0x40000000
    s_add_u32 s10, s10, 4096
    v_mov_b32 v5, s4
    s_mov_b64 exec, 1
    buffer_store_dword v5, v15, s[68:71], s10 offen sc1
    s_mov_b64 exec, -1
    v_exp_f32 v44, v44
    v_exp_f32 v45, v45
    v_exp_f32 v46, v46
    v_exp_f32 v47, v47
    s_setprio 1
    s_waitcnt lgkmcnt(3)
    v_smfmac_f32_32x32x32_bf16 v[48:63], v[80:83], v[40:47], v84
    ds_read_b128 v[80:83], v87 offset:31488
    v_exp_f32 v16, v16
    v_exp_f32 v17, v17
    v_exp_f32 v18, v18
    v_exp_f32 v19, v19
    s_waitcnt lgkmcnt(3)
    v_mfma_f32_32x32x16_bf16 v[32:47], v[72:75], v[64:67], 0
    ds_read_b128 v[72:75], v85 offset:30720
    s_add_u32 m0, s19, 23040
    s_nop 0
    buffer_load_dwordx4 v11, s[24:27], s18 offen lds
    s_add_u32 s18, s18, 61440
    v_exp_f32 v20, v20
    v_exp_f32 v21, v21
    v_exp_f32 v22, v22
    v_exp_f32 v23, v23
    s_waitcnt lgkmcnt(3)
    v_mfma_f32_32x32x8_bf16 v[32:47], v[70:71], v[68:69], v[32:47]
    ds_read_b32 v70, v86 offset:30720
    v_exp_f32 v24, v24
    v_exp_f32 v25, v25
    v_exp_f32 v26, v26
    v_exp_f32 v27, v27
    s_waitcnt lgkmcnt(3)
    v_smfmac_f32_32x32x32_bf16 v[48:63], v[76:79], v[16:23], v84
    ds_read_b128 v[76:79], v87 offset:30720
    s_add_u32 m0, s19, 30720
    s_nop 0
    buffer_load_dwordx4 v11, s[24:27], s18 offen lds
    s_add_u32 s18, s18, 61440
    v_exp_f32 v28, v28
    v_exp_f32 v29, v29
    v_exp_f32 v30, v30
    v_exp_f32 v31, v31
    s_setprio 0
    s_waitcnt lgkmcnt(3)
    v_smfmac_f32_32x32x32_bf16 v[48:63], v[80:83], v[24:31], v84
    ds_read_b128 v[80:83], v87 offset:34560
    v_exp_f32 v32, v32
    v_exp_f32 v33, v33
    v_exp_f32 v34, v34
    v_exp_f32 v35, v35
    s_waitcnt lgkmcnt(3)
    v_mfma_f32_32x32x16_bf16 v[16:31], v[72:75], v[64:67], 0
    ds_read_b128 v[72:75], v85 offset:33792
    s_add_u32 m0, s19, 38400
    s_nop 0
    buffer_load_dwordx4 v11, s[24:27], s18 offen lds
    s_add_u32 s18, s18, 61440
    v_exp_f32 v36, v36
    v_exp_f32 v37, v37
    v_exp_f32 v38, v38
    v_exp_f32 v39, v39
    s_waitcnt lgkmcnt(3)
    v_mfma_f32_32x32x8_bf16 v[16:31], v[70:71], v[68:69], v[16:31]
    ds_read_b32 v70, v86 offset:33792
    v_exp_f32 v40, v40
    v_exp_f32 v41, v41
    v_exp_f32 v42, v42
    v_exp_f32 v43, v43
    s_waitcnt lgkmcnt(3)
    v_smfmac_f32_32x32x32_bf16 v[48:63], v[76:79], v[32:39], v84
    ds_read_b128 v[76:79], v87 offset:33792
    buffer_load_dword v4, v3, s[68:71], s13 offen offset:4 sc1
    v_exp_f32 v44, v44
    v_exp_f32 v45, v45
    v_exp_f32 v46, v46
    v_exp_f32 v47, v47
    s_waitcnt lgkmcnt(0)
    s_barrier
    s_setprio 3
    v_smfmac_f32_32x32x32_bf16 v[48:63], v[80:83], v[40:47], v84
    ds_read_b128 v[80:83], v87 offset:37632
    v_exp_f32 v16, v16
    v_exp_f32 v17, v17
    v_exp_f32 v18, v18
    v_exp_f32 v19, v19
    v_mfma_f32_32x32x16_bf16 v[32:47], v[72:75], v[64:67], 0
    ds_read_b128 v[72:75], v85 offset:36864
    s_add_u32 m0, s19, 46080
    s_nop 0
    buffer_load_dwordx4 v11, s[24:27], s18 offen lds
    s_add_u32 s18, s18, 61440
    v_exp_f32 v20, v20
    v_exp_f32 v21, v21
    v_exp_f32 v22, v22
    v_exp_f32 v23, v23
    v_mfma_f32_32x32x8_bf16 v[32:47], v[70:71], v[68:69], v[32:47]
    ds_read_b32 v70, v86 offset:36864
    v_exp_f32 v24, v24
    v_exp_f32 v25, v25
    v_exp_f32 v26, v26
    v_exp_f32 v27, v27
    v_smfmac_f32_32x32x32_bf16 v[48:63], v[76:79], v[16:23], v84
    ds_read_b128 v[76:79], v87 offset:36864
    v_exp_f32 v28, v28
    v_exp_f32 v29, v29
    v_exp_f32 v30, v30
    v_exp_f32 v31, v31
    s_setprio 2
    s_waitcnt lgkmcnt(3)
    v_smfmac_f32_32x32x32_bf16 v[48:63], v[80:83], v[24:31], v84
    ds_read_b128 v[80:83], v87 offset:40704
    v_exp_f32 v32, v32
    v_exp_f32 v33, v33
    v_exp_f32 v34, v34
    v_exp_f32 v35, v35
    s_waitcnt lgkmcnt(3)
    v_mfma_f32_32x32x16_bf16 v[16:31], v[72:75], v[64:67], 0
    ds_read_b128 v[72:75], v85 offset:39936
    s_add_u32 m0, s19, 53760
    s_nop 0
    buffer_load_dwordx4 v11, s[24:27], s18 offen lds
    s_add_u32 s18, s18, 61440
    v_exp_f32 v36, v36
    v_exp_f32 v37, v37
    v_exp_f32 v38, v38
    v_exp_f32 v39, v39
    s_waitcnt lgkmcnt(3)
    v_mfma_f32_32x32x8_bf16 v[16:31], v[70:71], v[68:69], v[16:31]
    ds_read_b32 v70, v86 offset:39936
    v_exp_f32 v40, v40
    v_exp_f32 v41, v41
    v_exp_f32 v42, v42
    v_exp_f32 v43, v43
    s_waitcnt lgkmcnt(3)
    v_smfmac_f32_32x32x32_bf16 v[48:63], v[76:79], v[32:39], v84
    ds_read_b128 v[76:79], v87 offset:39936
    v_exp_f32 v44, v44
    v_exp_f32 v45, v45
    v_exp_f32 v46, v46
    v_exp_f32 v47, v47
    s_setprio 1
    s_waitcnt lgkmcnt(3)
    v_smfmac_f32_32x32x32_bf16 v[48:63], v[80:83], v[40:47], v84
    ds_read_b128 v[80:83], v87 offset:43776
    v_exp_f32 v16, v16
    v_exp_f32 v17, v17
    v_exp_f32 v18, v18
    v_exp_f32 v19, v19
    s_waitcnt lgkmcnt(3)
    v_mfma_f32_32x32x16_bf16 v[32:47], v[72:75], v[64:67], 0
    ds_read_b128 v[72:75], v85 offset:43008
    s_add_u32 m0, s19, 61440
    s_nop 0
    buffer_load_dwordx4 v11, s[24:27], s18 offen lds
    s_add_u32 s18, s18, 61440
    v_exp_f32 v20, v20
    v_exp_f32 v21, v21
    v_exp_f32 v22, v22
    v_exp_f32 v23, v23
    s_waitcnt lgkmcnt(3)
    v_mfma_f32_32x32x8_bf16 v[32:47], v[70:71], v[68:69], v[32:47]
    ds_read_b32 v70, v86 offset:43008
    v_exp_f32 v24, v24
    v_exp_f32 v25, v25
    v_exp_f32 v26, v26
    v_exp_f32 v27, v27
    s_waitcnt lgkmcnt(3)
    v_smfmac_f32_32x32x32_bf16 v[48:63], v[76:79], v[16:23], v84
    ds_read_b128 v[76:79], v87 offset:43008
    v_exp_f32 v28, v28
    v_exp_f32 v29, v29
    v_exp_f32 v30, v30
    v_exp_f32 v31, v31
    s_setprio 0
    s_waitcnt lgkmcnt(3)
    v_smfmac_f32_32x32x32_bf16 v[48:63], v[80:83], v[24:31], v84
    ds_read_b128 v[80:83], v87 offset:46848
    v_exp_f32 v32, v32
    v_exp_f32 v33, v33
    v_exp_f32 v34, v34
    v_exp_f32 v35, v35
    s_waitcnt lgkmcnt(3)
    v_mfma_f32_32x32x16_bf16 v[16:31], v[72:75], v[64:67], 0
    ds_read_b128 v[72:75], v85 offset:46080
    buffer_load_dwordx2 v[92:93], v2, s[40:43], s15 offen offset:64
    s_and_b32 s10, s39, 4
    s_mul_i32 s10, s10, 24
    s_add_u32 s15, s15, s10
    v_exp_f32 v36, v36
    v_exp_f32 v37, v37
    v_exp_f32 v38, v38
    v_exp_f32 v39, v39
    s_waitcnt lgkmcnt(3)
    v_mfma_f32_32x32x8_bf16 v[16:31], v[70:71], v[68:69], v[16:31]
    ds_read_b32 v70, v86 offset:46080
    v_exp_f32 v40, v40
    v_exp_f32 v41, v41
    v_exp_f32 v42, v42
    v_exp_f32 v43, v43
    s_waitcnt lgkmcnt(3)
    v_smfmac_f32_32x32x32_bf16 v[48:63], v[76:79], v[32:39], v84
    ds_read_b128 v[76:79], v87 offset:46080
    v_exp_f32 v44, v44
    v_exp_f32 v45, v45
    v_exp_f32 v46, v46
    v_exp_f32 v47, v47
    s_waitcnt vmcnt(9) lgkmcnt(0)
    s_barrier
    s_setprio 3
    v_smfmac_f32_32x32x32_bf16 v[48:63], v[80:83], v[40:47], v84
    ds_read_b128 v[80:83], v87 offset:768
    v_exp_f32 v16, v16
    v_exp_f32 v17, v17
    v_exp_f32 v18, v18
    v_exp_f32 v19, v19
    v_mfma_f32_32x32x16_bf16 v[32:47], v[72:75], v[64:67], 0
    ds_read_b128 v[72:75], v85 offset:0
    s_add_u32 s72, s72, 32768
    s_bitset0_b32 s72, 18
    s_add_u32 m0, s73, 139264
    s_nop 0
    buffer_load_dwordx4 v15, s[68:71], s72 offen offset:0 sc1 lds
    v_exp_f32 v20, v20
    v_exp_f32 v21, v21
    v_exp_f32 v22, v22
    v_exp_f32 v23, v23
    v_mfma_f32_32x32x8_bf16 v[32:47], v[70:71], v[68:69], v[32:47]
    ds_read_b32 v70, v86 offset:0
    v_exp_f32 v24, v24
    v_exp_f32 v25, v25
    v_exp_f32 v26, v26
    v_exp_f32 v27, v27
    v_smfmac_f32_32x32x32_bf16 v[48:63], v[76:79], v[16:23], v84
    ds_read_b128 v[76:79], v87 offset:0
    buffer_load_dwordx4 v15, s[68:71], s72 offen offset:1024 sc1 lds
    v_exp_f32 v28, v28
    v_exp_f32 v29, v29
    v_exp_f32 v30, v30
    v_exp_f32 v31, v31
    s_setprio 2
    s_waitcnt lgkmcnt(3)
    v_smfmac_f32_32x32x32_bf16 v[48:63], v[80:83], v[24:31], v84
    ds_read_b128 v[80:83], v87 offset:3840
    v_exp_f32 v32, v32
    v_exp_f32 v33, v33
    v_exp_f32 v34, v34
    v_exp_f32 v35, v35
    s_waitcnt lgkmcnt(3)
    v_mfma_f32_32x32x16_bf16 v[16:31], v[72:75], v[64:67], 0
    ds_read_b128 v[72:75], v85 offset:3072
    buffer_load_dwordx4 v15, s[68:71], s72 offen offset:2048 sc1 lds
    v_exp_f32 v36, v36
    v_exp_f32 v37, v37
    v_exp_f32 v38, v38
    v_exp_f32 v39, v39
    s_waitcnt lgkmcnt(3)
    v_mfma_f32_32x32x8_bf16 v[16:31], v[70:71], v[68:69], v[16:31]
    ds_read_b32 v70, v86 offset:3072
    v_exp_f32 v40, v40
    v_exp_f32 v41, v41
    v_exp_f32 v42, v42
    v_exp_f32 v43, v43
    s_waitcnt lgkmcnt(3)
    v_smfmac_f32_32x32x32_bf16 v[48:63], v[76:79], v[32:39], v84
    ds_read_b128 v[76:79], v87 offset:3072
    s_add_u32 m0, s19, 69120
    s_nop 0
    buffer_load_dwordx4 v11, s[24:27], s18 offen lds
    s_add_u32 s18, s18, 61440
    v_exp_f32 v44, v44
    v_exp_f32 v45, v45
    v_exp_f32 v46, v46
    v_exp_f32 v47, v47
    s_setprio 1
    s_waitcnt lgkmcnt(3)
    v_smfmac_f32_32x32x32_bf16 v[48:63], v[80:83], v[40:47], v84
    ds_read_b128 v[80:83], v87 offset:6912
    v_exp_f32 v16, v16
    v_exp_f32 v17, v17
    v_exp_f32 v18, v18
    v_exp_f32 v19, v19
    s_waitcnt lgkmcnt(3)
    v_mfma_f32_32x32x16_bf16 v[32:47], v[72:75], v[64:67], 0
    ds_read_b128 v[72:75], v85 offset:6144
    s_add_u32 m0, s19, 76800
    s_nop 0
    buffer_load_dwordx4 v11, s[24:27], s18 offen lds
    s_add_u32 s18, s18, 61440
    v_exp_f32 v20, v20
    v_exp_f32 v21, v21
    v_exp_f32 v22, v22
    v_exp_f32 v23, v23
    s_waitcnt lgkmcnt(3)
    v_mfma_f32_32x32x8_bf16 v[32:47], v[70:71], v[68:69], v[32:47]
    ds_read_b32 v70, v86 offset:6144
    v_exp_f32 v24, v24
    v_exp_f32 v25, v25
    v_exp_f32 v26, v26
    v_exp_f32 v27, v27
    s_waitcnt lgkmcnt(3)
    v_smfmac_f32_32x32x32_bf16 v[48:63], v[76:79], v[16:23], v84
    ds_read_b128 v[76:79], v87 offset:6144
    v_exp_f32 v28, v28
    v_exp_f32 v29, v29
    v_exp_f32 v30, v30
    v_exp_f32 v31, v31
    s_setprio 0
    s_waitcnt lgkmcnt(3)
    v_smfmac_f32_32x32x32_bf16 v[48:63], v[80:83], v[24:31], v84
    ds_read_b128 v[80:83], v87 offset:9984
    v_exp_f32 v32, v32
    v_exp_f32 v33, v33
    v_exp_f32 v34, v34
    v_exp_f32 v35, v35
    s_waitcnt lgkmcnt(3)
    v_mfma_f32_32x32x16_bf16 v[16:31], v[72:75], v[64:67], 0
    ds_read_b128 v[72:75], v85 offset:9216
    s_add_u32 m0, s19, 84480
    s_nop 0
    buffer_load_dwordx4 v11, s[24:27], s18 offen lds
    s_add_u32 s18, s18, 61440
    v_exp_f32 v36, v36
    v_exp_f32 v37, v37
    v_exp_f32 v38, v38
    v_exp_f32 v39, v39
    s_waitcnt lgkmcnt(3)
    v_mfma_f32_32x32x8_bf16 v[16:31], v[70:71], v[68:69], v[16:31]
    ds_read_b32 v70, v86 offset:9216
    v_exp_f32 v40, v40
    v_exp_f32 v41, v41
    v_exp_f32 v42, v42
    v_exp_f32 v43, v43
    s_waitcnt lgkmcnt(3)
    v_smfmac_f32_32x32x32_bf16 v[48:63], v[76:79], v[32:39], v84
    ds_read_b128 v[76:79], v87 offset:9216
    v_exp_f32 v44, v44
    v_exp_f32 v45, v45
    v_exp_f32 v46, v46
    v_exp_f32 v47, v47
    s_waitcnt vmcnt(10) lgkmcnt(0)
    s_barrier
    s_setprio 3
    v_smfmac_f32_32x32x32_bf16 v[48:63], v[80:83], v[40:47], v84
    ds_read_b128 v[80:83], v87 offset:13056
    v_cmp_ne_u32 vcc, s8, v4
    s_cmp_eq_u64 vcc, 0
    s_cselect_b32 s7, 1, 0
    v_and_b32 v3, 0x1f0, v15
    s_movk_i32 s13, 4096
    v_exp_f32 v16, v16
    v_exp_f32 v17, v17
    v_exp_f32 v18, v18
    v_exp_f32 v19, v19
    v_mfma_f32_32x32x16_bf16 v[32:47], v[72:75], v[64:67], 0
    ds_read_b128 v[72:75], v85 offset:12288
    s_add_u32 m0, s19, 92160
    s_nop 0
    buffer_load_dwordx4 v11, s[24:27], s18 offen lds
    s_add_u32 s18, s18, 61440
    v_exp_f32 v20, v20
    v_exp_f32 v21, v21
    v_exp_f32 v22, v22
    v_exp_f32 v23, v23
    v_mfma_f32_32x32x8_bf16 v[32:47], v[70:71], v[68:69], v[32:47]
WST40960:
    s_cbranch_execz WST19601
    ds_read_b32 v70, v86 offset:12288
    v_exp_f32 v24, v24
    v_exp_f32 v25, v25
    v_exp_f32 v26, v26
    v_exp_f32 v27, v27
    v_smfmac_f32_32x32x32_bf16 v[48:63], v[76:79], v[16:23], v84
    ds_read_b128 v[76:79], v87 offset:12288
    v_exp_f32 v28, v28
    v_exp_f32 v29, v29
    v_exp_f32 v30, v30
    v_exp_f32 v31, v31
    s_setprio 2
    s_waitcnt lgkmcnt(3)
    v_smfmac_f32_32x32x32_bf16 v[48:63], v[80:83], v[24:31], v84
    ds_read_b128 v[80:83], v87 offset:16128
    v_exp_f32 v32, v32
    v_exp_f32 v33, v33
    v_exp_f32 v34, v34
    v_exp_f32 v35, v35
    s_waitcnt lgkmcnt(3)
    v_mfma_f32_32x32x16_bf16 v[16:31], v[72:75], v[64:67], 0
    ds_read_b128 v[72:75], v85 offset:15360
    s_add_u32 m0, s19, 99840
    s_nop 0
    buffer_load_dwordx4 v11, s[24:27], s18 offen lds
    s_add_u32 s18, s18, 61440
    v_exp_f32 v36, v36
    v_exp_f32 v37, v37
    v_exp_f32 v38, v38
    v_exp_f32 v39, v39
    s_waitcnt lgkmcnt(3)
    v_mfma_f32_32x32x8_bf16 v[16:31], v[70:71], v[68:69], v[16:31]
    ds_read_b32 v70, v86 offset:15360
    v_exp_f32 v40, v40
    v_exp_f32 v41, v41
    v_exp_f32 v42, v42
    v_exp_f32 v43, v43
    s_waitcnt lgkmcnt(3)
    v_smfmac_f32_32x32x32_bf16 v[48:63], v[76:79], v[32:39], v84
    ds_read_b128 v[76:79], v87 offset:15360
    v_exp_f32 v44, v44
    v_exp_f32 v45, v45
    v_exp_f32 v46, v46
    v_exp_f32 v47, v47
    s_setprio 1
    s_waitcnt lgkmcnt(3)
    v_smfmac_f32_32x32x32_bf16 v[48:63], v[80:83], v[40:47], v84
    ds_read_b128 v[80:83], v87 offset:19200
    v_exp_f32 v16, v16
    v_exp_f32 v17, v17
    v_exp_f32 v18, v18
    v_exp_f32 v19, v19
    s_waitcnt lgkmcnt(3)
    v_mfma_f32_32x32x16_bf16 v[32:47], v[72:75], v[64:67], 0
    ds_read_b128 v[72:75], v85 offset:18432
    buffer_load_dwordx2 v[88:89], v2, s[40:43], s15 offen offset:0
    v_exp_f32 v20, v20
    v_exp_f32 v21, v21
    v_exp_f32 v22, v22
    v_exp_f32 v23, v23
    s_waitcnt lgkmcnt(3)
    v_mfma_f32_32x32x8_bf16 v[32:47], v[70:71], v[68:69], v[32:47]
    ds_read_b32 v70, v86 offset:18432
    v_exp_f32 v24, v24
    v_exp_f32 v25, v25
    v_exp_f32 v26, v26
    v_exp_f32 v27, v27
    s_waitcnt lgkmcnt(3)
    v_smfmac_f32_32x32x32_bf16 v[48:63], v[76:79], v[16:23], v84
    ds_read_b128 v[76:79], v87 offset:18432
    v_exp_f32 v28, v28
    v_exp_f32 v29, v29
    v_exp_f32 v30, v30
    v_exp_f32 v31, v31
    s_setprio 0
    s_waitcnt lgkmcnt(3)
    v_smfmac_f32_32x32x32_bf16 v[48:63], v[80:83], v[24:31], v84
    ds_read_b128 v[80:83], v87 offset:22272
    v_exp_f32 v32, v32
    v_exp_f32 v33, v33
    v_exp_f32 v34, v34
    v_exp_f32 v35, v35
    s_waitcnt lgkmcnt(3)
    v_mfma_f32_32x32x16_bf16 v[16:31], v[72:75], v[64:67], 0
    ds_read_b128 v[72:75], v85 offset:21504
    buffer_load_dwordx2 v[90:91], v2, s[40:43], s15 offen offset:32
    v_exp_f32 v36, v36
    v_exp_f32 v37, v37
    v_exp_f32 v38, v38
    v_exp_f32 v39, v39
    s_waitcnt lgkmcnt(3)
    v_mfma_f32_32x32x8_bf16 v[16:31], v[70:71], v[68:69], v[16:31]
    ds_read_b32 v70, v86 offset:21504
    v_exp_f32 v40, v40
    v_exp_f32 v41, v41
    v_exp_f32 v42, v42
    v_exp_f32 v43, v43
    s_waitcnt lgkmcnt(3)
    v_smfmac_f32_32x32x32_bf16 v[48:63], v[76:79], v[32:39], v84
    ds_read_b128 v[76:79], v87 offset:21504
    v_exp_f32 v44, v44
    v_exp_f32 v45, v45
    v_exp_f32 v46, v46
    v_exp_f32 v47, v47
    s_waitcnt vmcnt(7) lgkmcnt(0)
    s_barrier
    s_setprio 3
    v_smfmac_f32_32x32x32_bf16 v[48:63], v[80:83], v[40:47], v84
    ds_read_b128 v[80:83], v87 offset:25344
    s_mul_i32 s15, s16, 1280
    s_add_u32 s15, s15, s79
    s_add_u32 s15, s15, 36864
    s_lshl2_add_u32 s16, s16, s79
    v_lshlrev_b32 v8, 3, v1
    v_exp_f32 v16, v16
    v_exp_f32 v17, v17
    v_exp_f32 v18, v18
    v_exp_f32 v19, v19
    v_mfma_f32_32x32x16_bf16 v[32:47], v[72:75], v[64:67], 0
    ds_read_b128 v[72:75], v85 offset:24576
    buffer_load_dword v4, v3, s[68:71], s13 offen sc1
    v_exp_f32 v20, v20
    v_exp_f32 v21, v21
    v_exp_f32 v22, v22
    v_exp_f32 v23, v23
    v_mfma_f32_32x32x8_bf16 v[32:47], v[70:71], v[68:69], v[32:47]
    ds_read_b32 v70, v86 offset:24576
    v_exp_f32 v24, v24
    v_exp_f32 v25, v25
    v_exp_f32 v26, v26
    v_exp_f32 v27, v27
    v_smfmac_f32_32x32x32_bf16 v[48:63], v[76:79], v[16:23], v84
    ds_read_b128 v[76:79], v87 offset:24576
    v_exp_f32 v28, v28
    v_exp_f32 v29, v29
    v_exp_f32 v30, v30
    v_exp_f32 v31, v31
    s_setprio 2
    s_waitcnt lgkmcnt(3)
    v_smfmac_f32_32x32x32_bf16 v[48:63], v[80:83], v[24:31], v84
    ds_read_b128 v[80:83], v87 offset:28416
    v_exp_f32 v32, v32
    v_exp_f32 v33, v33
    v_exp_f32 v34, v34
    v_exp_f32 v35, v35
    s_waitcnt lgkmcnt(3)
    v_mfma_f32_32x32x16_bf16 v[16:31], v[72:75], v[64:67], 0
    ds_read_b128 v[72:75], v85 offset:27648
    s_add_u32 s72, s72, 32768
    s_bitset0_b32 s72, 18
    s_add_u32 m0, s73, 114688
    s_nop 0
    buffer_load_dwordx4 v15, s[68:71], s72 offen offset:0 sc1 lds
    v_exp_f32 v36, v36
    v_exp_f32 v37, v37
    v_exp_f32 v38, v38
    v_exp_f32 v39, v39
    s_waitcnt lgkmcnt(3)
    v_mfma_f32_32x32x8_bf16 v[16:31], v[70:71], v[68:69], v[16:31]
    ds_read_b32 v70, v86 offset:27648
    v_exp_f32 v40, v40
    v_exp_f32 v41, v41
    v_exp_f32 v42, v42
    v_exp_f32 v43, v43
    s_waitcnt lgkmcnt(3)
    v_smfmac_f32_32x32x32_bf16 v[48:63], v[76:79], v[32:39], v84
    ds_read_b128 v[76:79], v87 offset:27648
    v_exp_f32 v44, v44
    v_exp_f32 v45, v45
    v_exp_f32 v46, v46
    v_exp_f32 v47, v47
    s_setprio 1
    s_waitcnt lgkmcnt(3)
    v_smfmac_f32_32x32x32_bf16 v[48:63], v[80:83], v[40:47], v84
    ds_read_b128 v[80:83], v87 offset:31488
    v_exp_f32 v16, v16
    v_exp_f32 v17, v17
    v_exp_f32 v18, v18
    v_exp_f32 v19, v19
    s_waitcnt lgkmcnt(3)
    v_mfma_f32_32x32x16_bf16 v[32:47], v[72:75], v[64:67], 0
    ds_read_b128 v[72:75], v85 offset:30720
    buffer_load_dwordx4 v15, s[68:71], s72 offen offset:1024 sc1 lds
    v_exp_f32 v20, v20
    v_exp_f32 v21, v21
    v_exp_f32 v22, v22
    v_exp_f32 v23, v23
    s_waitcnt lgkmcnt(3)
    v_mfma_f32_32x32x8_bf16 v[32:47], v[70:71], v[68:69], v[32:47]
    ds_read_b32 v70, v86 offset:30720
    v_exp_f32 v24, v24
    v_exp_f32 v25, v25
    v_exp_f32 v26, v26
    v_exp_f32 v27, v27
    s_waitcnt lgkmcnt(3)
    v_smfmac_f32_32x32x32_bf16 v[48:63], v[76:79], v[16:23], v84
    ds_read_b128 v[76:79], v87 offset:30720
    v_exp_f32 v28, v28
    v_exp_f32 v29, v29
    v_exp_f32 v30, v30
    v_exp_f32 v31, v31
    s_setprio 0
    s_waitcnt lgkmcnt(3)
    v_smfmac_f32_32x32x32_bf16 v[48:63], v[80:83], v[24:31], v84
    ds_read_b128 v[80:83], v87 offset:34560
    v_exp_f32 v32, v32
    v_exp_f32 v33, v33
    v_exp_f32 v34, v34
    v_exp_f32 v35, v35
    s_waitcnt lgkmcnt(3)
    v_mfma_f32_32x32x16_bf16 v[16:31], v[72:75], v[64:67], 0
    ds_read_b128 v[72:75], v85 offset:33792
    buffer_load_dwordx4 v15, s[68:71], s72 offen offset:2048 sc1 lds
    v_exp_f32 v36, v36
    v_exp_f32 v37, v37
    v_exp_f32 v38, v38
    v_exp_f32 v39, v39
    s_waitcnt lgkmcnt(3)
    v_mfma_f32_32x32x8_bf16 v[16:31], v[70:71], v[68:69], v[16:31]
    ds_read_b32 v70, v86 offset:33792
    v_exp_f32 v40, v40
    v_exp_f32 v41, v41
    v_exp_f32 v42, v42
    v_exp_f32 v43, v43
    s_waitcnt lgkmcnt(3)
    v_smfmac_f32_32x32x32_bf16 v[48:63], v[76:79], v[32:39], v84
    ds_read_b128 v[76:79], v87 offset:33792
    v_exp_f32 v44, v44
    v_exp_f32 v45, v45
    v_exp_f32 v46, v46
    v_exp_f32 v47, v47
    s_waitcnt lgkmcnt(0)
    s_barrier
    s_setprio 3
    v_smfmac_f32_32x32x32_bf16 v[48:63], v[80:83], v[40:47], v84
    ds_read_b128 v[80:83], v87 offset:37632
    v_exp_f32 v16, v16
    v_exp_f32 v17, v17
    v_exp_f32 v18, v18
    v_exp_f32 v19, v19
    v_mfma_f32_32x32x16_bf16 v[32:47], v[72:75], v[64:67], 0
    ds_read_b128 v[72:75], v85 offset:36864
    s_mov_b64 exec, 0x1fff
    buffer_load_dwordx2 v[6:7], v10, s[68:71], s14 offen offset:124 sc1
    s_mov_b64 exec, -1
    v_exp_f32 v20, v20
    v_exp_f32 v21, v21
    v_exp_f32 v22, v22
    v_exp_f32 v23, v23
    v_mfma_f32_32x32x8_bf16 v[32:47], v[70:71], v[68:69], v[32:47]
    ds_read_b32 v70, v86 offset:36864
    v_exp_f32 v24, v24
    v_exp_f32 v25, v25
    v_exp_f32 v26, v26
    v_exp_f32 v27, v27
    v_smfmac_f32_32x32x32_bf16 v[48:63], v[76:79], v[16:23], v84
    ds_read_b128 v[76:79], v87 offset:36864
    v_exp_f32 v28, v28
    v_exp_f32 v29, v29
    v_exp_f32 v30, v30
    v_exp_f32 v31, v31
    s_setprio 2
    s_waitcnt lgkmcnt(3)
    v_smfmac_f32_32x32x32_bf16 v[48:63], v[80:83], v[24:31], v84
    ds_read_b128 v[80:83], v87 offset:40704
    v_exp_f32 v32, v32
    v_exp_f32 v33, v33
    v_exp_f32 v34, v34
    v_exp_f32 v35, v35
    s_waitcnt lgkmcnt(3)
    v_mfma_f32_32x32x16_bf16 v[16:31], v[72:75], v[64:67], 0
    ds_read_b128 v[72:75], v85 offset:39936
    v_exp_f32 v36, v36
    v_exp_f32 v37, v37
    v_exp_f32 v38, v38
    v_exp_f32 v39, v39
    s_waitcnt lgkmcnt(3)
    v_mfma_f32_32x32x8_bf16 v[16:31], v[70:71], v[68:69], v[16:31]
    ds_read_b32 v70, v86 offset:39936
    v_exp_f32 v40, v40
    v_exp_f32 v41, v41
    v_exp_f32 v42, v42
    v_exp_f32 v43, v43
    s_waitcnt lgkmcnt(3)
    v_smfmac_f32_32x32x32_bf16 v[48:63], v[76:79], v[32:39], v84
    ds_read_b128 v[76:79], v87 offset:39936
    v_exp_f32 v44, v44
    v_exp_f32 v45, v45
    v_exp_f32 v46, v46
    v_exp_f32 v47, v47
    s_setprio 1
    s_waitcnt lgkmcnt(3)
    v_smfmac_f32_32x32x32_bf16 v[48:63], v[80:83], v[40:47], v84
    ds_read_b128 v[80:83], v87 offset:43776
    v_exp_f32 v16, v16
    v_exp_f32 v17, v17
    v_exp_f32 v18, v18
    v_exp_f32 v19, v19
    s_waitcnt lgkmcnt(3)
    v_mfma_f32_32x32x16_bf16 v[32:47], v[72:75], v[64:67], 0
    ds_read_b128 v[72:75], v85 offset:43008
    v_exp_f32 v20, v20
    v_exp_f32 v21, v21
    v_exp_f32 v22, v22
    v_exp_f32 v23, v23
    s_waitcnt lgkmcnt(3)
    v_mfma_f32_32x32x8_bf16 v[32:47], v[70:71], v[68:69], v[32:47]
    ds_read_b32 v70, v86 offset:43008
    v_exp_f32 v24, v24
    v_exp_f32 v25, v25
    v_exp_f32 v26, v26
    v_exp_f32 v27, v27
    s_waitcnt lgkmcnt(3)
    v_smfmac_f32_32x32x32_bf16 v[48:63], v[76:79], v[16:23], v84
    ds_read_b128 v[76:79], v87 offset:43008
    v_exp_f32 v28, v28
    v_exp_f32 v29, v29
    v_exp_f32 v30, v30
    v_exp_f32 v31, v31
    s_setprio 0
    s_waitcnt lgkmcnt(3)
    v_smfmac_f32_32x32x32_bf16 v[48:63], v[80:83], v[24:31], v84
    ds_read_b128 v[80:83], v87 offset:46848
    v_exp_f32 v32, v32
    v_exp_f32 v33, v33
    v_exp_f32 v34, v34
    v_exp_f32 v35, v35
    s_waitcnt lgkmcnt(3)
    v_mfma_f32_32x32x16_bf16 v[16:31], v[72:75], v[64:67], 0
    ds_read_b128 v[72:75], v85 offset:46080
    v_exp_f32 v36, v36
    v_exp_f32 v37, v37
    v_exp_f32 v38, v38
    v_exp_f32 v39, v39
    s_waitcnt lgkmcnt(3)
    v_mfma_f32_32x32x8_bf16 v[16:31], v[70:71], v[68:69], v[16:31]
    ds_read_b32 v70, v86 offset:46080
    v_exp_f32 v40, v40
    v_exp_f32 v41, v41
    v_exp_f32 v42, v42
    v_exp_f32 v43, v43
    s_waitcnt lgkmcnt(3)
    v_smfmac_f32_32x32x32_bf16 v[48:63], v[76:79], v[32:39], v84
    ds_read_b128 v[76:79], v87 offset:46080
    v_exp_f32 v44, v44
    v_exp_f32 v45, v45
    v_exp_f32 v46, v46
    v_exp_f32 v47, v47
    s_waitcnt vmcnt(1) lgkmcnt(0)
    s_barrier
    s_setprio 3
    v_smfmac_f32_32x32x32_bf16 v[48:63], v[80:83], v[40:47], v84
    ds_read_b128 v[80:83], v87 offset:768
    v_cmp_ne_u32 vcc, s4, v4
    s_cbranch_vccnz W2C_44
W2CB_45:
    v_exp_f32 v16, v16
    v_exp_f32 v17, v17
    v_exp_f32 v18, v18
    v_exp_f32 v19, v19
    v_mfma_f32_32x32x16_bf16 v[32:47], v[72:75], v[64:67], 0
    ds_read_b128 v[72:75], v85 offset:0
    v_exp_f32 v20, v20
    v_exp_f32 v21, v21
    v_exp_f32 v22, v22
    v_exp_f32 v23, v23
    v_mfma_f32_32x32x8_bf16 v[32:47], v[70:71], v[68:69], v[32:47]
    ds_read_b32 v70, v86 offset:0
    v_exp_f32 v24, v24
    v_exp_f32 v25, v25
    v_exp_f32 v26, v26
    v_exp_f32 v27, v27
    v_smfmac_f32_32x32x32_bf16 v[48:63], v[76:79], v[16:23], v84
    ds_read_b128 v[76:79], v87 offset:0
    v_exp_f32 v28, v28
    v_exp_f32 v29, v29
    v_exp_f32 v30, v30
    v_exp_f32 v31, v31
    s_setprio 2
    s_waitcnt lgkmcnt(3)
    v_smfmac_f32_32x32x32_bf16 v[48:63], v[80:83], v[24:31], v84
    ds_read_b128 v[80:83], v87 offset:3840
    v_exp_f32 v32, v32
    v_exp_f32 v33, v33
    v_exp_f32 v34, v34
    v_exp_f32 v35, v35
    s_waitcnt lgkmcnt(3)
    v_mfma_f32_32x32x16_bf16 v[16:31], v[72:75], v[64:67], 0
    ds_read_b128 v[72:75], v85 offset:3072
    v_exp_f32 v36, v36
    v_exp_f32 v37, v37
    v_exp_f32 v38, v38
    v_exp_f32 v39, v39
    s_waitcnt lgkmcnt(3)
    v_mfma_f32_32x32x8_bf16 v[16:31], v[70:71], v[68:69], v[16:31]
    ds_read_b32 v70, v86 offset:3072
    v_exp_f32 v40, v40
    v_exp_f32 v41, v41
    v_exp_f32 v42, v42
    v_exp_f32 v43, v43
    s_waitcnt lgkmcnt(3)
    v_smfmac_f32_32x32x32_bf16 v[48:63], v[76:79], v[32:39], v84
    ds_read_b128 v[76:79], v87 offset:3072
    v_exp_f32 v44, v44
    v_exp_f32 v45, v45
    v_exp_f32 v46, v46
    v_exp_f32 v47, v47
    s_setprio 1
    s_waitcnt lgkmcnt(3)
    v_smfmac_f32_32x32x32_bf16 v[48:63], v[80:83], v[40:47], v84
    ds_read_b128 v[80:83], v87 offset:6912
    v_exp_f32 v16, v16
    v_exp_f32 v17, v17
    v_exp_f32 v18, v18
    v_exp_f32 v19, v19
    s_waitcnt lgkmcnt(3)
    v_mfma_f32_32x32x16_bf16 v[32:47], v[72:75], v[64:67], 0
    ds_read_b128 v[72:75], v85 offset:6144
    v_exp_f32 v20, v20
    v_exp_f32 v21, v21
    v_exp_f32 v22, v22
    v_exp_f32 v23, v23
    s_waitcnt lgkmcnt(3)
    v_mfma_f32_32x32x8_bf16 v[32:47], v[70:71], v[68:69], v[32:47]
    ds_read_b32 v70, v86 offset:6144
    v_exp_f32 v24, v24
    v_exp_f32 v25, v25
    v_exp_f32 v26, v26
    v_exp_f32 v27, v27
    s_waitcnt lgkmcnt(3)
    v_smfmac_f32_32x32x32_bf16 v[48:63], v[76:79], v[16:23], v84
    ds_read_b128 v[76:79], v87 offset:6144
    v_exp_f32 v28, v28
    v_exp_f32 v29, v29
    v_exp_f32 v30, v30
    v_exp_f32 v31, v31
    s_setprio 0
    s_waitcnt lgkmcnt(3)
    v_smfmac_f32_32x32x32_bf16 v[48:63], v[80:83], v[24:31], v84
    ds_read_b128 v[80:83], v87 offset:9984
    v_exp_f32 v32, v32
    v_exp_f32 v33, v33
    v_exp_f32 v34, v34
    v_exp_f32 v35, v35
    s_waitcnt lgkmcnt(3)
    v_mfma_f32_32x32x16_bf16 v[16:31], v[72:75], v[64:67], 0
    ds_read_b128 v[72:75], v85 offset:9216
    v_exp_f32 v36, v36
    v_exp_f32 v37, v37
    v_exp_f32 v38, v38
    v_exp_f32 v39, v39
    s_waitcnt lgkmcnt(3)
    v_mfma_f32_32x32x8_bf16 v[16:31], v[70:71], v[68:69], v[16:31]
    ds_read_b32 v70, v86 offset:9216
    v_exp_f32 v40, v40
    v_exp_f32 v41, v41
    v_exp_f32 v42, v42
    v_exp_f32 v43, v43
    s_waitcnt lgkmcnt(3)
    v_smfmac_f32_32x32x32_bf16 v[48:63], v[76:79], v[32:39], v84
    ds_read_b128 v[76:79], v87 offset:9216
    v_exp_f32 v44, v44
    v_exp_f32 v45, v45
    v_exp_f32 v46, v46
    v_exp_f32 v47, v47
    s_waitcnt lgkmcnt(0)
    s_barrier
    s_setprio 3
    v_smfmac_f32_32x32x32_bf16 v[48:63], v[80:83], v[40:47], v84
    ds_read_b128 v[80:83], v87 offset:13056
    v_exp_f32 v16, v16
    v_exp_f32 v17, v17
    v_exp_f32 v18, v18
    v_exp_f32 v19, v19
    v_mfma_f32_32x32x16_bf16 v[32:47], v[72:75], v[64:67], 0
    ds_read_b128 v[72:75], v85 offset:12288
    v_exp_f32 v20, v20
    v_exp_f32 v21, v21
    v_exp_f32 v22, v22
    v_exp_f32 v23, v23
    v_mfma_f32_32x32x8_bf16 v[32:47], v[70:71], v[68:69], v[32:47]
    ds_read_b32 v70, v86 offset:12288
    v_exp_f32 v24, v24
    v_exp_f32 v25, v25
    v_exp_f32 v26, v26
    v_exp_f32 v27, v27
    v_smfmac_f32_32x32x32_bf16 v[48:63], v[76:79], v[16:23], v84
    ds_read_b128 v[76:79], v87 offset:12288
    v_exp_f32 v28, v28
    v_exp_f32 v29, v29
    v_exp_f32 v30, v30
    v_exp_f32 v31, v31
    s_setprio 2
    s_waitcnt lgkmcnt(3)
    v_smfmac_f32_32x32x32_bf16 v[48:63], v[80:83], v[24:31], v84
    ds_read_b128 v[80:83], v87 offset:16128
    v_exp_f32 v32, v32
    v_exp_f32 v33, v33
    v_exp_f32 v34, v34
    v_exp_f32 v35, v35
    s_waitcnt lgkmcnt(3)
    v_mfma_f32_32x32x16_bf16 v[16:31], v[72:75], v[64:67], 0
    ds_read_b128 v[72:75], v85 offset:15360
    v_exp_f32 v36, v36
    v_exp_f32 v37, v37
    v_exp_f32 v38, v38
    v_exp_f32 v39, v39
    s_waitcnt lgkmcnt(3)
    v_mfma_f32_32x32x8_bf16 v[16:31], v[70:71], v[68:69], v[16:31]
    ds_read_b32 v70, v86 offset:15360
    v_exp_f32 v40, v40
    v_exp_f32 v41, v41
    v_exp_f32 v42, v42
    v_exp_f32 v43, v43
    s_waitcnt lgkmcnt(3)
    v_smfmac_f32_32x32x32_bf16 v[48:63], v[76:79], v[32:39], v84
    ds_read_b128 v[76:79], v87 offset:15360
    v_exp_f32 v44, v44
    v_exp_f32 v45, v45
    v_exp_f32 v46, v46
    v_exp_f32 v47, v47
    s_setprio 1
    s_waitcnt lgkmcnt(3)
    v_smfmac_f32_32x32x32_bf16 v[48:63], v[80:83], v[40:47], v84
    ds_read_b128 v[80:83], v87 offset:19200
    v_exp_f32 v16, v16
    v_exp_f32 v17, v17
    v_exp_f32 v18, v18
    v_exp_f32 v19, v19
    s_waitcnt lgkmcnt(3)
    v_mfma_f32_32x32x16_bf16 v[32:47], v[72:75], v[64:67], 0
    ds_read_b128 v[72:75], v85 offset:18432
    v_exp_f32 v20, v20
    v_exp_f32 v21, v21
    v_exp_f32 v22, v22
    v_exp_f32 v23, v23
    s_waitcnt lgkmcnt(3)
    v_mfma_f32_32x32x8_bf16 v[32:47], v[70:71], v[68:69], v[32:47]
    ds_read_b32 v70, v86 offset:18432
    v_exp_f32 v24, v24
    v_exp_f32 v25, v25
    v_exp_f32 v26, v26
    v_exp_f32 v27, v27
    s_waitcnt lgkmcnt(3)
    v_smfmac_f32_32x32x32_bf16 v[48:63], v[76:79], v[16:23], v84
    ds_read_b128 v[76:79], v87 offset:18432
    v_exp_f32 v28, v28
    v_exp_f32 v29, v29
    v_exp_f32 v30, v30
    v_exp_f32 v31, v31
    s_waitcnt lgkmcnt(3)
    s_nop 0
    v_smfmac_f32_32x32x32_bf16 v[48:63], v[80:83], v[24:31], v84
    ds_read_b128 v[80:83], v87 offset:22272
    v_exp_f32 v32, v32
    v_exp_f32 v33, v33
    v_exp_f32 v34, v34
    v_exp_f32 v35, v35
    v_exp_f32 v36, v36
    v_exp_f32 v37, v37
    v_exp_f32 v38, v38
    v_exp_f32 v39, v39
    v_exp_f32 v40, v40
    v_exp_f32 v41, v41
    v_exp_f32 v42, v42
    v_exp_f32 v43, v43
    s_waitcnt lgkmcnt(1)
    v_smfmac_f32_32x32x32_bf16 v[48:63], v[76:79], v[32:39], v84
    v_exp_f32 v44, v44
    v_exp_f32 v45, v45
    v_exp_f32 v46, v46
    v_exp_f32 v47, v47
P2JE:
    s_branch P2E
W2C_44:
POLL_46:
    buffer_load_dword v4, v3, s[68:71], s13 offen sc1
    s_waitcnt vmcnt(0)
    v_cmp_ne_u32 vcc, s4, v4
    s_cbranch_vccz W2CB_45
    s_sleep 1
    s_sub_i32 s9, s9, 1
    s_cmp_gt_i32 s9, 0
    s_cbranch_scc1 POLL_46
    s_branch W2CB_45
.section .rodata,"a"
.p2align 6
.amdhsa_kernel sequential_preLN__grouped_kv_mqa__glu_gated_swiglu__prompt_kernel
  .amdhsa_next_free_vgpr 256
  .amdhsa_next_free_sgpr 102
  .amdhsa_accum_offset 256
  .amdhsa_group_segment_fixed_size 0
  .amdhsa_kernarg_size 96
  .amdhsa_user_sgpr_count 2
  .amdhsa_user_sgpr_kernarg_segment_ptr 1
  .amdhsa_system_sgpr_workgroup_id_x 1
.end_amdhsa_kernel
```
